```python
import torch

def _softmax(x, axis=-1):
    return torch.softmax(x, dim=axis)
def _gelu(x):
    return torch.nn.functional.gelu(x, approximate="tanh")
def _silu(x):
    return torch.nn.functional.silu(x)
def _sigmoid(x):
    return torch.sigmoid(x)
def _layernorm(x, axis=-1, eps=1e-5):
    m = x.mean(dim=axis, keepdim=True)
    v = x.var(dim=axis, keepdim=True, unbiased=False)
    return (x - m) / torch.sqrt(v + eps)
def _scatter_add(tgt, idx, src, axis=0):
    return tgt.clone().index_add_(axis, idx, src)
def _segment_sum(src, seg, n):
    out = torch.zeros((n,) + src.shape[1:], dtype=src.dtype)
    return out.index_add_(0, seg, src)
def _pad(x, pw):
    flat = tuple(v for pair in reversed(pw) for v in pair)
    return torch.nn.functional.pad(x, flat)

kernel_name = 'concat_heads__softmax_full_mha__linear_kernel_hedgehog__prompt'

def setup_inputs():

    _w = (lambda a: (lambda t: t.to(torch.bfloat16) if t.is_floating_point() else t)(torch.as_tensor(a)))
    def _A_setup():
        B, S, D = 1, 2048, 448
        return {
            "x": _w((lambda *s: torch.randn(*s, dtype=torch.bfloat16) * 0.4)(B, S, D)),
            "wqkv": _w((lambda *s: torch.randn(*s, dtype=torch.bfloat16) * 0.4)(D, 3 * D)),
            "wo": _w((lambda *s: torch.randn(*s, dtype=torch.bfloat16) * 0.05)(D, D)),
        }
    _A_in = _A_setup()

    def _B_setup():
        B, S, D, H = 1, 2048, 448, 16
        Dh = D // H
        return {
            "x": _w((lambda *s: torch.randn(*s, dtype=torch.bfloat16) * 0.8)(B, S, D)),
            "wqkv": _w((lambda *s: torch.randn(*s, dtype=torch.bfloat16) * 1.6)(D, 3 * D)),
            "w_phi": _w((lambda *s: torch.randn(*s, dtype=torch.bfloat16) * 1.6)(H, Dh, Dh) * (Dh ** -0.5)),
            "wo": _w((lambda *s: torch.randn(*s, dtype=torch.bfloat16) * 0.1)(D, D)),
        }
    _B_in = _B_setup()

    return {
        "A_x": _A_in["x"],
        "A_wqkv": _A_in["wqkv"],
        "A_wo": _A_in["wo"],
        "B_x": _B_in["x"],
        "B_wqkv": _B_in["wqkv"],
        "B_w_phi": _B_in["w_phi"],
        "B_wo": _B_in["wo"],
    }

def reference(A_x, A_wqkv, A_wo, B_x, B_wqkv, B_w_phi, B_wo):
    def _A_ref(x, wqkv, wo):
        B, S, D = x.shape
        H = 16; Dh = D // H
        qkv = (lambda x, *d: x.permute(*d))((x @ wqkv).reshape(B, S, 3, H, Dh), 2, 0, 3, 1, 4)
        q, k, v = qkv[0], qkv[1], qkv[2]
        scale = Dh ** -0.5
        scores = torch.einsum("bhqd,bhkd->bhqk", q, k) * scale
        p = _softmax(scores, axis=-1)
        o = torch.einsum("bhqk,bhkd->bhqd", p, v)
        return (lambda x, *d: x.permute(*d))(o, 0, 2, 1, 3).reshape(B, S, D) @ wo

    def _B_ref(x, wqkv, w_phi, wo):
        B, S, D = x.shape
        H = 16; Dh = D // H
        qkv = (lambda x, *d: x.permute(*d))((x @ wqkv).reshape(B, S, 3, H, Dh), 2, 0, 3, 1, 4)
        q, k, v = qkv[0], qkv[1], qkv[2]
        pq = torch.einsum("bhsd,hdf->bhsf", q, w_phi)
        pk = torch.einsum("bhsd,hdf->bhsf", k, w_phi)
        phi_q = torch.concatenate([_softmax(pq, axis=-1), _softmax(-pq, axis=-1)], axis=-1)
        phi_k = torch.concatenate([_softmax(pk, axis=-1), _softmax(-pk, axis=-1)], axis=-1)
        kv = torch.einsum("bhsf,bhsd->bhfd", phi_k, v)
        z  = torch.einsum("bhsf->bhf", phi_k)
        num = torch.einsum("bhqf,bhfd->bhqd", phi_q, kv)
        den = torch.einsum("bhqf,bhf->bhq", phi_q, z)[..., None] + 1e-6
        o = num / den
        return (lambda x, *d: x.permute(*d))(o, 0, 2, 1, 3).reshape(B, S, D) @ wo

    a = _A_ref(A_x, A_wqkv, A_wo)
    b = _B_ref(B_x, B_wqkv, B_w_phi, B_wo)
    return torch.concatenate([a, b], axis=-1)
```

```asm
; @launch grid=(256,1,1) block=(512,1,1) lds=163840
.amdgcn_target "amdgcn-amd-amdhsa--gfx950"
.text
.globl concat_heads__softmax_full_mha__linear_kernel_hedgehog__prompt_kernel
.p2align 8
.type concat_heads__softmax_full_mha__linear_kernel_hedgehog__prompt_kernel,@function
concat_heads__softmax_full_mha__linear_kernel_hedgehog__prompt_kernel:
    s_cmp_ge_u32 s2, 256
    s_cbranch_scc1 L_end
    s_load_dwordx16 s[4:19], s[0:1], 0
    s_load_dwordx4 s[20:23], s[0:1], 64
    v_readfirstlane_b32 s56, v0
    v_and_b32 v0, 63, v0
    s_lshr_b32 s56, s56, 6
    s_cmp_lt_u32 s56, 4
    s_cbranch_scc1 L_G
    s_bitcmp0_b32 s2, 3
    s_cbranch_scc0 L_ldB
    s_setprio 1
    s_and_b32 s58, s2, 7
    s_lshr_b32 s59, s2, 3
    s_and_b32 s60, s59, 1
    s_lshr_b32 s64, s59, 1
    s_lshr_b32 s67, s58, 1
    s_and_b32 s61, s64, 3
    s_lshl2_add_u32 s61, s67, s61
    s_and_b32 s67, s58, 1
    s_lshr_b32 s62, s64, 2
    s_lshl2_add_u32 s62, s67, s62
    s_and_b32 s57, s56, 3
    v_lshlrev_b32 v1, 4, v0
    v_lshrrev_b32 v16, 3, v0
    v_and_b32 v17, 7, v0
    v_lshrrev_b32 v18, 4, v0
    v_xor_b32 v13, v17, v18
    v_mul_u32_u24 v14, 896, v16
    v_lshl_add_u32 v112, v13, 4, v14
    s_lshl2_add_u32 s70, s61, s57
    s_mul_i32 s70, s70, 28672
    s_mov_b32 s26, 1835008
    s_mov_b32 s27, 0x20000
    s_mov_b32 s30, 1204224
    s_mov_b32 s31, 0x20000
    s_lshl_b32 s91, s58, 2
    s_lshr_b32 s67, 0x26045230, s91
    s_and_b32 s91, s67, 15
    s_lshl_b32 s67, s91, 7
    s_add_u32 s70, s70, s67
    s_and_b32 s72, s62, 3
    s_add_u32 s67, s72, 0
    s_and_b32 s67, s67, 3
    s_lshl2_add_u32 s76, s57, s67
    s_lshl_b32 s76, s76, 10
    s_mul_i32 s68, s67, 7168
    s_and_b32 s67, s67, 1
    s_lshl_b32 s67, s67, 6
    v_xor_b32 v116, s67, v112
    v_add_u32 v116, s68, v116
    s_waitcnt lgkmcnt(0)
    s_mov_b64 s[24:25], s[4:5]
    s_mov_b64 s[28:29], s[6:7]
    s_add_u32 m0, s76, 4096
    s_nop 0
    buffer_load_dwordx4 v116, s[24:27], s70 offen lds
    s_mul_i32 s71, s91, 172032
    s_and_b32 s73, s61, 3
    v_and_b32 v18, 1, v18
    v_lshlrev_b32 v13, 2, v18
    v_xor_b32 v13, v17, v13
    s_lshl_b32 s67, s57, 4
    v_add_u32 v14, s67, v16
    v_mul_u32_u24 v14, 2688, v14
    v_lshl_add_u32 v113, v13, 4, v14
    s_mul_i32 s68, s62, 336
    s_and_b32 s69, s68, 127
    s_sub_u32 s68, s68, s69
    s_add_u32 s71, s71, s68
    s_cmp_gt_u32 s69, 48
    s_cselect_b32 s74, 4, 3
    s_add_u32 s67, s73, 0
    s_and_b32 s67, s67, 3
    s_lshl2_add_u32 s80, s67, s57
    s_lshl_b32 s80, s80, 11
    s_cmp_eq_u32 s67, s74
    s_cselect_b32 s67, 0x800000, s67
    s_lshl_b32 s67, s67, 7
    v_add_u32 v120, s67, v113
    v_add_u32 v121, 20480, v120
    s_add_u32 m0, s80, 20480
    s_nop 0
    buffer_load_dwordx4 v120, s[28:31], s71 offen offset:0 lds
    buffer_load_dwordx4 v121, s[28:31], s71 offen offset:1024 lds
    s_add_u32 s67, s72, 1
    s_and_b32 s67, s67, 3
    s_lshl2_add_u32 s77, s57, s67
    s_lshl_b32 s77, s77, 10
    s_mul_i32 s68, s67, 7168
    s_and_b32 s67, s67, 1
    s_lshl_b32 s67, s67, 6
    v_xor_b32 v117, s67, v112
    v_add_u32 v117, s68, v117
    s_add_u32 m0, s77, 4096
    s_nop 0
    buffer_load_dwordx4 v117, s[24:27], s70 offen lds
    s_add_u32 s67, s73, 1
    s_and_b32 s67, s67, 3
    s_lshl2_add_u32 s81, s67, s57
    s_lshl_b32 s81, s81, 11
    s_cmp_eq_u32 s67, s74
    s_cselect_b32 s67, 0x800000, s67
    s_lshl_b32 s67, s67, 7
    v_add_u32 v122, s67, v113
    v_add_u32 v123, 20480, v122
    s_add_u32 m0, s81, 20480
    s_nop 0
    buffer_load_dwordx4 v122, s[28:31], s71 offen offset:0 lds
    buffer_load_dwordx4 v123, s[28:31], s71 offen offset:1024 lds
    s_add_u32 s67, s72, 2
    s_and_b32 s67, s67, 3
    s_lshl2_add_u32 s78, s57, s67
    s_lshl_b32 s78, s78, 10
    s_mul_i32 s68, s67, 7168
    s_and_b32 s67, s67, 1
    s_lshl_b32 s67, s67, 6
    v_xor_b32 v118, s67, v112
    v_add_u32 v118, s68, v118
    s_add_u32 m0, s78, 4096
    s_nop 0
    buffer_load_dwordx4 v118, s[24:27], s70 offen lds
    s_add_u32 s67, s73, 2
    s_and_b32 s67, s67, 3
    s_lshl2_add_u32 s82, s67, s57
    s_lshl_b32 s82, s82, 11
    s_cmp_eq_u32 s67, s74
    s_cselect_b32 s67, 0x800000, s67
    s_lshl_b32 s67, s67, 7
    v_add_u32 v124, s67, v113
    v_add_u32 v125, 20480, v124
    s_add_u32 m0, s82, 20480
    s_nop 0
    buffer_load_dwordx4 v124, s[28:31], s71 offen offset:0 lds
    buffer_load_dwordx4 v125, s[28:31], s71 offen offset:1024 lds
    s_add_u32 s67, s72, 3
    s_and_b32 s67, s67, 3
    s_lshl2_add_u32 s79, s57, s67
    s_lshl_b32 s79, s79, 10
    s_mul_i32 s68, s67, 7168
    s_and_b32 s67, s67, 1
    s_lshl_b32 s67, s67, 6
    v_xor_b32 v119, s67, v112
    v_add_u32 v119, s68, v119
    s_add_u32 m0, s79, 4096
    s_nop 0
    buffer_load_dwordx4 v119, s[24:27], s70 offen lds
    s_add_u32 s67, s73, 3
    s_and_b32 s67, s67, 3
    s_lshl2_add_u32 s83, s67, s57
    s_lshl_b32 s83, s83, 11
    s_cmp_eq_u32 s67, s74
    s_cselect_b32 s67, 0x800000, s67
    s_lshl_b32 s67, s67, 7
    v_add_u32 v126, s67, v113
    v_add_u32 v127, 20480, v126
    s_add_u32 m0, s83, 20480
    s_nop 0
    buffer_load_dwordx4 v126, s[28:31], s71 offen offset:0 lds
    buffer_load_dwordx4 v127, s[28:31], s71 offen offset:1024 lds
    s_mov_b32 s32, s22
    s_mov_b32 s33, s23
    s_mov_b32 s34, 20971520
    s_mov_b32 s35, 0x20000
    s_mov_b32 s36, s20
    s_mov_b32 s37, s21
    s_mov_b32 s38, 256
    s_mov_b32 s39, 0x20000
    s_cmp_lg_u32 s2, 0
    s_cbranch_scc1 L_noep
    s_mov_b32 s98, 524288
    buffer_load_dwordx2 v[8:9], off, s[32:35], s98 sc1
L_noep:
    s_add_u32 s91, s91, 1
    s_cmp_eq_u32 s91, 7
    s_cselect_b32 s67, -6, 1
    s_mul_i32 s68, s67, 172032
    s_lshl_b32 s67, s67, 7
    s_add_u32 s71, s71, s68
    s_add_u32 s70, s70, s67
    s_add_u32 m0, s76, 57344
    s_nop 0
    buffer_load_dwordx4 v116, s[24:27], s70 offen lds
    s_add_u32 m0, s80, 73728
    s_nop 0
    buffer_load_dwordx4 v120, s[28:31], s71 offen offset:0 lds
    s_setprio 0
    buffer_load_dwordx4 v121, s[28:31], s71 offen offset:1024 lds
    s_add_u32 m0, s77, 57344
    s_nop 0
    buffer_load_dwordx4 v117, s[24:27], s70 offen lds
    s_add_u32 m0, s81, 73728
    s_nop 0
    buffer_load_dwordx4 v122, s[28:31], s71 offen offset:0 lds
    buffer_load_dwordx4 v123, s[28:31], s71 offen offset:1024 lds
    s_add_u32 m0, s78, 57344
    s_nop 0
    buffer_load_dwordx4 v118, s[24:27], s70 offen lds
    s_add_u32 m0, s82, 73728
    s_nop 0
    buffer_load_dwordx4 v124, s[28:31], s71 offen offset:0 lds
    buffer_load_dwordx4 v125, s[28:31], s71 offen offset:1024 lds
    s_add_u32 m0, s79, 57344
    s_nop 0
    buffer_load_dwordx4 v119, s[24:27], s70 offen lds
    s_waitcnt vmcnt(10)
    s_barrier
    s_branch L_ldC
L_ldB:
    s_setprio 1
    s_and_b32 s58, s2, 7
    s_lshr_b32 s59, s2, 3
    s_and_b32 s60, s59, 1
    s_lshr_b32 s64, s59, 1
    s_lshr_b32 s67, s58, 1
    s_and_b32 s61, s64, 3
    s_lshl2_add_u32 s61, s67, s61
    s_and_b32 s67, s58, 1
    s_lshr_b32 s62, s64, 2
    s_lshl2_add_u32 s62, s67, s62
    s_and_b32 s57, s56, 3
    v_lshlrev_b32 v1, 4, v0
    v_lshrrev_b32 v16, 3, v0
    v_and_b32 v17, 7, v0
    v_lshrrev_b32 v18, 4, v0
    v_xor_b32_e64 v13, v17, v18
    v_mul_u32_u24 v14, 896, v16
    v_lshl_add_u32 v112, v13, 4, v14
    s_lshl2_add_u32 s70, s61, s57
    s_mul_i32 s70, s70, 28672
    s_mov_b32 s26, 1835008
    s_mov_b32 s27, 0x20000
    s_mov_b32 s30, 1204224
    s_mov_b32 s31, 0x20000
    s_lshl_b32 s91, s58, 2
    s_lshr_b32 s67, 0x26045230, s91
    s_and_b32 s91, s67, 15
    s_lshl_b32 s67, s91, 7
    s_add_u32 s70, s70, s67
    s_and_b32 s72, s62, 3
    s_add_u32 s67, s72, 0
    s_and_b32 s67, s67, 3
    s_lshl2_add_u32 s76, s57, s67
    s_lshl_b32 s76, s76, 10
    s_mul_i32 s68, s67, 7168
    s_and_b32 s67, s67, 1
    s_lshl_b32 s67, s67, 6
    v_xor_b32 v116, s67, v112
    v_add_u32 v116, s68, v116
    s_waitcnt lgkmcnt(0)
    s_mov_b64 s[24:25], s[10:11]
    s_mov_b64 s[28:29], s[12:13]
    s_add_u32 m0, s76, 4096
    s_nop 0
    buffer_load_dwordx4 v116, s[24:27], s70 offen lds
    s_mul_i32 s71, s91, 172032
    s_and_b32 s73, s61, 3
    v_and_b32 v18, 1, v18
    v_lshlrev_b32 v13, 2, v18
    v_xor_b32 v13, v17, v13
    s_lshl_b32 s67, s57, 4
    v_add_u32 v14, s67, v16
    v_mul_u32_u24 v14, 2688, v14
    v_lshl_add_u32 v113, v13, 4, v14
    s_mul_i32 s68, s62, 112
    s_and_b32 s69, s68, 127
    s_sub_u32 s68, s68, s69
    s_add_u32 s71, s71, s68
    s_cmp_gt_u32 s69, 16
    s_cselect_b32 s74, 0, 0x40000000
    s_and_b32 s69, s69, 64
    s_lshl_b32 s68, s69, 1
    v_add_u32 v113, s68, v113
    s_sub_u32 s69, 128, s69
    s_add_u32 s69, s69, s74
    v_lshrrev_b32 v13, 2, v13
    v_lshl_add_u32 v13, v13, 5, v16
    s_lshl_b32 s67, s57, 3
    v_add_u32 v13, s67, v13
    v_mul_u32_u24 v13, 2688, v13
    v_and_b32 v14, 3, v0
    v_lshl_add_u32 v13, v14, 4, v13
    v_add_u32 v114, s69, v13
    s_cmp_eq_u32 s73, 3
    s_cselect_b32 s73, 0, s73
    s_add_u32 s67, s73, 0
    s_sub_u32 s68, s67, 3
    s_min_u32 s67, s67, s68
    s_mul_i32 s68, s67, 12288
    s_lshl_b32 s69, s57, 10
    s_lshl1_add_u32 s80, s69, s68
    s_add_u32 s94, s69, s68
    s_mulk_i32 s67, 896
    v_add_u32 v120, s67, v113
    v_add_u32 v121, 20480, v120
    v_add_u32 v128, s67, v114
    s_add_u32 m0, s80, 20480
    s_nop 0
    buffer_load_dwordx4 v120, s[28:31], s71 offen offset:0 lds
    buffer_load_dwordx4 v121, s[28:31], s71 offen offset:1024 lds
    s_add_u32 m0, s94, 28672
    s_nop 0
    buffer_load_dwordx4 v128, s[28:31], s71 offen lds
    s_add_u32 s67, s72, 1
    s_and_b32 s67, s67, 3
    s_lshl2_add_u32 s77, s57, s67
    s_lshl_b32 s77, s77, 10
    s_mul_i32 s68, s67, 7168
    s_and_b32 s67, s67, 1
    s_lshl_b32 s67, s67, 6
    v_xor_b32 v117, s67, v112
    v_add_u32 v117, s68, v117
    s_add_u32 m0, s77, 4096
    s_nop 0
    buffer_load_dwordx4 v117, s[24:27], s70 offen lds
    s_add_u32 s67, s73, 1
    s_sub_u32 s68, s67, 3
    s_min_u32 s67, s67, s68
    s_mul_i32 s68, s67, 12288
    s_lshl_b32 s69, s57, 10
    s_lshl1_add_u32 s81, s69, s68
    s_add_u32 s95, s69, s68
    s_mulk_i32 s67, 896
    v_add_u32 v122, s67, v113
    v_add_u32 v123, 20480, v122
    v_add_u32 v129, s67, v114
    s_add_u32 m0, s81, 20480
    s_nop 0
    buffer_load_dwordx4 v122, s[28:31], s71 offen offset:0 lds
    buffer_load_dwordx4 v123, s[28:31], s71 offen offset:1024 lds
    s_add_u32 m0, s95, 28672
    s_nop 0
    buffer_load_dwordx4 v129, s[28:31], s71 offen lds
    s_add_u32 s67, s72, 2
    s_and_b32 s67, s67, 3
    s_lshl2_add_u32 s78, s57, s67
    s_lshl_b32 s78, s78, 10
    s_mul_i32 s68, s67, 7168
    s_and_b32 s67, s67, 1
    s_lshl_b32 s67, s67, 6
    v_xor_b32 v118, s67, v112
    v_add_u32 v118, s68, v118
    s_add_u32 m0, s78, 4096
    s_nop 0
    buffer_load_dwordx4 v118, s[24:27], s70 offen lds
    s_add_u32 s67, s73, 2
    s_sub_u32 s68, s67, 3
    s_min_u32 s67, s67, s68
    s_mul_i32 s68, s67, 12288
    s_lshl_b32 s69, s57, 10
    s_lshl1_add_u32 s82, s69, s68
    s_add_u32 s96, s69, s68
    s_mulk_i32 s67, 896
    v_add_u32 v124, s67, v113
    v_add_u32 v125, 20480, v124
    v_add_u32 v130, s67, v114
    s_add_u32 m0, s82, 20480
    s_nop 0
    buffer_load_dwordx4 v124, s[28:31], s71 offen offset:0 lds
    buffer_load_dwordx4 v125, s[28:31], s71 offen offset:1024 lds
    s_add_u32 m0, s96, 28672
    s_nop 0
    buffer_load_dwordx4 v130, s[28:31], s71 offen lds
    s_add_u32 s67, s72, 3
    s_and_b32 s67, s67, 3
    s_lshl2_add_u32 s79, s57, s67
    s_lshl_b32 s79, s79, 10
    s_mul_i32 s68, s67, 7168
    s_and_b32 s67, s67, 1
    s_lshl_b32 s67, s67, 6
    v_xor_b32 v119, s67, v112
    v_add_u32 v119, s68, v119
    s_add_u32 m0, s79, 4096
    s_nop 0
    buffer_load_dwordx4 v119, s[24:27], s70 offen lds
    s_mov_b32 s32, s22
    s_mov_b32 s33, s23
    s_mov_b32 s34, 20971520
    s_mov_b32 s35, 0x20000
    s_mov_b32 s36, s20
    s_mov_b32 s37, s21
    s_mov_b32 s38, 256
    s_mov_b32 s39, 0x20000
    s_mov_b32 s52, s14
    s_mov_b32 s53, s15
    s_mov_b32 s54, 25088
    s_mov_b32 s55, 0x20000
    s_add_u32 s91, s91, 1
    s_cmp_eq_u32 s91, 7
    s_cselect_b32 s67, -6, 1
    s_mul_i32 s68, s67, 172032
    s_lshl_b32 s67, s67, 7
    s_add_u32 s71, s71, s68
    s_add_u32 s70, s70, s67
    s_add_u32 m0, s76, 57344
    s_nop 0
    buffer_load_dwordx4 v116, s[24:27], s70 offen lds
    s_add_u32 m0, s80, 73728
    s_nop 0
    buffer_load_dwordx4 v120, s[28:31], s71 offen offset:0 lds
    s_setprio 0
    buffer_load_dwordx4 v121, s[28:31], s71 offen offset:1024 lds
    s_add_u32 m0, s94, 81920
    s_nop 0
    buffer_load_dwordx4 v128, s[28:31], s71 offen lds
    s_add_u32 m0, s77, 57344
    s_nop 0
    buffer_load_dwordx4 v117, s[24:27], s70 offen lds
    s_add_u32 m0, s81, 73728
    s_nop 0
    buffer_load_dwordx4 v122, s[28:31], s71 offen offset:0 lds
    buffer_load_dwordx4 v123, s[28:31], s71 offen offset:1024 lds
    s_add_u32 m0, s95, 81920
    s_nop 0
    buffer_load_dwordx4 v129, s[28:31], s71 offen lds
    s_add_u32 m0, s78, 57344
    s_nop 0
    buffer_load_dwordx4 v118, s[24:27], s70 offen lds
    s_add_u32 m0, s82, 73728
    s_nop 0
    buffer_load_dwordx4 v124, s[28:31], s71 offen offset:0 lds
    s_waitcnt vmcnt(10)
    s_barrier
    s_mul_i32 s98, s62, 3136
    s_lshl_b32 s99, s57, 10
    s_add_u32 s98, s98, s99
    s_add_u32 m0, s99, 0
    s_nop 0
    buffer_load_dwordx4 v1, s[52:55], s98 offen lds
    s_add_u32 m0, s82, 73728
    s_nop 0
    buffer_load_dwordx4 v125, s[28:31], s71 offen offset:1024 lds
    s_add_u32 m0, s96, 81920
    s_nop 0
    buffer_load_dwordx4 v130, s[28:31], s71 offen lds
    s_add_u32 m0, s79, 57344
    s_nop 0
    buffer_load_dwordx4 v119, s[24:27], s70 offen lds
    s_add_u32 s91, s91, 1
    s_cmp_eq_u32 s91, 7
    s_cselect_b32 s67, -6, 1
    s_mul_i32 s68, s67, 172032
    s_lshl_b32 s67, s67, 7
    s_add_u32 s71, s71, s68
    s_add_u32 s70, s70, s67
    s_add_u32 m0, s76, 110592
    s_nop 0
    buffer_load_dwordx4 v116, s[24:27], s70 offen lds
    s_add_u32 m0, s80, 126976
    s_nop 0
    buffer_load_dwordx4 v120, s[28:31], s71 offen offset:0 lds
    buffer_load_dwordx4 v121, s[28:31], s71 offen offset:1024 lds
    s_add_u32 m0, s94, 135168
    s_nop 0
    buffer_load_dwordx4 v128, s[28:31], s71 offen lds
    s_add_u32 m0, s77, 110592
    s_nop 0
    buffer_load_dwordx4 v117, s[24:27], s70 offen lds
    s_add_u32 m0, s81, 126976
    s_nop 0
    buffer_load_dwordx4 v122, s[28:31], s71 offen offset:0 lds
    buffer_load_dwordx4 v123, s[28:31], s71 offen offset:1024 lds
    s_add_u32 m0, s95, 135168
    s_nop 0
    buffer_load_dwordx4 v129, s[28:31], s71 offen lds
    s_add_u32 m0, s78, 110592
    s_nop 0
    buffer_load_dwordx4 v118, s[24:27], s70 offen lds
    s_add_u32 m0, s82, 126976
    s_nop 0
    buffer_load_dwordx4 v124, s[28:31], s71 offen offset:0 lds
    s_waitcnt vmcnt(10)
    s_barrier
    buffer_load_dwordx4 v125, s[28:31], s71 offen offset:1024 lds
    s_mov_b32 s40, s18
    s_mov_b32 s41, s19
    s_mov_b32 s42, 3670016
    s_mov_b32 s43, 0x20000
    s_add_u32 m0, s96, 135168
    s_nop 0
    buffer_load_dwordx4 v130, s[28:31], s71 offen lds
    s_mul_i32 s4, s59, 37
    s_lshr_b32 s4, s4, 8
    s_mul_i32 s5, s4, 7
    s_sub_u32 s65, s59, s5
    s_add_u32 m0, s79, 110592
    s_nop 0
    buffer_load_dwordx4 v119, s[24:27], s70 offen lds
    s_lshl_b32 s66, s58, 2
    s_add_u32 s66, s66, s4
    s_lshl1_add_u32 s63, s58, s60
    v_mov_b32 v2, 0xdddddddd
    s_add_u32 s91, s91, 1
    s_cmp_eq_u32 s91, 7
    s_cselect_b32 s67, -6, 1
    s_mul_i32 s68, s67, 172032
    s_lshl_b32 s67, s67, 7
    s_add_u32 s71, s71, s68
    s_add_u32 s70, s70, s67
    s_add_u32 m0, s76, 4096
    s_nop 0
    buffer_load_dwordx4 v116, s[24:27], s70 offen lds
    s_lshl_b32 s4, s58, 4
    s_lshl2_add_u32 s10, s57, s4
    s_add_u32 s4, s4, s64
    v_and_b32 v12, 3, v0
    s_add_u32 m0, s80, 20480
    s_nop 0
    buffer_load_dwordx4 v120, s[28:31], s71 offen offset:0 lds
    v_lshrrev_b32 v13, 2, v0
    v_add_u32 v13, 1, v13
    v_lshl_add_u32 v12, v13, 7, v12
    v_add_u32 v3, s10, v12
    buffer_load_dwordx4 v121, s[28:31], s71 offen offset:1024 lds
    v_writelane_b32 v3, s4, 8
    v_lshlrev_b32 v3, 7, v3
    s_add_u32 s6, s57, 1
    s_and_b32 s6, s6, 3
    s_add_u32 m0, s94, 28672
    s_nop 0
    buffer_load_dwordx4 v128, s[28:31], s71 offen lds
    s_lshl_b32 s7, s6, 12
    s_add_u32 s7, s7, 114688
    v_add_u32 v4, s7, v1
    s_lshl_b32 s7, s6, 11
    s_add_u32 m0, s77, 4096
    s_nop 0
    buffer_load_dwordx4 v117, s[24:27], s70 offen lds
    s_add_u32 s7, s7, 57344
    v_add_u32 v8, s7, v1
    s_add_u32 s6, s57, 2
    s_and_b32 s6, s6, 3
    s_add_u32 m0, s81, 20480
    s_nop 0
    buffer_load_dwordx4 v122, s[28:31], s71 offen offset:0 lds
    s_lshl_b32 s7, s6, 12
    s_add_u32 s7, s7, 131072
    v_add_u32 v5, s7, v1
    s_lshl_b32 s7, s6, 11
    buffer_load_dwordx4 v123, s[28:31], s71 offen offset:1024 lds
    s_add_u32 s7, s7, 57344
    v_add_u32 v9, s7, v1
    s_add_u32 s6, s57, 3
    s_and_b32 s6, s6, 3
    s_add_u32 m0, s95, 28672
    s_nop 0
    buffer_load_dwordx4 v129, s[28:31], s71 offen lds
    s_lshl_b32 s7, s6, 12
    s_add_u32 s7, s7, 147456
    v_add_u32 v6, s7, v1
    s_lshl_b32 s7, s6, 11
    s_add_u32 m0, s78, 4096
    s_nop 0
    buffer_load_dwordx4 v118, s[24:27], s70 offen lds
    s_add_u32 s7, s7, 57344
    v_add_u32 v10, s7, v1
    s_add_u32 s6, s57, 4
    s_and_b32 s6, s6, 3
    s_add_u32 m0, s82, 20480
    s_nop 0
    buffer_load_dwordx4 v124, s[28:31], s71 offen offset:0 lds
    s_lshl_b32 s7, s6, 12
    s_add_u32 s7, s7, 114688
    v_add_u32 v7, s7, v1
    s_lshl_b32 s7, s6, 11
    s_waitcnt vmcnt(10)
    s_barrier
    s_mov_b32 s44, s8
    s_mov_b32 s45, s9
    s_mov_b32 s46, 401408
    s_mov_b32 s47, 0x20000
    s_mov_b32 s48, s16
    s_mov_b32 s49, s17
    s_mov_b32 s50, 401408
    s_mov_b32 s51, 0x20000
    s_lshl2_add_u32 s98, s2, s57
    s_mulk_i32 s98, 512
    v_lshlrev_b32 v132, 7, v0
    s_mov_b64 exec, 15
    buffer_load_dword v255, v132, s[44:47], s98 offen
    buffer_load_dword v255, v132, s[48:51], s98 offen
    buffer_load_dword v255, v132, s[32:35], s98 offen
    s_mov_b64 exec, -1
    buffer_load_dwordx4 v125, s[28:31], s71 offen offset:1024 lds
    s_add_u32 s7, s7, 57344
    v_add_u32 v11, s7, v1
    s_and_b32 s10, s57, 1
    s_lshr_b32 s11, s57, 1
    s_add_u32 m0, s96, 28672
    s_nop 0
    buffer_load_dwordx4 v130, s[28:31], s71 offen lds
    v_bfe_u32 v12, v0, 2, 2
    v_and_b32 v13, 3, v0
    v_lshlrev_b32 v13, 3, v13
    v_bfe_u32 v14, v0, 4, 1
    s_add_u32 m0, s79, 4096
    s_nop 0
    buffer_load_dwordx4 v119, s[24:27], s70 offen lds
    v_lshl_or_b32 v13, v14, 5, v13
    s_mul_i32 s12, s11, 28672
    s_add_u32 s12, s12, 57344
    v_add_u32 v13, s12, v13
    s_add_u32 s91, s91, 1
    s_cmp_eq_u32 s91, 7
    s_cselect_b32 s67, -6, 1
    s_mul_i32 s68, s67, 172032
    s_lshl_b32 s67, s67, 7
    s_add_u32 s71, s71, s68
    s_add_u32 s70, s70, s67
    s_add_u32 m0, s76, 57344
    s_nop 0
    buffer_load_dwordx4 v116, s[24:27], s70 offen lds
    v_lshrrev_b32 v14, 5, v0
    v_lshl_add_u32 v16, v14, 2, v12
    v_lshrrev_b32 v17, 1, v12
    v_xor_b32 v17, s11, v17
    s_add_u32 m0, s80, 73728
    s_nop 0
    buffer_load_dwordx4 v120, s[28:31], s71 offen offset:0 lds
    v_lshl_add_u32 v17, v17, 6, v13
    v_lshl_add_u32 v240, v16, 7, v17
    v_xor_b32 v241, 64, v240
    v_mov_b32 v18, 0x1a0b1918
    buffer_load_dwordx4 v121, s[28:31], s71 offen offset:1024 lds
    v_mov_b32 v19, 0x180f1b1a
    v_lshlrev_b32 v16, 3, v16
    v_lshrrev_b64 v[16:17], v16, v[18:19]
    v_and_b32 v16, 255, v16
    s_add_u32 m0, s94, 81920
    s_nop 0
    buffer_load_dwordx4 v128, s[28:31], s71 offen lds
    v_bfe_u32 v17, v16, 1, 1
    v_xor_b32 v17, s11, v17
    v_lshl_add_u32 v17, v17, 6, v13
    v_lshl_add_u32 v242, v16, 7, v17
    s_add_u32 m0, s77, 57344
    s_nop 0
    buffer_load_dwordx4 v117, s[24:27], s70 offen lds
    v_xor_b32 v243, 64, v242
    s_lshl_b32 s12, s57, 12
    s_add_u32 s12, s12, 131072
    v_add_u32 v244, s12, v1
    s_add_u32 m0, s81, 73728
    s_nop 0
    buffer_load_dwordx4 v122, s[28:31], s71 offen offset:0 lds
    s_xor_b32 s12, s57, 2
    s_lshl_b32 s12, s12, 12
    s_add_u32 s12, s12, 131072
    v_add_u32 v245, s12, v1
    buffer_load_dwordx4 v123, s[28:31], s71 offen offset:1024 lds
    v_and_b32 v12, 31, v0
    v_bfe_u32 v13, v12, 1, 2
    v_lshlrev_b32 v13, 4, v13
    v_lshl_or_b32 v13, v14, 3, v13
    s_add_u32 m0, s95, 81920
    s_nop 0
    buffer_load_dwordx4 v129, s[28:31], s71 offen lds
    v_lshl_or_b32 v13, v12, 6, v13
    v_add_u32 v252, s12, v13
    v_lshrrev_b32 v12, 2, v0
    v_bfe_u32 v14, v0, 3, 2
    s_add_u32 m0, s78, 57344
    s_nop 0
    buffer_load_dwordx4 v118, s[24:27], s70 offen lds
    v_xor_b32 v14, v14, v0
    v_and_b32 v14, 3, v14
    v_and_b32 v13, 19, v12
    v_bfe_u32 v16, v12, 2, 1
    s_add_u32 m0, s82, 73728
    s_nop 0
    buffer_load_dwordx4 v124, s[28:31], s71 offen offset:0 lds
    v_lshl_or_b32 v13, v16, 3, v13
    v_bfe_u32 v16, v12, 3, 1
    v_lshl_or_b32 v12, v16, 2, v13
    v_mul_u32_u24 v12, 1792, v12
    s_waitcnt vmcnt(10)
    s_barrier
    buffer_load_dwordx4 v125, s[28:31], s71 offen offset:1024 lds
    v_lshl_add_u32 v246, v14, 4, v12
    s_lshl1_add_u32 s12, s66, s10
    s_mul_i32 s84, s12, 57344
    s_lshl_b32 s13, s65, 7
    s_add_u32 m0, s96, 81920
    s_nop 0
    buffer_load_dwordx4 v130, s[28:31], s71 offen lds
    s_add_u32 s84, s84, s13
    s_lshl_b32 s13, s11, 6
    s_add_u32 s84, s84, s13
    s_add_u32 s84, s84, 0
    s_add_u32 m0, s79, 57344
    s_nop 0
    buffer_load_dwordx4 v119, s[24:27], s70 offen lds
    s_lshl1_add_u32 s3, s12, s11
    s_lshl_b32 s85, s3, 14
    s_add_u32 s85, s85, 8388608
    s_lshl_b32 s3, s3, 10
    s_mov_b32 s73, 0
    s_add_u32 s67, s73, 0
    s_sub_u32 s68, s67, 3
    s_min_u32 s67, s67, s68
    s_mul_i32 s68, s67, 12288
    s_lshl_b32 s69, s57, 10
    s_lshl1_add_u32 s80, s69, s68
    s_add_u32 s94, s69, s68
    s_mulk_i32 s67, 896
    v_add_u32 v120, s67, v113
    v_add_u32 v121, 20480, v120
    v_add_u32 v128, s67, v114
    s_add_u32 s67, s73, 1
    s_sub_u32 s68, s67, 3
    s_min_u32 s67, s67, s68
    s_mul_i32 s68, s67, 12288
    s_lshl_b32 s69, s57, 10
    s_lshl1_add_u32 s81, s69, s68
    s_add_u32 s95, s69, s68
    s_mulk_i32 s67, 896
    v_add_u32 v122, s67, v113
    v_add_u32 v123, 20480, v122
    v_add_u32 v129, s67, v114
    s_add_u32 s67, s73, 2
    s_sub_u32 s68, s67, 3
    s_min_u32 s67, s67, s68
    s_mul_i32 s68, s67, 12288
    s_lshl_b32 s69, s57, 10
    s_lshl1_add_u32 s82, s69, s68
    s_add_u32 s96, s69, s68
    s_mulk_i32 s67, 896
    v_add_u32 v124, s67, v113
    v_add_u32 v125, 20480, v124
    v_add_u32 v130, s67, v114
    s_add_u32 s91, s91, 1
    s_cmp_eq_u32 s91, 7
    s_cselect_b32 s67, -6, 1
    s_mul_i32 s68, s67, 172032
    s_lshl_b32 s67, s67, 7
    s_add_u32 s71, s71, s68
    s_add_u32 s70, s70, s67
    s_add_u32 m0, s76, 110592
    s_nop 0
    buffer_load_dwordx4 v116, s[24:27], s70 offen lds
    s_add_u32 s3, s3, 196608
    v_lshlrev_b32 v247, 7, v0
    v_add_u32 v247, s3, v247
    v_mov_b64 v[16:17], 0
    s_add_u32 m0, s77, 110592
    s_nop 0
    buffer_load_dwordx4 v117, s[24:27], s70 offen lds
    v_mov_b64 v[18:19], 0
    v_mov_b64 v[20:21], 0
    v_mov_b64 v[22:23], 0
    v_mov_b64 v[24:25], 0
    s_add_u32 m0, s78, 110592
    s_nop 0
    buffer_load_dwordx4 v118, s[24:27], s70 offen lds
    v_mov_b64 v[26:27], 0
    v_mov_b64 v[28:29], 0
    v_mov_b64 v[30:31], 0
    v_mov_b64 v[32:33], 0
    s_add_u32 m0, s79, 110592
    s_nop 0
    buffer_load_dwordx4 v119, s[24:27], s70 offen lds
    v_mov_b64 v[34:35], 0
    v_mov_b64 v[36:37], 0
    v_mov_b64 v[38:39], 0
    v_mov_b64 v[40:41], 0
    s_add_u32 m0, s81, 126976
    s_nop 0
    buffer_load_dwordx4 v122, s[28:31], s71 offen offset:0 lds
    v_mov_b64 v[42:43], 0
    v_mov_b64 v[44:45], 0
    v_mov_b64 v[46:47], 0
    v_mov_b64 v[48:49], 0
    buffer_load_dwordx4 v123, s[28:31], s71 offen offset:1024 lds
    v_mov_b64 v[50:51], 0
    v_mov_b64 v[52:53], 0
    v_mov_b64 v[54:55], 0
    v_mov_b64 v[56:57], 0
    s_add_u32 m0, s95, 135168
    s_nop 0
    buffer_load_dwordx4 v129, s[28:31], s71 offen lds
    v_mov_b64 v[58:59], 0
    v_mov_b64 v[60:61], 0
    v_mov_b64 v[62:63], 0
    v_mov_b64 v[64:65], 0
    s_waitcnt vmcnt(7)
    s_barrier
    s_mov_b32 s75, s71
    s_add_u32 s91, s91, 1
    s_cmp_eq_u32 s91, 7
    s_cselect_b32 s67, -6, 1
    s_mul_i32 s68, s67, 172032
    s_lshl_b32 s67, s67, 7
    s_add_u32 s71, s71, s68
    s_add_u32 s70, s70, s67
    s_add_u32 m0, s76, 4096
    s_nop 0
    buffer_load_dwordx4 v116, s[24:27], s70 offen lds
    v_mov_b64 v[66:67], 0
    v_mov_b64 v[68:69], 0
    v_mov_b64 v[70:71], 0
    v_mov_b64 v[72:73], 0
    s_add_u32 m0, s77, 4096
    s_nop 0
    buffer_load_dwordx4 v117, s[24:27], s70 offen lds
    v_mov_b64 v[74:75], 0
    v_mov_b64 v[76:77], 0
    v_mov_b64 v[78:79], 0
    s_add_u32 m0, s78, 4096
    s_nop 0
    buffer_load_dwordx4 v118, s[24:27], s70 offen lds
    s_add_u32 m0, s79, 4096
    s_nop 0
    buffer_load_dwordx4 v119, s[24:27], s70 offen lds
    s_add_u32 m0, s81, 20480
    s_nop 0
    buffer_load_dwordx4 v122, s[28:31], s71 offen offset:0 lds
    buffer_load_dwordx4 v123, s[28:31], s71 offen offset:1024 lds
    s_add_u32 m0, s95, 28672
    s_nop 0
    buffer_load_dwordx4 v129, s[28:31], s71 offen lds
    s_add_u32 m0, s80, 20480
    s_nop 0
    buffer_load_dwordx4 v120, s[28:31], s71 offen offset:0 lds
    buffer_load_dwordx4 v121, s[28:31], s71 offen offset:1024 lds
    s_add_u32 m0, s94, 28672
    s_nop 0
    buffer_load_dwordx4 v128, s[28:31], s71 offen lds
    s_waitcnt vmcnt(10)
    s_barrier
    s_add_u32 m0, s80, 126976
    s_nop 0
    buffer_load_dwordx4 v120, s[28:31], s75 offen offset:0 lds
    buffer_load_dwordx4 v121, s[28:31], s75 offen offset:1024 lds
    s_add_u32 m0, s94, 135168
    s_nop 0
    buffer_load_dwordx4 v128, s[28:31], s75 offen lds
    s_add_u32 m0, s82, 126976
    s_nop 0
    buffer_load_dwordx4 v124, s[28:31], s75 offen offset:0 lds
    buffer_load_dwordx4 v125, s[28:31], s75 offen offset:1024 lds
    s_add_u32 m0, s96, 135168
    s_nop 0
    buffer_load_dwordx4 v130, s[28:31], s75 offen lds
    s_add_u32 m0, s82, 20480
    s_nop 0
    buffer_load_dwordx4 v124, s[28:31], s71 offen offset:0 lds
    s_waitcnt vmcnt(10)
    s_barrier
    buffer_load_dwordx4 v125, s[28:31], s71 offen offset:1024 lds
    s_add_u32 m0, s96, 28672
    s_nop 0
    buffer_load_dwordx4 v130, s[28:31], s71 offen lds
    buffer_load_dwordx4 v[248:251], off, s[36:39], 0 sc1
    s_waitcnt vmcnt(7)
    s_barrier
    v_lshlrev_b32 v134, 2, v0
    v_add_u32 v134, 65536, v134
    v_mov_b32 v135, 0
    ds_write_b32 v134, v135
    s_mov_b32 s90, 0x40000
L_tagwaitB:
    s_waitcnt vmcnt(0)
    v_and_b32 v134, v248, v249
    v_bitop3_b32 v134, v134, v250, v251 bitop3:0x80
    v_and_b32 v134, 1, v134
    v_cmp_ne_u32 vcc, 1, v134
    s_cbranch_vccz L_tagokB
    buffer_load_dwordx4 v[248:251], off, s[36:39], 0 sc1
    s_sub_u32 s90, s90, 1
    s_cbranch_scc0 L_tagwaitB
    s_waitcnt vmcnt(0)
L_tagokB:
    s_lshl2_add_u32 s70, s63, s57
    s_lshl_b32 s70, s70, 16
    s_add_u32 s70, s70, 4194304
    s_lshl4_add_u32 s71, s63, s64
    s_lshl2_add_u32 s71, s71, s57
    s_lshl_b32 s71, s71, 11
    s_add_u32 s71, s71, 1048576
    s_mov_b32 s77, 0xc2c00000
    s_mov_b32 s78, 0x3e8b97f6
    s_mov_b32 s79, 0xffff0000
    v_and_b32 v12, 3, v0
    v_lshlrev_b32 v12, 4, v12
    v_lshrrev_b64 v[12:13], v12, v[248:249]
    v_lshlrev_b32 v253, 16, v12
    s_mov_b32 s86, 0x07060302
    s_mov_b32 s87, 0x07060100
    v_mov_b32 v15, 1
    s_waitcnt lgkmcnt(0)
    s_barrier
    s_branch L_ldE
L_ldC:
    s_lshl3_add_u32 s98, s2, s56
    s_cmp_lg_u32 s98, 4
    s_cbranch_scc1 L_notag
    v_add_u32 v8, 0x7f4a7c16, v8
    v_add_u32 v9, 0x9e3779b8, v9
    v_or_b32 v16, 1, v8
    v_or_b32 v17, 1, v9
    v_or_b32 v18, 1, v8
    v_or_b32 v19, 1, v9
    s_mov_b32 s98, 524288
    s_mov_b64 exec, 1
    buffer_store_dwordx4 v[16:19], off, s[36:39], 0 sc1
    buffer_store_dwordx4 v[16:19], off, s[32:35], s98 sc1
    s_mov_b64 exec, -1
L_notag:
    s_add_u32 m0, s83, 73728
    s_nop 0
    buffer_load_dwordx4 v126, s[28:31], s71 offen offset:0 lds
    buffer_load_dwordx4 v127, s[28:31], s71 offen offset:1024 lds
    s_add_u32 s91, s91, 1
    s_cmp_eq_u32 s91, 7
    s_cselect_b32 s67, -6, 1
    s_mul_i32 s68, s67, 172032
    s_lshl_b32 s67, s67, 7
    s_add_u32 s71, s71, s68
    s_add_u32 s70, s70, s67
    s_add_u32 m0, s76, 110592
    s_nop 0
    buffer_load_dwordx4 v116, s[24:27], s70 offen lds
    s_add_u32 m0, s80, 126976
    s_nop 0
    buffer_load_dwordx4 v120, s[28:31], s71 offen offset:0 lds
    buffer_load_dwordx4 v121, s[28:31], s71 offen offset:1024 lds
    s_add_u32 m0, s77, 110592
    s_nop 0
    buffer_load_dwordx4 v117, s[24:27], s70 offen lds
    s_add_u32 m0, s81, 126976
    s_nop 0
    buffer_load_dwordx4 v122, s[28:31], s71 offen offset:0 lds
    buffer_load_dwordx4 v123, s[28:31], s71 offen offset:1024 lds
    s_add_u32 m0, s78, 110592
    s_nop 0
    buffer_load_dwordx4 v118, s[24:27], s70 offen lds
    s_add_u32 m0, s82, 126976
    s_nop 0
    buffer_load_dwordx4 v124, s[28:31], s71 offen offset:0 lds
    buffer_load_dwordx4 v125, s[28:31], s71 offen offset:1024 lds
    s_add_u32 m0, s79, 110592
    s_nop 0
    buffer_load_dwordx4 v119, s[24:27], s70 offen lds
    s_waitcnt vmcnt(10)
    s_barrier
    s_add_u32 m0, s83, 126976
    s_nop 0
    buffer_load_dwordx4 v126, s[28:31], s71 offen offset:0 lds
    s_mov_b32 s40, s18
    s_mov_b32 s41, s19
    s_mov_b32 s42, 3670016
    s_mov_b32 s43, 0x20000
    buffer_load_dwordx4 v127, s[28:31], s71 offen offset:1024 lds
    s_mul_i32 s4, s59, 37
    s_lshr_b32 s4, s4, 8
    s_mul_i32 s5, s4, 7
    s_sub_u32 s65, s59, s5
    s_add_u32 s91, s91, 1
    s_cmp_eq_u32 s91, 7
    s_cselect_b32 s67, -6, 1
    s_mul_i32 s68, s67, 172032
    s_lshl_b32 s67, s67, 7
    s_add_u32 s71, s71, s68
    s_add_u32 s70, s70, s67
    s_add_u32 m0, s76, 4096
    s_nop 0
    buffer_load_dwordx4 v116, s[24:27], s70 offen lds
    s_lshl_b32 s66, s58, 2
    s_add_u32 s66, s66, s4
    s_lshl1_add_u32 s63, s58, s60
    v_mov_b32 v2, 0xdddddddd
    s_add_u32 m0, s80, 20480
    s_nop 0
    buffer_load_dwordx4 v120, s[28:31], s71 offen offset:0 lds
    s_lshl_b32 s4, s58, 4
    s_lshl2_add_u32 s10, s57, s4
    s_add_u32 s4, s4, s64
    v_and_b32 v12, 3, v0
    buffer_load_dwordx4 v121, s[28:31], s71 offen offset:1024 lds
    v_lshrrev_b32 v13, 2, v0
    v_add_u32 v13, 1, v13
    v_lshl_add_u32 v12, v13, 7, v12
    v_add_u32 v3, s10, v12
    s_add_u32 m0, s77, 4096
    s_nop 0
    buffer_load_dwordx4 v117, s[24:27], s70 offen lds
    v_writelane_b32 v3, s4, 8
    v_lshlrev_b32 v3, 7, v3
    s_add_u32 s6, s57, 1
    s_and_b32 s6, s6, 3
    s_add_u32 m0, s81, 20480
    s_nop 0
    buffer_load_dwordx4 v122, s[28:31], s71 offen offset:0 lds
    s_lshl_b32 s7, s6, 12
    s_add_u32 s7, s7, 114688
    v_add_u32 v4, s7, v1
    s_lshl_b32 s7, s6, 11
    buffer_load_dwordx4 v123, s[28:31], s71 offen offset:1024 lds
    s_add_u32 s7, s7, 114688
    v_add_u32 v8, s7, v1
    s_add_u32 s6, s57, 2
    s_and_b32 s6, s6, 3
    s_add_u32 m0, s78, 4096
    s_nop 0
    buffer_load_dwordx4 v118, s[24:27], s70 offen lds
    s_lshl_b32 s7, s6, 12
    s_add_u32 s7, s7, 131072
    v_add_u32 v5, s7, v1
    s_lshl_b32 s7, s6, 11
    s_add_u32 m0, s82, 20480
    s_nop 0
    buffer_load_dwordx4 v124, s[28:31], s71 offen offset:0 lds
    s_add_u32 s7, s7, 114688
    v_add_u32 v9, s7, v1
    s_add_u32 s6, s57, 3
    s_and_b32 s6, s6, 3
    buffer_load_dwordx4 v125, s[28:31], s71 offen offset:1024 lds
    s_lshl_b32 s7, s6, 12
    s_add_u32 s7, s7, 147456
    v_add_u32 v6, s7, v1
    s_lshl_b32 s7, s6, 11
    s_add_u32 m0, s79, 4096
    s_nop 0
    buffer_load_dwordx4 v119, s[24:27], s70 offen lds
    s_add_u32 s7, s7, 114688
    v_add_u32 v10, s7, v1
    s_add_u32 s6, s57, 4
    s_and_b32 s6, s6, 3
    s_waitcnt vmcnt(10)
    s_barrier
    s_mov_b32 s44, s8
    s_mov_b32 s45, s9
    s_mov_b32 s46, 401408
    s_mov_b32 s47, 0x20000
    s_mov_b32 s48, s16
    s_mov_b32 s49, s17
    s_mov_b32 s50, 401408
    s_mov_b32 s51, 0x20000
    s_lshl2_add_u32 s98, s2, s57
    s_mulk_i32 s98, 512
    v_lshlrev_b32 v132, 7, v0
    s_mov_b64 exec, 15
    buffer_load_dword v255, v132, s[44:47], s98 offen
    buffer_load_dword v255, v132, s[48:51], s98 offen
    buffer_load_dword v255, v132, s[32:35], s98 offen
    s_mov_b64 exec, -1
    s_add_u32 m0, s83, 20480
    s_nop 0
    buffer_load_dwordx4 v126, s[28:31], s71 offen offset:0 lds
    s_lshl_b32 s7, s6, 12
    s_add_u32 s7, s7, 114688
    v_add_u32 v7, s7, v1
    s_lshl_b32 s7, s6, 11
    buffer_load_dwordx4 v127, s[28:31], s71 offen offset:1024 lds
    s_add_u32 s7, s7, 114688
    v_add_u32 v11, s7, v1
    s_and_b32 s10, s57, 1
    s_lshr_b32 s11, s57, 1
    s_add_u32 s91, s91, 1
    s_cmp_eq_u32 s91, 7
    s_cselect_b32 s67, -6, 1
    s_mul_i32 s68, s67, 172032
    s_lshl_b32 s67, s67, 7
    s_add_u32 s71, s71, s68
    s_add_u32 s70, s70, s67
    s_add_u32 m0, s76, 57344
    s_nop 0
    buffer_load_dwordx4 v116, s[24:27], s70 offen lds
    v_bfe_u32 v12, v0, 2, 2
    v_and_b32 v13, 3, v0
    v_lshlrev_b32 v13, 3, v13
    v_bfe_u32 v14, v0, 4, 1
    s_add_u32 m0, s80, 73728
    s_nop 0
    buffer_load_dwordx4 v120, s[28:31], s71 offen offset:0 lds
    v_lshl_or_b32 v13, v14, 5, v13
    s_mul_i32 s12, s11, 28672
    s_add_u32 s12, s12, 57344
    v_add_u32 v13, s12, v13
    buffer_load_dwordx4 v121, s[28:31], s71 offen offset:1024 lds
    v_lshrrev_b32 v14, 5, v0
    v_lshl_add_u32 v16, v14, 2, v12
    v_lshrrev_b32 v17, 1, v12
    v_xor_b32 v17, s11, v17
    s_add_u32 m0, s77, 57344
    s_nop 0
    buffer_load_dwordx4 v117, s[24:27], s70 offen lds
    v_lshl_add_u32 v17, v17, 6, v13
    v_lshl_add_u32 v240, v16, 7, v17
    v_xor_b32 v241, 64, v240
    v_mov_b32 v18, 0x1a0b1918
    s_add_u32 m0, s81, 73728
    s_nop 0
    buffer_load_dwordx4 v122, s[28:31], s71 offen offset:0 lds
    v_mov_b32 v19, 0x180f1b1a
    v_lshlrev_b32 v16, 3, v16
    v_lshrrev_b64 v[16:17], v16, v[18:19]
    v_and_b32 v16, 255, v16
    buffer_load_dwordx4 v123, s[28:31], s71 offen offset:1024 lds
    v_bfe_u32 v17, v16, 1, 1
    v_xor_b32 v17, s11, v17
    v_lshl_add_u32 v17, v17, 6, v13
    v_lshl_add_u32 v242, v16, 7, v17
    s_add_u32 m0, s78, 57344
    s_nop 0
    buffer_load_dwordx4 v118, s[24:27], s70 offen lds
    v_xor_b32 v243, 64, v242
    s_lshl_b32 s12, s57, 12
    s_add_u32 s12, s12, 131072
    v_add_u32 v244, s12, v1
    s_add_u32 m0, s82, 73728
    s_nop 0
    buffer_load_dwordx4 v124, s[28:31], s71 offen offset:0 lds
    s_xor_b32 s12, s57, 2
    s_lshl_b32 s12, s12, 12
    s_add_u32 s12, s12, 131072
    v_add_u32 v245, s12, v1
    buffer_load_dwordx4 v125, s[28:31], s71 offen offset:1024 lds
    v_and_b32 v12, 31, v0
    v_bfe_u32 v13, v12, 1, 2
    v_lshlrev_b32 v13, 4, v13
    v_lshl_or_b32 v13, v14, 3, v13
    s_add_u32 m0, s79, 57344
    s_nop 0
    buffer_load_dwordx4 v119, s[24:27], s70 offen lds
    v_lshl_or_b32 v13, v12, 6, v13
    v_add_u32 v252, s12, v13
    v_lshrrev_b32 v12, 2, v0
    v_bfe_u32 v14, v0, 3, 2
    s_waitcnt vmcnt(10)
    s_barrier
    s_add_u32 m0, s83, 73728
    s_nop 0
    buffer_load_dwordx4 v126, s[28:31], s71 offen offset:0 lds
    v_xor_b32 v14, v14, v0
    v_and_b32 v14, 3, v14
    v_and_b32 v13, 19, v12
    v_bfe_u32 v16, v12, 2, 1
    buffer_load_dwordx4 v127, s[28:31], s71 offen offset:1024 lds
    v_lshl_or_b32 v13, v16, 3, v13
    v_bfe_u32 v16, v12, 3, 1
    v_lshl_or_b32 v12, v16, 2, v13
    v_mul_u32_u24 v12, 1792, v12
    s_mov_b32 s73, 0
    s_add_u32 s67, s73, 0
    s_and_b32 s67, s67, 3
    s_lshl2_add_u32 s80, s67, s57
    s_lshl_b32 s80, s80, 11
    s_cmp_eq_u32 s67, s74
    s_cselect_b32 s67, 0x800000, s67
    s_lshl_b32 s67, s67, 7
    v_add_u32 v120, s67, v113
    v_add_u32 v121, 20480, v120
    s_add_u32 s67, s73, 1
    s_and_b32 s67, s67, 3
    s_lshl2_add_u32 s81, s67, s57
    s_lshl_b32 s81, s81, 11
    s_cmp_eq_u32 s67, s74
    s_cselect_b32 s67, 0x800000, s67
    s_lshl_b32 s67, s67, 7
    v_add_u32 v122, s67, v113
    v_add_u32 v123, 20480, v122
    s_add_u32 s67, s73, 2
    s_and_b32 s67, s67, 3
    s_lshl2_add_u32 s82, s67, s57
    s_lshl_b32 s82, s82, 11
    s_cmp_eq_u32 s67, s74
    s_cselect_b32 s67, 0x800000, s67
    s_lshl_b32 s67, s67, 7
    v_add_u32 v124, s67, v113
    v_add_u32 v125, 20480, v124
    s_add_u32 s67, s73, 3
    s_and_b32 s67, s67, 3
    s_lshl2_add_u32 s83, s67, s57
    s_lshl_b32 s83, s83, 11
    s_cmp_eq_u32 s67, s74
    s_cselect_b32 s67, 0x800000, s67
    s_lshl_b32 s67, s67, 7
    v_add_u32 v126, s67, v113
    v_add_u32 v127, 20480, v126
    s_add_u32 s91, s91, 1
    s_cmp_eq_u32 s91, 7
    s_cselect_b32 s67, -6, 1
    s_mul_i32 s68, s67, 172032
    s_lshl_b32 s67, s67, 7
    s_add_u32 s71, s71, s68
    s_add_u32 s70, s70, s67
    s_add_u32 m0, s76, 110592
    s_nop 0
    buffer_load_dwordx4 v116, s[24:27], s70 offen lds
    v_lshl_add_u32 v246, v14, 4, v12
    s_lshl1_add_u32 s12, s66, s10
    s_mul_i32 s84, s12, 57344
    s_lshl_b32 s13, s65, 7
    s_add_u32 m0, s77, 110592
    s_nop 0
    buffer_load_dwordx4 v117, s[24:27], s70 offen lds
    s_add_u32 s84, s84, s13
    s_lshl_b32 s13, s11, 6
    s_add_u32 s84, s84, s13
    s_add_u32 s84, s84, 0
    s_add_u32 m0, s78, 110592
    s_nop 0
    buffer_load_dwordx4 v118, s[24:27], s70 offen lds
    s_lshl1_add_u32 s3, s12, s11
    s_lshl_b32 s85, s3, 14
    s_add_u32 s85, s85, 8388608
    s_lshl_b32 s3, s3, 10
    s_add_u32 m0, s79, 110592
    s_nop 0
    buffer_load_dwordx4 v119, s[24:27], s70 offen lds
    s_add_u32 s3, s3, 196608
    v_lshlrev_b32 v247, 7, v0
    v_add_u32 v247, s3, v247
    v_mov_b64 v[16:17], 0
    s_add_u32 m0, s80, 126976
    s_nop 0
    buffer_load_dwordx4 v120, s[28:31], s71 offen offset:0 lds
    v_mov_b64 v[18:19], 0
    v_mov_b64 v[20:21], 0
    v_mov_b64 v[22:23], 0
    v_mov_b64 v[24:25], 0
    buffer_load_dwordx4 v121, s[28:31], s71 offen offset:1024 lds
    v_mov_b64 v[26:27], 0
    v_mov_b64 v[28:29], 0
    v_mov_b64 v[30:31], 0
    v_mov_b64 v[32:33], 0
    s_add_u32 m0, s81, 126976
    s_nop 0
    buffer_load_dwordx4 v122, s[28:31], s71 offen offset:0 lds
    v_mov_b64 v[34:35], 0
    v_mov_b64 v[36:37], 0
    v_mov_b64 v[38:39], 0
    v_mov_b64 v[40:41], 0
    buffer_load_dwordx4 v123, s[28:31], s71 offen offset:1024 lds
    v_mov_b64 v[42:43], 0
    v_mov_b64 v[44:45], 0
    v_mov_b64 v[46:47], 0
    v_mov_b64 v[48:49], 0
    s_add_u32 m0, s82, 126976
    s_nop 0
    buffer_load_dwordx4 v124, s[28:31], s71 offen offset:0 lds
    v_mov_b64 v[50:51], 0
    v_mov_b64 v[52:53], 0
    v_mov_b64 v[54:55], 0
    v_mov_b64 v[56:57], 0
    buffer_load_dwordx4 v125, s[28:31], s71 offen offset:1024 lds
    v_mov_b64 v[58:59], 0
    v_mov_b64 v[60:61], 0
    v_mov_b64 v[62:63], 0
    v_mov_b64 v[64:65], 0
    s_waitcnt vmcnt(10)
    s_barrier
    s_mov_b32 s75, s71
    s_add_u32 s91, s91, 1
    s_cmp_eq_u32 s91, 7
    s_cselect_b32 s67, -6, 1
    s_mul_i32 s68, s67, 172032
    s_lshl_b32 s67, s67, 7
    s_add_u32 s71, s71, s68
    s_add_u32 s70, s70, s67
    s_add_u32 m0, s76, 4096
    s_nop 0
    buffer_load_dwordx4 v116, s[24:27], s70 offen lds
    v_mov_b64 v[66:67], 0
    v_mov_b64 v[68:69], 0
    v_mov_b64 v[70:71], 0
    v_mov_b64 v[72:73], 0
    s_add_u32 m0, s77, 4096
    s_nop 0
    buffer_load_dwordx4 v117, s[24:27], s70 offen lds
    v_mov_b64 v[74:75], 0
    v_mov_b64 v[76:77], 0
    v_mov_b64 v[78:79], 0
    s_add_u32 m0, s78, 4096
    s_nop 0
    buffer_load_dwordx4 v118, s[24:27], s70 offen lds
    s_add_u32 m0, s79, 4096
    s_nop 0
    buffer_load_dwordx4 v119, s[24:27], s70 offen lds
    s_add_u32 m0, s80, 20480
    s_nop 0
    buffer_load_dwordx4 v120, s[28:31], s71 offen offset:0 lds
    buffer_load_dwordx4 v121, s[28:31], s71 offen offset:1024 lds
    s_add_u32 m0, s81, 20480
    s_nop 0
    buffer_load_dwordx4 v122, s[28:31], s71 offen offset:0 lds
    buffer_load_dwordx4 v123, s[28:31], s71 offen offset:1024 lds
    s_add_u32 m0, s82, 20480
    s_nop 0
    buffer_load_dwordx4 v124, s[28:31], s71 offen offset:0 lds
    buffer_load_dwordx4 v125, s[28:31], s71 offen offset:1024 lds
    s_waitcnt vmcnt(10)
    s_barrier
    s_add_u32 m0, s83, 20480
    s_nop 0
    buffer_load_dwordx4 v126, s[28:31], s71 offen offset:0 lds
    buffer_load_dwordx4 v127, s[28:31], s71 offen offset:1024 lds
    s_add_u32 m0, s83, 126976
    s_nop 0
    buffer_load_dwordx4 v126, s[28:31], s75 offen offset:0 lds
    buffer_load_dwordx4 v127, s[28:31], s75 offen offset:1024 lds
    buffer_load_dwordx4 v[248:251], off, s[36:39], 0 sc1
    s_waitcnt vmcnt(7)
    s_barrier
    s_waitcnt vmcnt(5)
    s_barrier
    s_mov_b32 s90, 0x40000
L_tagwaitA:
    s_waitcnt vmcnt(0)
    v_and_b32 v134, v248, v249
    v_bitop3_b32 v134, v134, v250, v251 bitop3:0x80
    v_and_b32 v134, 1, v134
    v_cmp_ne_u32 vcc, 1, v134
    s_cbranch_vccz L_tagokA
    buffer_load_dwordx4 v[248:251], off, s[36:39], 0 sc1
    s_sub_u32 s90, s90, 1
    s_cbranch_scc0 L_tagwaitA
    s_waitcnt vmcnt(0)
L_tagokA:
    s_barrier
    s_lshl2_add_u32 s70, s63, s57
    s_lshl_b32 s70, s70, 16
    s_add_u32 s70, s70, 4194304
    s_lshl4_add_u32 s71, s63, s64
    s_lshl2_add_u32 s71, s71, s57
    s_lshl_b32 s71, s71, 11
    s_add_u32 s71, s71, 1048576
    s_mov_b32 s77, 0xc2c00000
    s_mov_b32 s78, 0x3e8b97f6
    s_mov_b32 s79, 0xffff0000
    v_and_b32 v12, 3, v0
    v_lshlrev_b32 v12, 4, v12
    v_lshrrev_b64 v[12:13], v12, v[248:249]
    v_lshlrev_b32 v253, 16, v12
    s_mov_b32 s86, 0x07060302
    s_mov_b32 s87, 0x07060100
    v_mov_b32 v15, 1
    s_waitcnt lgkmcnt(0)
    s_barrier
L_ldE:
    s_setprio 1
    s_mov_b64 exec, 511
    s_mov_b32 s90, 0x40000
L_poll_1:
    buffer_load_dwordx2 v[12:13], v3, s[32:35], 0 offen sc1
    s_waitcnt vmcnt(0)
    v_cmp_ne_u64 vcc, v[248:249], v[12:13]
    s_cbranch_vccz L_polld_2
    s_mov_b64 exec, vcc
    s_sleep 1
    s_sub_u32 s90, s90, 1
    s_cbranch_scc0 L_poll_1
L_polld_2:
    s_mov_b64 exec, -1
    buffer_load_dwordx4 v[104:107], v1, s[32:35], s71 offen offset:0 sc1
    buffer_load_dwordx4 v[108:111], v1, s[32:35], s71 offen offset:1024 sc1
    buffer_load_dwordx4 v[112:115], v1, s[32:35], s70 offen offset:0 sc1
    buffer_load_dwordx4 v[116:119], v1, s[32:35], s70 offen offset:1024 sc1
    buffer_load_dwordx4 v[120:123], v1, s[32:35], s70 offen offset:2048 sc1
    buffer_load_dwordx4 v[124:127], v1, s[32:35], s70 offen offset:3072 sc1
    s_add_u32 s70, s70, 4096
    buffer_load_dwordx4 v[128:131], v1, s[32:35], s70 offen offset:0 sc1
    buffer_load_dwordx4 v[132:135], v1, s[32:35], s70 offen offset:1024 sc1
    buffer_load_dwordx4 v[136:139], v1, s[32:35], s70 offen offset:2048 sc1
    buffer_load_dwordx4 v[140:143], v1, s[32:35], s70 offen offset:3072 sc1
    s_add_u32 s70, s70, 4096
    s_waitcnt vmcnt(6)
    v_mfma_f32_32x32x16_bf16 v[192:207], v[112:115], v[104:107], 0
    v_mfma_f32_32x32x16_bf16 v[192:207], v[116:119], v[108:111], v[192:207]
    v_lshlrev_b32 v208, 16, v104
    v_and_b32 v209, s79, v104
    v_lshlrev_b32 v210, 16, v105
    v_and_b32 v211, s79, v105
    v_lshlrev_b32 v212, 16, v106
    v_and_b32 v213, s79, v106
    v_lshlrev_b32 v214, 16, v107
    v_and_b32 v215, s79, v107
    v_mul_f32 v208, s78, v208
    v_mul_f32 v209, s78, v209
    v_mul_f32 v210, s78, v210
    v_mul_f32 v211, s78, v211
    v_mul_f32 v212, s78, v212
    v_mul_f32 v213, s78, v213
    v_mul_f32 v214, s78, v214
    v_mul_f32_e64 v215, s78, v215
    v_cvt_pk_bf16_f32 v104, v208, v209
    v_cvt_pk_bf16_f32 v105, v210, v211
    v_cvt_pk_bf16_f32 v106, v212, v213
    v_cvt_pk_bf16_f32 v107, v214, v215
    ds_write_b128 v11, v[104:107]
    v_lshlrev_b32 v216, 16, v108
    v_and_b32 v217, s79, v108
    v_lshlrev_b32 v218, 16, v109
    v_and_b32 v219, s79, v109
    v_lshlrev_b32 v220, 16, v110
    v_and_b32 v221, s79, v110
    v_lshlrev_b32 v222, 16, v111
    v_and_b32 v223, s79, v111
    v_mul_f32 v216, s78, v216
    v_mul_f32 v217, s78, v217
    v_mul_f32 v218, s78, v218
    v_mul_f32 v219, s78, v219
    v_mul_f32 v220, s78, v220
    v_mul_f32 v221, s78, v221
    v_mul_f32 v222, s78, v222
    v_mul_f32 v223, s78, v223
    v_cvt_pk_bf16_f32 v108, v216, v217
    v_cvt_pk_bf16_f32 v109, v218, v219
    v_cvt_pk_bf16_f32 v110, v220, v221
    v_cvt_pk_bf16_f32 v111, v222, v223
    v_max3_f32 v12, v192, v193, v194
    v_max3_f32 v13, v195, v196, v197
    v_max3_f32 v12, v12, v198, v199
    v_max3_f32 v13, v13, v200, v201
    v_max3_f32 v12, v12, v202, v203
    v_max3_f32 v13, v13, v204, v205
    v_max3_f32 v12, v12, v206, v207
    v_max_f32 v12, v12, v13
    v_mov_b32 v13, v12
    s_nop 1
    v_permlane32_swap_b32 v12, v13
    s_mov_b32 exec_lo, 0
    v_max_f32 v12, v12, v13
    v_mul_f32 v12, s78, v12
    v_cvt_pk_bf16_f32 v110, -v12, s77
    s_mov_b32 exec_lo, -1
    ds_write_b128 v11, v[108:111] offset:1024
    buffer_load_dwordx4 v[144:147], v1, s[32:35], s70 offen offset:0 sc1
    buffer_load_dwordx4 v[148:151], v1, s[32:35], s70 offen offset:1024 sc1
    buffer_load_dwordx4 v[152:155], v1, s[32:35], s70 offen offset:2048 sc1
    buffer_load_dwordx4 v[156:159], v1, s[32:35], s70 offen offset:3072 sc1
    s_add_u32 s70, s70, 4096
    buffer_load_dwordx4 v[160:163], v1, s[32:35], s70 offen offset:0 sc1
    buffer_load_dwordx4 v[164:167], v1, s[32:35], s70 offen offset:1024 sc1
    buffer_load_dwordx4 v[168:171], v1, s[32:35], s70 offen offset:2048 sc1
    buffer_load_dwordx4 v[172:175], v1, s[32:35], s70 offen offset:3072 sc1
    s_add_u32 s70, s70, 4096
    s_waitcnt lgkmcnt(0)
    s_barrier
    ds_read_b128 v[80:83], v8 offset:0
    ds_read_b128 v[84:87], v8 offset:1024
    ds_read_b128 v[88:91], v9 offset:0
    ds_read_b128 v[92:95], v9 offset:1024
    ds_read_b128 v[96:99], v10 offset:0
    ds_read_b128 v[100:103], v10 offset:1024
    ds_write_b32 v6, v16 offset:3072
    s_waitcnt lgkmcnt(5)
    v_mfma_f32_32x32x16_bf16 v[192:207], v[112:115], v[80:83], 0
    v_mfma_f32_32x32x16_bf16 v[192:207], v[116:119], v[84:87], v[192:207]
    s_waitcnt lgkmcnt(3)
    v_mfma_f32_32x32x16_bf16 v[208:223], v[112:115], v[88:91], 0
    v_mfma_f32_32x32x16_bf16 v[208:223], v[116:119], v[92:95], v[208:223]
    s_waitcnt vmcnt(12) lgkmcnt(0)
    s_barrier
    s_nop 5
    s_setprio 0
    v_exp_f32 v192, v192
    v_exp_f32 v193, v193
    buffer_load_dwordx4 v[176:179], v1, s[32:35], s70 offen offset:0 sc1
    buffer_load_dwordx4 v[180:183], v1, s[32:35], s70 offen offset:1024 sc1
    buffer_load_dwordx4 v[184:187], v1, s[32:35], s70 offen offset:2048 sc1
    buffer_load_dwordx4 v[188:191], v1, s[32:35], s70 offen offset:3072 sc1
    v_exp_f32 v194, v194
    v_exp_f32 v195, v195
    v_exp_f32 v196, v196
    v_exp_f32 v197, v197
    v_mfma_f32_32x32x16_bf16 v[224:239], v[112:115], v[96:99], 0
    v_exp_f32 v198, v198
    v_exp_f32 v199, v199
    v_exp_f32 v200, v200
    v_exp_f32 v201, v201
    v_smfmac_f32_32x32x32_bf16 v[16:31], v[120:123], v[192:199], v2
    v_exp_f32 v202, v202
    v_exp_f32 v203, v203
    v_exp_f32 v204, v204
    v_exp_f32 v205, v205
    v_mfma_f32_32x32x16_bf16 v[224:239], v[116:119], v[100:103], v[224:239]
    v_exp_f32 v206, v206
    v_exp_f32 v207, v207
    v_exp_f32 v208, v208
    v_exp_f32 v209, v209
    v_smfmac_f32_32x32x32_bf16 v[16:31], v[124:127], v[200:207], v2
    v_exp_f32 v210, v210
    v_exp_f32 v211, v211
    v_exp_f32 v212, v212
    v_exp_f32 v213, v213
    v_mfma_f32_32x32x16_bf16 v[192:207], v[112:115], v[104:107], 0
    v_exp_f32 v214, v214
    v_exp_f32 v215, v215
    v_exp_f32 v216, v216
    v_exp_f32 v217, v217
    v_smfmac_f32_32x32x32_bf16 v[32:47], v[120:123], v[208:215], v2
    v_exp_f32 v218, v218
    v_exp_f32 v219, v219
    v_exp_f32 v220, v220
    v_exp_f32 v221, v221
    v_mfma_f32_32x32x16_bf16 v[192:207], v[116:119], v[108:111], v[192:207]
    s_waitcnt vmcnt(12)
    v_exp_f32 v222, v222
    v_exp_f32 v223, v223
    v_exp_f32 v224, v224
    v_exp_f32 v225, v225
    v_smfmac_f32_32x32x32_bf16 v[32:47], v[124:127], v[216:223], v2
    v_exp_f32 v226, v226
    v_exp_f32 v227, v227
    v_exp_f32 v228, v228
    v_exp_f32 v229, v229
    v_mfma_f32_32x32x16_bf16 v[208:223], v[128:131], v[80:83], 0
    v_exp_f32 v230, v230
    v_exp_f32 v231, v231
    v_exp_f32 v232, v232
    v_exp_f32 v233, v233
    v_smfmac_f32_32x32x32_bf16 v[48:63], v[120:123], v[224:231], v2
    v_exp_f32 v234, v234
    v_exp_f32 v235, v235
    v_exp_f32 v236, v236
    v_exp_f32 v237, v237
    v_mfma_f32_32x32x16_bf16 v[208:223], v[132:135], v[84:87], v[208:223]
    v_exp_f32 v238, v238
    v_exp_f32 v239, v239
    v_exp_f32 v192, v192
    v_exp_f32 v193, v193
    v_smfmac_f32_32x32x32_bf16 v[48:63], v[124:127], v[232:239], v2
    v_exp_f32 v194, v194
    v_exp_f32 v195, v195
    v_exp_f32 v196, v196
    v_exp_f32 v197, v197
    v_mfma_f32_32x32x16_bf16 v[224:239], v[128:131], v[88:91], 0
    s_add_u32 s70, s70, 4096
    v_exp_f32 v198, v198
    v_exp_f32 v199, v199
    v_exp_f32 v200, v200
    v_exp_f32 v201, v201
    v_smfmac_f32_32x32x32_bf16 v[64:79], v[120:123], v[192:199], v2
    v_exp_f32 v202, v202
    v_exp_f32 v203, v203
    v_exp_f32 v204, v204
    v_exp_f32 v205, v205
    v_mfma_f32_32x32x16_bf16 v[224:239], v[132:135], v[92:95], v[224:239]
    v_exp_f32 v206, v206
    v_exp_f32 v207, v207
    v_exp_f32 v208, v208
    v_exp_f32_e64 v209, v209
    v_smfmac_f32_32x32x32_bf16 v[64:79], v[124:127], v[200:207], v2
    buffer_load_dwordx4 v[112:115], v1, s[32:35], s70 offen offset:0 sc1
    buffer_load_dwordx4 v[116:119], v1, s[32:35], s70 offen offset:1024 sc1
    buffer_load_dwordx4 v[120:123], v1, s[32:35], s70 offen offset:2048 sc1
    buffer_load_dwordx4 v[124:127], v1, s[32:35], s70 offen offset:3072 sc1
    v_exp_f32 v210, v210
    v_exp_f32 v211, v211
    v_exp_f32 v212, v212
    v_exp_f32 v213, v213
    v_mfma_f32_32x32x16_bf16 v[192:207], v[128:131], v[96:99], 0
    v_exp_f32 v214, v214
    v_exp_f32 v215, v215
    v_exp_f32 v216, v216
    v_exp_f32 v217, v217
    v_smfmac_f32_32x32x32_bf16 v[16:31], v[136:139], v[208:215], v2
    v_exp_f32 v218, v218
    v_exp_f32 v219, v219
    v_exp_f32 v220, v220
    v_exp_f32 v221, v221
    v_mfma_f32_32x32x16_bf16 v[192:207], v[132:135], v[100:103], v[192:207]
    v_exp_f32 v222, v222
    v_exp_f32 v223, v223
    v_exp_f32 v224, v224
    v_exp_f32 v225, v225
    v_smfmac_f32_32x32x32_bf16 v[16:31], v[140:143], v[216:223], v2
    v_exp_f32 v226, v226
    v_exp_f32 v227, v227
    v_exp_f32 v228, v228
    v_exp_f32 v229, v229
    v_mfma_f32_32x32x16_bf16 v[208:223], v[128:131], v[104:107], 0
    v_exp_f32 v230, v230
    v_exp_f32 v231, v231
    v_exp_f32 v232, v232
    v_exp_f32 v233, v233
    v_smfmac_f32_32x32x32_bf16 v[32:47], v[136:139], v[224:231], v2
    v_exp_f32 v234, v234
    v_exp_f32 v235, v235
    v_exp_f32 v236, v236
    v_exp_f32 v237, v237
    v_mfma_f32_32x32x16_bf16 v[208:223], v[132:135], v[108:111], v[208:223]
    s_waitcnt vmcnt(12)
    v_exp_f32 v238, v238
    v_exp_f32 v239, v239
    v_exp_f32 v192, v192
    v_exp_f32 v193, v193
    v_smfmac_f32_32x32x32_bf16 v[32:47], v[140:143], v[232:239], v2
    v_exp_f32 v194, v194
    v_exp_f32 v195, v195
    v_exp_f32 v196, v196
    v_exp_f32 v197, v197
    v_mfma_f32_32x32x16_bf16 v[224:239], v[144:147], v[80:83], 0
    v_exp_f32 v198, v198
    v_exp_f32 v199, v199
    v_exp_f32 v200, v200
    v_exp_f32 v201, v201
    v_smfmac_f32_32x32x32_bf16 v[48:63], v[136:139], v[192:199], v2
    v_exp_f32 v202, v202
    v_exp_f32 v203, v203
    v_exp_f32 v204, v204
    v_exp_f32 v205, v205
    v_mfma_f32_32x32x16_bf16 v[224:239], v[148:151], v[84:87], v[224:239]
    v_exp_f32 v206, v206
    v_exp_f32 v207, v207
    v_exp_f32 v208, v208
    v_exp_f32 v209, v209
    v_smfmac_f32_32x32x32_bf16 v[48:63], v[140:143], v[200:207], v2
    v_exp_f32 v210, v210
    v_exp_f32 v211, v211
    v_exp_f32 v212, v212
    v_exp_f32 v213, v213
    v_mfma_f32_32x32x16_bf16 v[192:207], v[144:147], v[88:91], 0
    s_add_u32 s70, s70, 4096
    v_exp_f32 v214, v214
    v_exp_f32 v215, v215
    v_exp_f32 v216, v216
    v_exp_f32 v217, v217
    v_smfmac_f32_32x32x32_bf16 v[64:79], v[136:139], v[208:215], v2
    v_exp_f32 v218, v218
    v_exp_f32 v219, v219
    v_exp_f32 v220, v220
    v_exp_f32 v221, v221
    v_mfma_f32_32x32x16_bf16 v[192:207], v[148:151], v[92:95], v[192:207]
    v_exp_f32 v222, v222
    v_exp_f32 v223, v223
    v_exp_f32 v224, v224
    v_exp_f32_e64 v225, v225
    v_smfmac_f32_32x32x32_bf16 v[64:79], v[140:143], v[216:223], v2
    buffer_load_dwordx4 v[128:131], v1, s[32:35], s70 offen offset:0 sc1
    buffer_load_dwordx4 v[132:135], v1, s[32:35], s70 offen offset:1024 sc1
    buffer_load_dwordx4 v[136:139], v1, s[32:35], s70 offen offset:2048 sc1
    buffer_load_dwordx4 v[140:143], v1, s[32:35], s70 offen offset:3072 sc1
    v_exp_f32 v226, v226
    v_exp_f32 v227, v227
    v_exp_f32 v228, v228
    v_exp_f32 v229, v229
    v_mfma_f32_32x32x16_bf16 v[208:223], v[144:147], v[96:99], 0
    v_exp_f32 v230, v230
    v_exp_f32 v231, v231
    v_exp_f32 v232, v232
    v_exp_f32 v233, v233
    v_smfmac_f32_32x32x32_bf16 v[16:31], v[152:155], v[224:231], v2
    v_exp_f32 v234, v234
    v_exp_f32 v235, v235
    v_exp_f32 v236, v236
    v_exp_f32 v237, v237
    v_mfma_f32_32x32x16_bf16 v[208:223], v[148:151], v[100:103], v[208:223]
    v_exp_f32 v238, v238
    v_exp_f32 v239, v239
    v_exp_f32 v192, v192
    v_exp_f32 v193, v193
    v_smfmac_f32_32x32x32_bf16 v[16:31], v[156:159], v[232:239], v2
    v_exp_f32 v194, v194
    v_exp_f32 v195, v195
    v_exp_f32 v196, v196
    v_exp_f32 v197, v197
    v_mfma_f32_32x32x16_bf16 v[224:239], v[144:147], v[104:107], 0
    v_exp_f32 v198, v198
    v_exp_f32 v199, v199
    v_exp_f32 v200, v200
    v_exp_f32 v201, v201
    v_smfmac_f32_32x32x32_bf16 v[32:47], v[152:155], v[192:199], v2
    v_exp_f32 v202, v202
    v_exp_f32 v203, v203
    v_exp_f32 v204, v204
    v_exp_f32 v205, v205
    v_mfma_f32_32x32x16_bf16 v[224:239], v[148:151], v[108:111], v[224:239]
    s_waitcnt vmcnt(12)
    v_exp_f32 v206, v206
    v_exp_f32 v207, v207
    v_exp_f32 v208, v208
    v_exp_f32 v209, v209
    v_smfmac_f32_32x32x32_bf16 v[32:47], v[156:159], v[200:207], v2
    v_exp_f32 v210, v210
    v_exp_f32 v211, v211
    v_exp_f32 v212, v212
    v_exp_f32 v213, v213
    v_mfma_f32_32x32x16_bf16 v[192:207], v[160:163], v[80:83], 0
    v_exp_f32 v214, v214
    v_exp_f32 v215, v215
    v_exp_f32 v216, v216
    v_exp_f32 v217, v217
    v_smfmac_f32_32x32x32_bf16 v[48:63], v[152:155], v[208:215], v2
    v_exp_f32 v218, v218
    v_exp_f32 v219, v219
    v_exp_f32 v220, v220
    v_exp_f32 v221, v221
    v_mfma_f32_32x32x16_bf16 v[192:207], v[164:167], v[84:87], v[192:207]
    v_exp_f32 v222, v222
    v_exp_f32 v223, v223
    v_exp_f32 v224, v224
    v_exp_f32 v225, v225
    v_smfmac_f32_32x32x32_bf16 v[48:63], v[156:159], v[216:223], v2
    v_exp_f32 v226, v226
    v_exp_f32 v227, v227
    v_exp_f32 v228, v228
    v_exp_f32 v229, v229
    v_mfma_f32_32x32x16_bf16 v[208:223], v[160:163], v[88:91], 0
    s_add_u32 s70, s70, 4096
    v_exp_f32 v230, v230
    v_exp_f32 v231, v231
    v_exp_f32 v232, v232
    v_exp_f32 v233, v233
    v_smfmac_f32_32x32x32_bf16 v[64:79], v[152:155], v[224:231], v2
    v_exp_f32 v234, v234
    v_exp_f32 v235, v235
    v_exp_f32 v236, v236
    v_exp_f32 v237, v237
    v_mfma_f32_32x32x16_bf16 v[208:223], v[164:167], v[92:95], v[208:223]
    v_exp_f32 v238, v238
    v_exp_f32 v239, v239
    v_exp_f32 v192, v192
    v_exp_f32_e64 v193, v193
    v_smfmac_f32_32x32x32_bf16 v[64:79], v[156:159], v[232:239], v2
    buffer_load_dwordx4 v[144:147], v1, s[32:35], s70 offen offset:0 sc1
    buffer_load_dwordx4 v[148:151], v1, s[32:35], s70 offen offset:1024 sc1
    buffer_load_dwordx4 v[152:155], v1, s[32:35], s70 offen offset:2048 sc1
    buffer_load_dwordx4 v[156:159], v1, s[32:35], s70 offen offset:3072 sc1
    v_exp_f32 v194, v194
    v_exp_f32 v195, v195
    v_exp_f32 v196, v196
    v_exp_f32 v197, v197
    v_mfma_f32_32x32x16_bf16 v[224:239], v[160:163], v[96:99], 0
    v_exp_f32 v198, v198
    v_exp_f32 v199, v199
    v_exp_f32 v200, v200
    v_exp_f32 v201, v201
    v_smfmac_f32_32x32x32_bf16 v[16:31], v[168:171], v[192:199], v2
    v_exp_f32 v202, v202
    v_exp_f32 v203, v203
    v_exp_f32 v204, v204
    v_exp_f32 v205, v205
    v_mfma_f32_32x32x16_bf16 v[224:239], v[164:167], v[100:103], v[224:239]
    v_exp_f32 v206, v206
    v_exp_f32 v207, v207
    v_exp_f32 v208, v208
    v_exp_f32 v209, v209
    v_smfmac_f32_32x32x32_bf16 v[16:31], v[172:175], v[200:207], v2
    v_exp_f32 v210, v210
    v_exp_f32 v211, v211
    v_exp_f32 v212, v212
    v_exp_f32 v213, v213
    v_mfma_f32_32x32x16_bf16 v[192:207], v[160:163], v[104:107], 0
    v_exp_f32 v214, v214
    v_exp_f32 v215, v215
    v_exp_f32 v216, v216
    v_exp_f32 v217, v217
    v_smfmac_f32_32x32x32_bf16 v[32:47], v[168:171], v[208:215], v2
    v_exp_f32 v218, v218
    v_exp_f32 v219, v219
    v_exp_f32 v220, v220
    v_exp_f32 v221, v221
    v_mfma_f32_32x32x16_bf16 v[192:207], v[164:167], v[108:111], v[192:207]
    s_waitcnt vmcnt(12)
    v_exp_f32 v222, v222
    v_exp_f32 v223, v223
    v_exp_f32 v224, v224
    v_exp_f32 v225, v225
    v_smfmac_f32_32x32x32_bf16 v[32:47], v[172:175], v[216:223], v2
    v_exp_f32 v226, v226
    v_exp_f32 v227, v227
    v_exp_f32 v228, v228
    v_exp_f32 v229, v229
    v_mfma_f32_32x32x16_bf16 v[208:223], v[176:179], v[80:83], 0
    v_exp_f32 v230, v230
    v_exp_f32 v231, v231
    v_exp_f32 v232, v232
    v_exp_f32 v233, v233
    v_smfmac_f32_32x32x32_bf16 v[48:63], v[168:171], v[224:231], v2
    v_exp_f32 v234, v234
    v_exp_f32 v235, v235
    v_exp_f32 v236, v236
    v_exp_f32 v237, v237
    v_mfma_f32_32x32x16_bf16 v[208:223], v[180:183], v[84:87], v[208:223]
    v_exp_f32 v238, v238
    v_exp_f32 v239, v239
    v_exp_f32 v192, v192
    v_exp_f32 v193, v193
    v_smfmac_f32_32x32x32_bf16 v[48:63], v[172:175], v[232:239], v2
    v_exp_f32 v194, v194
    v_exp_f32 v195, v195
    v_exp_f32 v196, v196
    v_exp_f32 v197, v197
    v_mfma_f32_32x32x16_bf16 v[224:239], v[176:179], v[88:91], 0
    s_add_u32 s70, s70, 4096
    v_exp_f32 v198, v198
    v_exp_f32 v199, v199
    v_exp_f32 v200, v200
    v_exp_f32 v201, v201
    v_smfmac_f32_32x32x32_bf16 v[64:79], v[168:171], v[192:199], v2
    v_exp_f32 v202, v202
    v_exp_f32 v203, v203
    v_exp_f32 v204, v204
    v_exp_f32 v205, v205
    v_mfma_f32_32x32x16_bf16 v[224:239], v[180:183], v[92:95], v[224:239]
    v_exp_f32 v206, v206
    v_exp_f32 v207, v207
    v_exp_f32 v208, v208
    v_exp_f32_e64 v209, v209
    v_smfmac_f32_32x32x32_bf16 v[64:79], v[172:175], v[200:207], v2
    buffer_load_dwordx4 v[160:163], v1, s[32:35], s70 offen offset:0 sc1
    buffer_load_dwordx4 v[164:167], v1, s[32:35], s70 offen offset:1024 sc1
    buffer_load_dwordx4 v[168:171], v1, s[32:35], s70 offen offset:2048 sc1
    buffer_load_dwordx4 v[172:175], v1, s[32:35], s70 offen offset:3072 sc1
    v_exp_f32 v210, v210
    v_exp_f32 v211, v211
    v_exp_f32 v212, v212
    v_exp_f32 v213, v213
    v_mfma_f32_32x32x16_bf16 v[192:207], v[176:179], v[96:99], 0
    v_exp_f32 v214, v214
    v_exp_f32 v215, v215
    v_exp_f32 v216, v216
    v_exp_f32 v217, v217
    v_smfmac_f32_32x32x32_bf16 v[16:31], v[184:187], v[208:215], v2
    v_exp_f32 v218, v218
    v_exp_f32 v219, v219
    v_exp_f32 v220, v220
    v_exp_f32 v221, v221
    v_mfma_f32_32x32x16_bf16 v[192:207], v[180:183], v[100:103], v[192:207]
    v_exp_f32 v222, v222
    v_exp_f32 v223, v223
    v_exp_f32 v224, v224
    v_exp_f32 v225, v225
    v_smfmac_f32_32x32x32_bf16 v[16:31], v[188:191], v[216:223], v2
    v_exp_f32 v226, v226
    v_exp_f32 v227, v227
    v_exp_f32 v228, v228
    v_exp_f32 v229, v229
    v_mfma_f32_32x32x16_bf16 v[208:223], v[176:179], v[104:107], 0
    v_exp_f32 v230, v230
    v_exp_f32 v231, v231
    v_exp_f32 v232, v232
    v_exp_f32 v233, v233
    v_smfmac_f32_32x32x32_bf16 v[32:47], v[184:187], v[224:231], v2
    v_exp_f32 v234, v234
    v_exp_f32 v235, v235
    v_exp_f32 v236, v236
    v_exp_f32 v237, v237
    v_mfma_f32_32x32x16_bf16 v[208:223], v[180:183], v[108:111], v[208:223]
    s_waitcnt vmcnt(12)
    v_exp_f32 v238, v238
    v_exp_f32 v239, v239
    v_exp_f32 v192, v192
    v_exp_f32 v193, v193
    v_smfmac_f32_32x32x32_bf16 v[32:47], v[188:191], v[232:239], v2
    v_exp_f32 v194, v194
    v_exp_f32 v195, v195
    v_exp_f32 v196, v196
    v_exp_f32 v197, v197
    v_mfma_f32_32x32x16_bf16 v[224:239], v[112:115], v[80:83], 0
    v_exp_f32 v198, v198
    v_exp_f32 v199, v199
    v_exp_f32 v200, v200
    v_exp_f32 v201, v201
    v_smfmac_f32_32x32x32_bf16 v[48:63], v[184:187], v[192:199], v2
    v_exp_f32 v202, v202
    v_exp_f32 v203, v203
    v_exp_f32 v204, v204
    v_exp_f32 v205, v205
    v_mfma_f32_32x32x16_bf16 v[224:239], v[116:119], v[84:87], v[224:239]
    v_exp_f32 v206, v206
    v_exp_f32 v207, v207
    v_exp_f32 v208, v208
    v_exp_f32 v209, v209
    v_smfmac_f32_32x32x32_bf16 v[48:63], v[188:191], v[200:207], v2
    v_exp_f32 v210, v210
    v_exp_f32 v211, v211
    v_exp_f32 v212, v212
    v_exp_f32 v213, v213
    v_mfma_f32_32x32x16_bf16 v[192:207], v[112:115], v[88:91], 0
    s_add_u32 s70, s70, 4096
    v_exp_f32 v214, v214
    v_exp_f32 v215, v215
    v_exp_f32 v216, v216
    v_exp_f32 v217, v217
    v_smfmac_f32_32x32x32_bf16 v[64:79], v[184:187], v[208:215], v2
    v_exp_f32 v218, v218
    v_exp_f32 v219, v219
    v_exp_f32 v220, v220
    v_exp_f32 v221, v221
    v_mfma_f32_32x32x16_bf16 v[192:207], v[116:119], v[92:95], v[192:207]
    v_exp_f32 v222, v222
    v_exp_f32 v223, v223
    v_exp_f32 v224, v224
    v_exp_f32_e64 v225, v225
    v_smfmac_f32_32x32x32_bf16 v[64:79], v[188:191], v[216:223], v2
    buffer_load_dwordx4 v[176:179], v1, s[32:35], s70 offen offset:0 sc1
    buffer_load_dwordx4 v[180:183], v1, s[32:35], s70 offen offset:1024 sc1
    buffer_load_dwordx4 v[184:187], v1, s[32:35], s70 offen offset:2048 sc1
    buffer_load_dwordx4 v[188:191], v1, s[32:35], s70 offen offset:3072 sc1
    v_exp_f32 v226, v226
    v_exp_f32 v227, v227
    v_exp_f32 v228, v228
    v_exp_f32 v229, v229
    v_mfma_f32_32x32x16_bf16 v[208:223], v[112:115], v[96:99], 0
    v_exp_f32 v230, v230
    v_exp_f32 v231, v231
    v_exp_f32 v232, v232
    v_exp_f32 v233, v233
    v_smfmac_f32_32x32x32_bf16 v[16:31], v[120:123], v[224:231], v2
    v_exp_f32 v234, v234
    v_exp_f32 v235, v235
    v_exp_f32 v236, v236
    v_exp_f32 v237, v237
    v_mfma_f32_32x32x16_bf16 v[208:223], v[116:119], v[100:103], v[208:223]
    v_exp_f32 v238, v238
    v_exp_f32 v239, v239
    v_exp_f32 v192, v192
    v_exp_f32 v193, v193
    v_smfmac_f32_32x32x32_bf16 v[16:31], v[124:127], v[232:239], v2
    v_exp_f32 v194, v194
    v_exp_f32 v195, v195
    v_exp_f32 v196, v196
    v_exp_f32 v197, v197
    v_mfma_f32_32x32x16_bf16 v[224:239], v[112:115], v[104:107], 0
    v_exp_f32 v198, v198
    v_exp_f32 v199, v199
    v_exp_f32 v200, v200
    v_exp_f32 v201, v201
    v_smfmac_f32_32x32x32_bf16 v[32:47], v[120:123], v[192:199], v2
    v_exp_f32 v202, v202
    v_exp_f32 v203, v203
    v_exp_f32 v204, v204
    v_exp_f32 v205, v205
    v_mfma_f32_32x32x16_bf16 v[224:239], v[116:119], v[108:111], v[224:239]
    s_waitcnt vmcnt(12)
    v_exp_f32 v206, v206
    v_exp_f32 v207, v207
    v_exp_f32 v208, v208
    v_exp_f32 v209, v209
    v_smfmac_f32_32x32x32_bf16 v[32:47], v[124:127], v[200:207], v2
    v_exp_f32 v210, v210
    v_exp_f32 v211, v211
    v_exp_f32 v212, v212
    v_exp_f32 v213, v213
    v_mfma_f32_32x32x16_bf16 v[192:207], v[128:131], v[80:83], 0
    v_exp_f32 v214, v214
    v_exp_f32 v215, v215
    v_exp_f32 v216, v216
    v_exp_f32 v217, v217
    v_smfmac_f32_32x32x32_bf16 v[48:63], v[120:123], v[208:215], v2
    v_exp_f32 v218, v218
    v_exp_f32 v219, v219
    v_exp_f32 v220, v220
    v_exp_f32 v221, v221
    v_mfma_f32_32x32x16_bf16 v[192:207], v[132:135], v[84:87], v[192:207]
    v_exp_f32 v222, v222
    v_exp_f32 v223, v223
    v_exp_f32 v224, v224
    v_exp_f32 v225, v225
    v_smfmac_f32_32x32x32_bf16 v[48:63], v[124:127], v[216:223], v2
    v_exp_f32 v226, v226
    v_exp_f32 v227, v227
    v_exp_f32 v228, v228
    v_exp_f32 v229, v229
    v_mfma_f32_32x32x16_bf16 v[208:223], v[128:131], v[88:91], 0
    s_add_u32 s70, s70, 4096
    v_exp_f32 v230, v230
    v_exp_f32 v231, v231
    v_exp_f32 v232, v232
    v_exp_f32 v233, v233
    v_smfmac_f32_32x32x32_bf16 v[64:79], v[120:123], v[224:231], v2
    v_exp_f32 v234, v234
    v_exp_f32 v235, v235
    v_exp_f32 v236, v236
    v_exp_f32 v237, v237
    v_mfma_f32_32x32x16_bf16 v[208:223], v[132:135], v[92:95], v[208:223]
    v_exp_f32 v238, v238
    v_exp_f32 v239, v239
    v_exp_f32 v192, v192
    v_exp_f32_e64 v193, v193
    v_smfmac_f32_32x32x32_bf16 v[64:79], v[124:127], v[232:239], v2
    buffer_load_dwordx4 v[112:115], v1, s[32:35], s70 offen offset:0 sc1
    buffer_load_dwordx4 v[116:119], v1, s[32:35], s70 offen offset:1024 sc1
    buffer_load_dwordx4 v[120:123], v1, s[32:35], s70 offen offset:2048 sc1
    buffer_load_dwordx4 v[124:127], v1, s[32:35], s70 offen offset:3072 sc1
    v_exp_f32 v194, v194
    v_exp_f32 v195, v195
    v_exp_f32 v196, v196
    v_exp_f32 v197, v197
    v_mfma_f32_32x32x16_bf16 v[224:239], v[128:131], v[96:99], 0
    v_exp_f32 v198, v198
    v_exp_f32 v199, v199
    v_exp_f32 v200, v200
    v_exp_f32 v201, v201
    v_smfmac_f32_32x32x32_bf16 v[16:31], v[136:139], v[192:199], v2
    v_exp_f32 v202, v202
    v_exp_f32 v203, v203
    v_exp_f32 v204, v204
    v_exp_f32 v205, v205
    v_mfma_f32_32x32x16_bf16 v[224:239], v[132:135], v[100:103], v[224:239]
    v_exp_f32 v206, v206
    v_exp_f32 v207, v207
    v_exp_f32 v208, v208
    v_exp_f32 v209, v209
    v_smfmac_f32_32x32x32_bf16 v[16:31], v[140:143], v[200:207], v2
    v_exp_f32 v210, v210
    v_exp_f32 v211, v211
    v_exp_f32 v212, v212
    v_exp_f32 v213, v213
    v_mfma_f32_32x32x16_bf16 v[192:207], v[128:131], v[104:107], 0
    v_exp_f32 v214, v214
    v_exp_f32 v215, v215
    v_exp_f32 v216, v216
    v_exp_f32 v217, v217
    v_smfmac_f32_32x32x32_bf16 v[32:47], v[136:139], v[208:215], v2
    v_exp_f32 v218, v218
    v_exp_f32 v219, v219
    v_exp_f32 v220, v220
    v_exp_f32 v221, v221
    v_mfma_f32_32x32x16_bf16 v[192:207], v[132:135], v[108:111], v[192:207]
    s_waitcnt vmcnt(12)
    v_exp_f32 v222, v222
    v_exp_f32 v223, v223
    v_exp_f32 v224, v224
    v_exp_f32 v225, v225
    v_smfmac_f32_32x32x32_bf16 v[32:47], v[140:143], v[216:223], v2
    v_exp_f32 v226, v226
    v_exp_f32 v227, v227
    v_exp_f32 v228, v228
    v_exp_f32 v229, v229
    v_mfma_f32_32x32x16_bf16 v[208:223], v[144:147], v[80:83], 0
    v_exp_f32 v230, v230
    v_exp_f32 v231, v231
    v_exp_f32 v232, v232
    v_exp_f32 v233, v233
    v_smfmac_f32_32x32x32_bf16 v[48:63], v[136:139], v[224:231], v2
    v_exp_f32 v234, v234
    v_exp_f32 v235, v235
    v_exp_f32 v236, v236
    v_exp_f32 v237, v237
    v_mfma_f32_32x32x16_bf16 v[208:223], v[148:151], v[84:87], v[208:223]
    v_exp_f32 v238, v238
    v_exp_f32 v239, v239
    v_exp_f32 v192, v192
    v_exp_f32 v193, v193
    v_smfmac_f32_32x32x32_bf16 v[48:63], v[140:143], v[232:239], v2
    v_exp_f32 v194, v194
    v_exp_f32 v195, v195
    v_exp_f32 v196, v196
    v_exp_f32 v197, v197
    v_mfma_f32_32x32x16_bf16 v[224:239], v[144:147], v[88:91], 0
    s_add_u32 s70, s70, 4096
    v_exp_f32 v198, v198
    v_exp_f32 v199, v199
    v_exp_f32 v200, v200
    v_exp_f32 v201, v201
    v_smfmac_f32_32x32x32_bf16 v[64:79], v[136:139], v[192:199], v2
    v_exp_f32 v202, v202
    v_exp_f32 v203, v203
    v_exp_f32 v204, v204
    v_exp_f32 v205, v205
    v_mfma_f32_32x32x16_bf16 v[224:239], v[148:151], v[92:95], v[224:239]
    v_exp_f32 v206, v206
    v_exp_f32 v207, v207
    v_exp_f32 v208, v208
    v_exp_f32_e64 v209, v209
    v_smfmac_f32_32x32x32_bf16 v[64:79], v[140:143], v[200:207], v2
    buffer_load_dwordx4 v[128:131], v1, s[32:35], s70 offen offset:0 sc1
    buffer_load_dwordx4 v[132:135], v1, s[32:35], s70 offen offset:1024 sc1
    buffer_load_dwordx4 v[136:139], v1, s[32:35], s70 offen offset:2048 sc1
    buffer_load_dwordx4 v[140:143], v1, s[32:35], s70 offen offset:3072 sc1
    v_exp_f32 v210, v210
    v_exp_f32 v211, v211
    v_exp_f32 v212, v212
    v_exp_f32 v213, v213
    v_mfma_f32_32x32x16_bf16 v[192:207], v[144:147], v[96:99], 0
    v_exp_f32 v214, v214
    v_exp_f32 v215, v215
    v_exp_f32 v216, v216
    v_exp_f32 v217, v217
    v_smfmac_f32_32x32x32_bf16 v[16:31], v[152:155], v[208:215], v2
    v_exp_f32 v218, v218
    v_exp_f32 v219, v219
    v_exp_f32 v220, v220
    v_exp_f32 v221, v221
    v_mfma_f32_32x32x16_bf16 v[192:207], v[148:151], v[100:103], v[192:207]
    v_exp_f32 v222, v222
    v_exp_f32 v223, v223
    v_exp_f32 v224, v224
    v_exp_f32 v225, v225
    v_smfmac_f32_32x32x32_bf16 v[16:31], v[156:159], v[216:223], v2
    v_exp_f32 v226, v226
    v_exp_f32 v227, v227
    v_exp_f32 v228, v228
    v_exp_f32 v229, v229
    v_mfma_f32_32x32x16_bf16 v[208:223], v[144:147], v[104:107], 0
    v_exp_f32 v230, v230
    v_exp_f32 v231, v231
    v_exp_f32 v232, v232
    v_exp_f32 v233, v233
    v_smfmac_f32_32x32x32_bf16 v[32:47], v[152:155], v[224:231], v2
    v_exp_f32 v234, v234
    v_exp_f32 v235, v235
    v_exp_f32 v236, v236
    v_exp_f32 v237, v237
    v_mfma_f32_32x32x16_bf16 v[208:223], v[148:151], v[108:111], v[208:223]
    s_waitcnt vmcnt(12)
    v_exp_f32 v238, v238
    v_exp_f32 v239, v239
    v_exp_f32 v192, v192
    v_exp_f32 v193, v193
    v_smfmac_f32_32x32x32_bf16 v[32:47], v[156:159], v[232:239], v2
    v_exp_f32 v194, v194
    v_exp_f32 v195, v195
    v_exp_f32 v196, v196
    v_exp_f32 v197, v197
    v_mfma_f32_32x32x16_bf16 v[224:239], v[160:163], v[80:83], 0
    v_exp_f32 v198, v198
    v_exp_f32 v199, v199
    v_exp_f32 v200, v200
    v_exp_f32 v201, v201
    v_smfmac_f32_32x32x32_bf16 v[48:63], v[152:155], v[192:199], v2
    v_exp_f32 v202, v202
    v_exp_f32 v203, v203
    v_exp_f32 v204, v204
    v_exp_f32 v205, v205
    v_mfma_f32_32x32x16_bf16 v[224:239], v[164:167], v[84:87], v[224:239]
    v_exp_f32 v206, v206
    v_exp_f32 v207, v207
    v_exp_f32 v208, v208
    v_exp_f32 v209, v209
    v_smfmac_f32_32x32x32_bf16 v[48:63], v[156:159], v[200:207], v2
    v_exp_f32 v210, v210
    v_exp_f32 v211, v211
    v_exp_f32 v212, v212
    v_exp_f32 v213, v213
    v_mfma_f32_32x32x16_bf16 v[192:207], v[160:163], v[88:91], 0
    s_add_u32 s70, s70, 4096
    v_exp_f32 v214, v214
    v_exp_f32 v215, v215
    v_exp_f32 v216, v216
    v_exp_f32 v217, v217
    v_smfmac_f32_32x32x32_bf16 v[64:79], v[152:155], v[208:215], v2
    v_exp_f32 v218, v218
    v_exp_f32 v219, v219
    v_exp_f32 v220, v220
    v_exp_f32 v221, v221
    v_mfma_f32_32x32x16_bf16 v[192:207], v[164:167], v[92:95], v[192:207]
    v_exp_f32 v222, v222
    v_exp_f32 v223, v223
    v_exp_f32 v224, v224
    v_exp_f32_e64 v225, v225
    v_smfmac_f32_32x32x32_bf16 v[64:79], v[156:159], v[216:223], v2
    buffer_load_dwordx4 v[144:147], v1, s[32:35], s70 offen offset:0 sc1
    buffer_load_dwordx4 v[148:151], v1, s[32:35], s70 offen offset:1024 sc1
    buffer_load_dwordx4 v[152:155], v1, s[32:35], s70 offen offset:2048 sc1
    buffer_load_dwordx4 v[156:159], v1, s[32:35], s70 offen offset:3072 sc1
    v_exp_f32 v226, v226
    v_exp_f32 v227, v227
    v_exp_f32 v228, v228
    v_exp_f32 v229, v229
    v_mfma_f32_32x32x16_bf16 v[208:223], v[160:163], v[96:99], 0
    v_exp_f32 v230, v230
    v_exp_f32 v231, v231
    v_exp_f32 v232, v232
    v_exp_f32 v233, v233
    v_smfmac_f32_32x32x32_bf16 v[16:31], v[168:171], v[224:231], v2
    v_exp_f32 v234, v234
    v_exp_f32 v235, v235
    v_exp_f32 v236, v236
    v_exp_f32 v237, v237
    v_mfma_f32_32x32x16_bf16 v[208:223], v[164:167], v[100:103], v[208:223]
    v_exp_f32 v238, v238
    v_exp_f32 v239, v239
    v_exp_f32 v192, v192
    v_exp_f32 v193, v193
    v_smfmac_f32_32x32x32_bf16 v[16:31], v[172:175], v[232:239], v2
    v_exp_f32 v194, v194
    v_exp_f32 v195, v195
    v_exp_f32 v196, v196
    v_exp_f32 v197, v197
    v_mfma_f32_32x32x16_bf16 v[224:239], v[160:163], v[104:107], 0
    v_exp_f32 v198, v198
    v_exp_f32 v199, v199
    v_exp_f32 v200, v200
    v_exp_f32 v201, v201
    v_smfmac_f32_32x32x32_bf16 v[32:47], v[168:171], v[192:199], v2
    v_exp_f32 v202, v202
    v_exp_f32 v203, v203
    v_exp_f32 v204, v204
    v_exp_f32 v205, v205
    v_mfma_f32_32x32x16_bf16 v[224:239], v[164:167], v[108:111], v[224:239]
    s_waitcnt vmcnt(12)
    v_exp_f32 v206, v206
    v_exp_f32 v207, v207
    v_exp_f32 v208, v208
    v_exp_f32 v209, v209
    v_smfmac_f32_32x32x32_bf16 v[32:47], v[172:175], v[200:207], v2
    v_exp_f32 v210, v210
    v_exp_f32 v211, v211
    v_exp_f32 v212, v212
    v_exp_f32 v213, v213
    v_mfma_f32_32x32x16_bf16 v[192:207], v[176:179], v[80:83], 0
    v_exp_f32 v214, v214
    v_exp_f32 v215, v215
    v_exp_f32 v216, v216
    v_exp_f32 v217, v217
    v_smfmac_f32_32x32x32_bf16 v[48:63], v[168:171], v[208:215], v2
    v_exp_f32 v218, v218
    v_exp_f32 v219, v219
    v_exp_f32 v220, v220
    v_exp_f32 v221, v221
    v_mfma_f32_32x32x16_bf16 v[192:207], v[180:183], v[84:87], v[192:207]
    v_exp_f32 v222, v222
    v_exp_f32 v223, v223
    v_exp_f32 v224, v224
    v_exp_f32 v225, v225
    v_smfmac_f32_32x32x32_bf16 v[48:63], v[172:175], v[216:223], v2
    v_exp_f32 v226, v226
    v_exp_f32 v227, v227
    v_exp_f32 v228, v228
    v_exp_f32 v229, v229
    v_mfma_f32_32x32x16_bf16 v[208:223], v[176:179], v[88:91], 0
    s_add_u32 s70, s70, 4096
    v_exp_f32 v230, v230
    v_exp_f32 v231, v231
    v_exp_f32 v232, v232
    v_exp_f32 v233, v233
    v_smfmac_f32_32x32x32_bf16 v[64:79], v[168:171], v[224:231], v2
    v_exp_f32 v234, v234
    v_exp_f32 v235, v235
    v_exp_f32 v236, v236
    v_exp_f32 v237, v237
    v_mfma_f32_32x32x16_bf16 v[208:223], v[180:183], v[92:95], v[208:223]
    v_exp_f32 v238, v238
    v_exp_f32 v239, v239
    v_exp_f32 v192, v192
    v_exp_f32_e64 v193, v193
    v_smfmac_f32_32x32x32_bf16 v[64:79], v[172:175], v[232:239], v2
    buffer_load_dwordx4 v[160:163], v1, s[32:35], s70 offen offset:0 sc1
    buffer_load_dwordx4 v[164:167], v1, s[32:35], s70 offen offset:1024 sc1
    buffer_load_dwordx4 v[168:171], v1, s[32:35], s70 offen offset:2048 sc1
    buffer_load_dwordx4 v[172:175], v1, s[32:35], s70 offen offset:3072 sc1
    v_exp_f32 v194, v194
    v_exp_f32 v195, v195
    v_exp_f32 v196, v196
    v_exp_f32 v197, v197
    v_mfma_f32_32x32x16_bf16 v[224:239], v[176:179], v[96:99], 0
    v_exp_f32 v198, v198
    v_exp_f32 v199, v199
    v_exp_f32 v200, v200
    v_exp_f32 v201, v201
    v_smfmac_f32_32x32x32_bf16 v[16:31], v[184:187], v[192:199], v2
    v_exp_f32 v202, v202
    v_exp_f32 v203, v203
    v_exp_f32 v204, v204
    v_exp_f32 v205, v205
    v_mfma_f32_32x32x16_bf16 v[224:239], v[180:183], v[100:103], v[224:239]
    v_exp_f32 v206, v206
    v_exp_f32 v207, v207
    v_exp_f32 v208, v208
    v_exp_f32 v209, v209
    v_smfmac_f32_32x32x32_bf16 v[16:31], v[188:191], v[200:207], v2
    v_exp_f32 v210, v210
    v_exp_f32 v211, v211
    v_exp_f32 v212, v212
    v_exp_f32 v213, v213
    v_mfma_f32_32x32x16_bf16 v[192:207], v[176:179], v[104:107], 0
    v_exp_f32 v214, v214
    v_exp_f32 v215, v215
    v_exp_f32 v216, v216
    v_exp_f32 v217, v217
    v_smfmac_f32_32x32x32_bf16 v[32:47], v[184:187], v[208:215], v2
    v_exp_f32 v218, v218
    v_exp_f32 v219, v219
    v_exp_f32 v220, v220
    v_exp_f32 v221, v221
    v_mfma_f32_32x32x16_bf16 v[192:207], v[180:183], v[108:111], v[192:207]
    s_waitcnt vmcnt(12)
    v_exp_f32 v222, v222
    v_exp_f32 v223, v223
    v_exp_f32 v224, v224
    v_exp_f32 v225, v225
    v_smfmac_f32_32x32x32_bf16 v[32:47], v[188:191], v[216:223], v2
    v_exp_f32 v226, v226
    v_exp_f32 v227, v227
    v_exp_f32 v228, v228
    v_exp_f32 v229, v229
    v_mfma_f32_32x32x16_bf16 v[208:223], v[112:115], v[80:83], 0
    v_exp_f32 v230, v230
    v_exp_f32 v231, v231
    v_exp_f32 v232, v232
    v_exp_f32 v233, v233
    v_smfmac_f32_32x32x32_bf16 v[48:63], v[184:187], v[224:231], v2
    v_exp_f32 v234, v234
    v_exp_f32 v235, v235
    v_exp_f32 v236, v236
    v_exp_f32 v237, v237
    v_mfma_f32_32x32x16_bf16 v[208:223], v[116:119], v[84:87], v[208:223]
    v_exp_f32 v238, v238
    v_exp_f32 v239, v239
    v_exp_f32 v192, v192
    v_exp_f32 v193, v193
    v_smfmac_f32_32x32x32_bf16 v[48:63], v[188:191], v[232:239], v2
    v_exp_f32 v194, v194
    v_exp_f32 v195, v195
    v_exp_f32 v196, v196
    v_exp_f32 v197, v197
    v_mfma_f32_32x32x16_bf16 v[224:239], v[112:115], v[88:91], 0
    s_add_u32 s70, s70, 4096
    v_exp_f32 v198, v198
    v_exp_f32 v199, v199
    v_exp_f32 v200, v200
    v_exp_f32 v201, v201
    v_smfmac_f32_32x32x32_bf16 v[64:79], v[184:187], v[192:199], v2
    v_exp_f32 v202, v202
    v_exp_f32 v203, v203
    v_exp_f32 v204, v204
    v_exp_f32 v205, v205
    v_mfma_f32_32x32x16_bf16 v[224:239], v[116:119], v[92:95], v[224:239]
    v_exp_f32 v206, v206
    v_exp_f32 v207, v207
    v_exp_f32 v208, v208
    v_exp_f32_e64 v209, v209
    v_smfmac_f32_32x32x32_bf16 v[64:79], v[188:191], v[200:207], v2
    buffer_load_dwordx4 v[176:179], v1, s[32:35], s70 offen offset:0 sc1
    buffer_load_dwordx4 v[180:183], v1, s[32:35], s70 offen offset:1024 sc1
    buffer_load_dwordx4 v[184:187], v1, s[32:35], s70 offen offset:2048 sc1
    buffer_load_dwordx4 v[188:191], v1, s[32:35], s70 offen offset:3072 sc1
    v_exp_f32 v210, v210
    v_exp_f32 v211, v211
    v_exp_f32 v212, v212
    v_exp_f32 v213, v213
    v_mfma_f32_32x32x16_bf16 v[192:207], v[112:115], v[96:99], 0
    v_exp_f32 v214, v214
    v_exp_f32 v215, v215
    v_exp_f32 v216, v216
    v_exp_f32 v217, v217
    v_smfmac_f32_32x32x32_bf16 v[16:31], v[120:123], v[208:215], v2
    v_exp_f32 v218, v218
    v_exp_f32 v219, v219
    v_exp_f32 v220, v220
    v_exp_f32 v221, v221
    v_mfma_f32_32x32x16_bf16 v[192:207], v[116:119], v[100:103], v[192:207]
    v_exp_f32 v222, v222
    v_exp_f32 v223, v223
    v_exp_f32 v224, v224
    v_exp_f32 v225, v225
    v_smfmac_f32_32x32x32_bf16 v[16:31], v[124:127], v[216:223], v2
    v_exp_f32 v226, v226
    v_exp_f32 v227, v227
    v_exp_f32 v228, v228
    v_exp_f32 v229, v229
    v_mfma_f32_32x32x16_bf16 v[208:223], v[112:115], v[104:107], 0
    v_exp_f32 v230, v230
    v_exp_f32 v231, v231
    v_exp_f32 v232, v232
    v_exp_f32 v233, v233
    v_smfmac_f32_32x32x32_bf16 v[32:47], v[120:123], v[224:231], v2
    v_exp_f32 v234, v234
    v_exp_f32 v235, v235
    v_exp_f32 v236, v236
    v_exp_f32 v237, v237
    v_mfma_f32_32x32x16_bf16 v[208:223], v[116:119], v[108:111], v[208:223]
    s_waitcnt vmcnt(12)
    v_exp_f32 v238, v238
    v_exp_f32 v239, v239
    v_exp_f32 v192, v192
    v_exp_f32 v193, v193
    v_smfmac_f32_32x32x32_bf16 v[32:47], v[124:127], v[232:239], v2
    v_exp_f32 v194, v194
    v_exp_f32 v195, v195
    v_exp_f32 v196, v196
    v_exp_f32 v197, v197
    v_mfma_f32_32x32x16_bf16 v[224:239], v[128:131], v[80:83], 0
    v_exp_f32 v198, v198
    v_exp_f32 v199, v199
    v_exp_f32 v200, v200
    v_exp_f32 v201, v201
    v_smfmac_f32_32x32x32_bf16 v[48:63], v[120:123], v[192:199], v2
    v_exp_f32 v202, v202
    v_exp_f32 v203, v203
    v_exp_f32 v204, v204
    v_exp_f32 v205, v205
    v_mfma_f32_32x32x16_bf16 v[224:239], v[132:135], v[84:87], v[224:239]
    v_exp_f32 v206, v206
    v_exp_f32 v207, v207
    v_exp_f32 v208, v208
    v_exp_f32 v209, v209
    v_smfmac_f32_32x32x32_bf16 v[48:63], v[124:127], v[200:207], v2
    v_exp_f32 v210, v210
    v_exp_f32 v211, v211
    v_exp_f32 v212, v212
    v_exp_f32 v213, v213
    v_mfma_f32_32x32x16_bf16 v[192:207], v[128:131], v[88:91], 0
    s_add_u32 s70, s70, 4096
    v_exp_f32 v214, v214
    v_exp_f32 v215, v215
    v_exp_f32 v216, v216
    v_exp_f32 v217, v217
    v_smfmac_f32_32x32x32_bf16 v[64:79], v[120:123], v[208:215], v2
    v_exp_f32 v218, v218
    v_exp_f32 v219, v219
    v_exp_f32 v220, v220
    v_exp_f32 v221, v221
    v_mfma_f32_32x32x16_bf16 v[192:207], v[132:135], v[92:95], v[192:207]
    v_exp_f32 v222, v222
    v_exp_f32 v223, v223
    v_exp_f32 v224, v224
    v_exp_f32_e64 v225, v225
    v_smfmac_f32_32x32x32_bf16 v[64:79], v[124:127], v[216:223], v2
    buffer_load_dwordx4 v[112:115], v1, s[32:35], s70 offen offset:0 sc1
    buffer_load_dwordx4 v[116:119], v1, s[32:35], s70 offen offset:1024 sc1
    buffer_load_dwordx4 v[120:123], v1, s[32:35], s70 offen offset:2048 sc1
    buffer_load_dwordx4 v[124:127], v1, s[32:35], s70 offen offset:3072 sc1
    v_exp_f32 v226, v226
    v_exp_f32 v227, v227
    v_exp_f32 v228, v228
    v_exp_f32 v229, v229
    v_mfma_f32_32x32x16_bf16 v[208:223], v[128:131], v[96:99], 0
    v_exp_f32 v230, v230
    v_exp_f32 v231, v231
    v_exp_f32 v232, v232
    v_exp_f32 v233, v233
    v_smfmac_f32_32x32x32_bf16 v[16:31], v[136:139], v[224:231], v2
    v_exp_f32 v234, v234
    v_exp_f32 v235, v235
    v_exp_f32 v236, v236
    v_exp_f32 v237, v237
    v_mfma_f32_32x32x16_bf16 v[208:223], v[132:135], v[100:103], v[208:223]
    v_exp_f32 v238, v238
    v_exp_f32 v239, v239
    v_exp_f32 v192, v192
    v_exp_f32 v193, v193
    v_smfmac_f32_32x32x32_bf16 v[16:31], v[140:143], v[232:239], v2
    v_exp_f32 v194, v194
    v_exp_f32 v195, v195
    v_exp_f32 v196, v196
    v_exp_f32 v197, v197
    v_mfma_f32_32x32x16_bf16 v[224:239], v[128:131], v[104:107], 0
    ds_write_b32 v6, v15 offset:3072
    v_exp_f32 v198, v198
    v_exp_f32 v199, v199
    v_exp_f32 v200, v200
    v_exp_f32 v201, v201
    v_smfmac_f32_32x32x32_bf16 v[32:47], v[136:139], v[192:199], v2
    v_exp_f32 v202, v202
    v_exp_f32 v203, v203
    v_exp_f32 v204, v204
    v_exp_f32 v205, v205
    v_mfma_f32_32x32x16_bf16 v[224:239], v[132:135], v[108:111], v[224:239]
    s_waitcnt vmcnt(12)
    v_exp_f32 v206, v206
    v_exp_f32 v207, v207
    v_exp_f32 v208, v208
    v_exp_f32 v209, v209
    v_smfmac_f32_32x32x32_bf16 v[32:47], v[140:143], v[200:207], v2
    v_exp_f32 v210, v210
    v_exp_f32 v211, v211
    v_exp_f32 v212, v212
    v_exp_f32 v213, v213
    v_mfma_f32_32x32x16_bf16 v[192:207], v[144:147], v[80:83], 0
    v_exp_f32 v214, v214
    v_exp_f32 v215, v215
    v_exp_f32 v216, v216
    v_exp_f32 v217, v217
    v_smfmac_f32_32x32x32_bf16 v[48:63], v[136:139], v[208:215], v2
    v_exp_f32 v218, v218
    v_exp_f32 v219, v219
    v_exp_f32 v220, v220
    v_exp_f32 v221, v221
    v_mfma_f32_32x32x16_bf16 v[192:207], v[148:151], v[84:87], v[192:207]
    v_exp_f32 v222, v222
    v_exp_f32 v223, v223
    v_exp_f32 v224, v224
    v_exp_f32 v225, v225
    v_smfmac_f32_32x32x32_bf16 v[48:63], v[140:143], v[216:223], v2
    v_exp_f32 v226, v226
    v_exp_f32 v227, v227
    v_exp_f32 v228, v228
    v_exp_f32 v229, v229
    v_mfma_f32_32x32x16_bf16 v[208:223], v[144:147], v[88:91], 0
    v_exp_f32 v230, v230
    v_exp_f32 v231, v231
    v_exp_f32 v232, v232
    v_exp_f32 v233, v233
    v_smfmac_f32_32x32x32_bf16 v[64:79], v[136:139], v[224:231], v2
    v_exp_f32 v234, v234
    v_exp_f32 v235, v235
    v_exp_f32 v236, v236
    v_exp_f32 v237, v237
    v_mfma_f32_32x32x16_bf16 v[208:223], v[148:151], v[92:95], v[208:223]
    v_exp_f32 v238, v238
    v_exp_f32 v239, v239
    v_exp_f32 v192, v192
    v_exp_f32 v193, v193
    v_smfmac_f32_32x32x32_bf16 v[64:79], v[140:143], v[232:239], v2
    v_exp_f32 v194, v194
    v_exp_f32 v195, v195
    v_exp_f32 v196, v196
    v_exp_f32 v197, v197
    v_mfma_f32_32x32x16_bf16 v[224:239], v[144:147], v[96:99], 0
    v_exp_f32 v198, v198
    v_exp_f32 v199, v199
    v_exp_f32 v200, v200
    v_exp_f32 v201, v201
    v_smfmac_f32_32x32x32_bf16 v[16:31], v[152:155], v[192:199], v2
    v_exp_f32 v202, v202
    v_exp_f32 v203, v203
    v_exp_f32 v204, v204
    v_exp_f32 v205, v205
    v_mfma_f32_32x32x16_bf16 v[224:239], v[148:151], v[100:103], v[224:239]
    v_exp_f32 v206, v206
    v_exp_f32 v207, v207
    v_exp_f32 v208, v208
    v_exp_f32 v209, v209
    v_smfmac_f32_32x32x32_bf16 v[16:31], v[156:159], v[200:207], v2
    v_exp_f32 v210, v210
    v_exp_f32 v211, v211
    v_exp_f32 v212, v212
    v_exp_f32 v213, v213
    v_mfma_f32_32x32x16_bf16 v[192:207], v[144:147], v[104:107], 0
    v_exp_f32 v214, v214
    v_exp_f32 v215, v215
    v_exp_f32 v216, v216
    v_exp_f32 v217, v217
    v_smfmac_f32_32x32x32_bf16 v[32:47], v[152:155], v[208:215], v2
    v_exp_f32 v218, v218
    v_exp_f32 v219, v219
    v_exp_f32 v220, v220
    v_exp_f32 v221, v221
    v_mfma_f32_32x32x16_bf16 v[192:207], v[148:151], v[108:111], v[192:207]
    s_waitcnt vmcnt(8)
    v_exp_f32 v222, v222
    v_exp_f32 v223, v223
    v_exp_f32 v224, v224
    v_exp_f32 v225, v225
    v_smfmac_f32_32x32x32_bf16 v[32:47], v[156:159], v[216:223], v2
    v_exp_f32 v226, v226
    v_exp_f32 v227, v227
    v_exp_f32 v228, v228
    v_exp_f32 v229, v229
    v_mfma_f32_32x32x16_bf16 v[208:223], v[160:163], v[80:83], 0
    v_exp_f32 v230, v230
    v_exp_f32 v231, v231
    v_exp_f32 v232, v232
    v_exp_f32 v233, v233
    v_smfmac_f32_32x32x32_bf16 v[48:63], v[152:155], v[224:231], v2
    v_exp_f32 v234, v234
    v_exp_f32 v235, v235
    v_exp_f32 v236, v236
    v_exp_f32 v237, v237
    v_mfma_f32_32x32x16_bf16 v[208:223], v[164:167], v[84:87], v[208:223]
    s_waitcnt vmcnt(4)
    v_exp_f32 v238, v238
    v_exp_f32 v239, v239
    v_exp_f32 v192, v192
    v_exp_f32 v193, v193
    v_smfmac_f32_32x32x32_bf16 v[48:63], v[156:159], v[232:239], v2
    v_exp_f32 v194, v194
    v_exp_f32 v195, v195
    v_exp_f32 v196, v196
    v_exp_f32 v197, v197
    v_mfma_f32_32x32x16_bf16 v[224:239], v[176:179], v[80:83], 0
    v_exp_f32 v198, v198
    v_exp_f32 v199, v199
    v_exp_f32 v200, v200
    v_exp_f32 v201, v201
    v_smfmac_f32_32x32x32_bf16 v[64:79], v[152:155], v[192:199], v2
    v_exp_f32 v202, v202
    v_exp_f32 v203, v203
    v_exp_f32 v204, v204
    v_exp_f32 v205, v205
    v_mfma_f32_32x32x16_bf16 v[224:239], v[180:183], v[84:87], v[224:239]
    s_waitcnt vmcnt(0)
    v_exp_f32 v206, v206
    v_exp_f32 v207, v207
    v_exp_f32 v208, v208
    v_exp_f32 v209, v209
    v_smfmac_f32_32x32x32_bf16 v[64:79], v[156:159], v[200:207], v2
    v_exp_f32 v210, v210
    v_exp_f32 v211, v211
    v_exp_f32 v212, v212
    v_exp_f32 v213, v213
    v_mfma_f32_32x32x16_bf16 v[192:207], v[112:115], v[80:83], 0
    v_exp_f32 v214, v214
    v_exp_f32 v215, v215
    v_exp_f32 v216, v216
    v_exp_f32 v217, v217
    v_smfmac_f32_32x32x32_bf16 v[16:31], v[168:171], v[208:215], v2
    v_exp_f32 v218, v218
    v_exp_f32 v219, v219
    v_exp_f32 v220, v220
    v_exp_f32 v221, v221
    v_mfma_f32_32x32x16_bf16 v[192:207], v[116:119], v[84:87], v[192:207]
    v_exp_f32 v222, v222
    v_exp_f32 v223, v223
    v_exp_f32 v224, v224
    v_exp_f32 v225, v225
    v_smfmac_f32_32x32x32_bf16 v[16:31], v[172:175], v[216:223], v2
    v_exp_f32 v226, v226
    v_exp_f32 v227, v227
    v_exp_f32 v228, v228
    v_exp_f32 v229, v229
    v_mfma_f32_32x32x16_bf16 v[208:223], v[160:163], v[88:91], 0
    v_exp_f32 v230, v230
    v_exp_f32 v231, v231
    v_exp_f32 v232, v232
    v_exp_f32 v233, v233
    v_smfmac_f32_32x32x32_bf16 v[16:31], v[184:187], v[224:231], v2
    v_exp_f32 v234, v234
    v_exp_f32 v235, v235
    v_exp_f32 v236, v236
    v_exp_f32 v237, v237
    v_mfma_f32_32x32x16_bf16 v[208:223], v[164:167], v[92:95], v[208:223]
    v_exp_f32 v238, v238
    v_exp_f32 v239, v239
    v_exp_f32 v192, v192
    v_exp_f32 v193, v193
    v_smfmac_f32_32x32x32_bf16 v[16:31], v[188:191], v[232:239], v2
    v_exp_f32 v194, v194
    v_exp_f32 v195, v195
    v_exp_f32 v196, v196
    v_exp_f32 v197, v197
    v_mfma_f32_32x32x16_bf16 v[224:239], v[176:179], v[88:91], 0
    v_exp_f32 v198, v198
    v_exp_f32 v199, v199
    v_exp_f32 v200, v200
    v_exp_f32 v201, v201
    v_smfmac_f32_32x32x32_bf16 v[16:31], v[120:123], v[192:199], v2
    v_exp_f32 v202, v202
    v_exp_f32 v203, v203
    v_exp_f32 v204, v204
    v_exp_f32 v205, v205
    v_mfma_f32_32x32x16_bf16 v[224:239], v[180:183], v[92:95], v[224:239]
    v_exp_f32 v206, v206
    v_exp_f32 v207, v207
    v_exp_f32 v208, v208
    v_exp_f32 v209, v209
    v_smfmac_f32_32x32x32_bf16 v[16:31], v[124:127], v[200:207], v2
    v_exp_f32 v210, v210
    v_exp_f32 v211, v211
    v_exp_f32 v212, v212
    v_exp_f32 v213, v213
    v_mfma_f32_32x32x16_bf16 v[192:207], v[112:115], v[88:91], 0
    v_exp_f32 v214, v214
    v_exp_f32 v215, v215
    v_exp_f32 v216, v216
    v_exp_f32 v217, v217
    v_smfmac_f32_32x32x32_bf16 v[32:47], v[168:171], v[208:215], v2
    v_exp_f32 v218, v218
    v_exp_f32 v219, v219
    v_exp_f32 v220, v220
    v_exp_f32 v221, v221
    v_mfma_f32_32x32x16_bf16 v[192:207], v[116:119], v[92:95], v[192:207]
    v_exp_f32 v222, v222
    v_exp_f32 v223, v223
    v_exp_f32 v224, v224
    v_exp_f32 v225, v225
    v_smfmac_f32_32x32x32_bf16 v[32:47], v[172:175], v[216:223], v2
    ds_write_b128 v4, v[16:19] offset:0
    v_exp_f32 v226, v226
    v_exp_f32 v227, v227
    v_exp_f32 v228, v228
    v_exp_f32 v229, v229
    v_mfma_f32_32x32x16_bf16 v[208:223], v[160:163], v[96:99], 0
    v_exp_f32 v230, v230
    v_exp_f32 v231, v231
    v_exp_f32 v232, v232
    v_exp_f32 v233, v233
    v_smfmac_f32_32x32x32_bf16 v[32:47], v[184:187], v[224:231], v2
    ds_write_b128 v4, v[20:23] offset:1024
    v_exp_f32 v234, v234
    v_exp_f32 v235, v235
    v_exp_f32 v236, v236
    v_exp_f32 v237, v237
    v_mfma_f32_32x32x16_bf16 v[208:223], v[164:167], v[100:103], v[208:223]
    v_exp_f32 v238, v238
    v_exp_f32 v239, v239
    v_exp_f32 v192, v192
    v_exp_f32 v193, v193
    v_smfmac_f32_32x32x32_bf16 v[32:47], v[188:191], v[232:239], v2
    ds_write_b128 v4, v[24:27] offset:2048
    v_exp_f32 v194, v194
    v_exp_f32 v195, v195
    v_exp_f32 v196, v196
    v_exp_f32 v197, v197
    v_mfma_f32_32x32x16_bf16 v[224:239], v[176:179], v[96:99], 0
    v_exp_f32 v198, v198
    v_exp_f32 v199, v199
    v_exp_f32 v200, v200
    v_exp_f32 v201, v201
    v_smfmac_f32_32x32x32_bf16 v[32:47], v[120:123], v[192:199], v2
    v_exp_f32 v202, v202
    v_exp_f32 v203, v203
    v_exp_f32 v204, v204
    v_exp_f32 v205, v205
    v_mfma_f32_32x32x16_bf16 v[224:239], v[180:183], v[100:103], v[224:239]
    v_exp_f32 v206, v206
    v_exp_f32 v207, v207
    v_exp_f32 v208, v208
    v_exp_f32 v209, v209
    v_smfmac_f32_32x32x32_bf16 v[32:47], v[124:127], v[200:207], v2
    ds_write_b128 v4, v[28:31] offset:3072
    v_exp_f32 v210, v210
    v_exp_f32 v211, v211
    v_exp_f32 v212, v212
    v_exp_f32 v213, v213
    v_mfma_f32_32x32x16_bf16 v[192:207], v[112:115], v[96:99], 0
    v_exp_f32 v214, v214
    v_exp_f32 v215, v215
    v_exp_f32 v216, v216
    v_exp_f32 v217, v217
    v_smfmac_f32_32x32x32_bf16 v[48:63], v[168:171], v[208:215], v2
    v_exp_f32 v218, v218
    v_exp_f32 v219, v219
    v_exp_f32 v220, v220
    v_exp_f32 v221, v221
    v_mfma_f32_32x32x16_bf16 v[192:207], v[116:119], v[100:103], v[192:207]
    v_exp_f32 v222, v222
    v_exp_f32 v223, v223
    v_exp_f32 v224, v224
    v_exp_f32 v225, v225
    v_smfmac_f32_32x32x32_bf16 v[48:63], v[172:175], v[216:223], v2
    ds_write_b128 v5, v[32:35] offset:0
    v_exp_f32 v226, v226
    v_exp_f32 v227, v227
    v_exp_f32 v228, v228
    v_exp_f32 v229, v229
    v_mfma_f32_32x32x16_bf16 v[208:223], v[160:163], v[104:107], 0
    v_exp_f32 v230, v230
    v_exp_f32 v231, v231
    v_exp_f32 v232, v232
    v_exp_f32 v233, v233
    v_smfmac_f32_32x32x32_bf16 v[48:63], v[184:187], v[224:231], v2
    ds_write_b128 v5, v[36:39] offset:1024
    v_exp_f32 v234, v234
    v_exp_f32 v235, v235
    v_exp_f32 v236, v236
    v_exp_f32 v237, v237
    v_mfma_f32_32x32x16_bf16 v[208:223], v[164:167], v[108:111], v[208:223]
    v_exp_f32 v238, v238
    v_exp_f32 v239, v239
    v_exp_f32 v192, v192
    v_exp_f32 v193, v193
    v_smfmac_f32_32x32x32_bf16 v[48:63], v[188:191], v[232:239], v2
    ds_write_b128 v5, v[40:43] offset:2048
    v_exp_f32 v194, v194
    v_exp_f32 v195, v195
    v_exp_f32 v196, v196
    v_exp_f32 v197, v197
    v_mfma_f32_32x32x16_bf16 v[224:239], v[176:179], v[104:107], 0
    ds_write_b32 v6, v2 offset:3072
    v_exp_f32 v198, v198
    v_exp_f32 v199, v199
    v_exp_f32 v200, v200
    v_exp_f32 v201, v201
    v_smfmac_f32_32x32x32_bf16 v[48:63], v[120:123], v[192:199], v2
    v_exp_f32 v202, v202
    v_exp_f32 v203, v203
    v_exp_f32 v204, v204
    v_exp_f32 v205, v205
    v_mfma_f32_32x32x16_bf16 v[224:239], v[180:183], v[108:111], v[224:239]
    v_exp_f32 v206, v206
    v_exp_f32 v207, v207
    v_exp_f32 v208, v208
    v_exp_f32 v209, v209
    v_smfmac_f32_32x32x32_bf16 v[48:63], v[124:127], v[200:207], v2
    ds_write_b128 v5, v[44:47] offset:3072
    v_exp_f32 v210, v210
    v_exp_f32 v211, v211
    v_exp_f32 v212, v212
    v_exp_f32 v213, v213
    v_mfma_f32_32x32x16_bf16 v[192:207], v[112:115], v[104:107], 0
    v_exp_f32 v214, v214
    v_exp_f32 v215, v215
    v_exp_f32 v216, v216
    v_exp_f32 v217, v217
    v_smfmac_f32_32x32x32_bf16 v[64:79], v[168:171], v[208:215], v2
    v_exp_f32 v218, v218
    v_exp_f32 v219, v219
    v_exp_f32 v220, v220
    v_exp_f32 v221, v221
    v_mfma_f32_32x32x16_bf16 v[192:207], v[116:119], v[108:111], v[192:207]
    v_exp_f32 v222, v222
    v_exp_f32 v223, v223
    v_exp_f32 v224, v224
    v_exp_f32 v225, v225
    v_smfmac_f32_32x32x32_bf16 v[64:79], v[172:175], v[216:223], v2
    ds_write_b128 v6, v[48:51] offset:0
    v_exp_f32 v226, v226
    v_exp_f32 v227, v227
    v_exp_f32 v228, v228
    v_exp_f32 v229, v229
    v_exp_f32 v230, v230
    v_exp_f32 v231, v231
    v_exp_f32 v232, v232
    v_exp_f32 v233, v233
    v_smfmac_f32_32x32x32_bf16 v[64:79], v[184:187], v[224:231], v2
    ds_write_b128 v6, v[52:55] offset:1024
    v_exp_f32 v234, v234
    v_exp_f32 v235, v235
    v_exp_f32 v236, v236
    v_exp_f32 v237, v237
    v_exp_f32 v238, v238
    v_exp_f32 v239, v239
    v_exp_f32 v192, v192
    v_exp_f32 v193, v193
    v_smfmac_f32_32x32x32_bf16 v[64:79], v[188:191], v[232:239], v2
    ds_write_b128 v6, v[56:59] offset:2048
    v_exp_f32 v194, v194
    v_exp_f32 v195, v195
    v_exp_f32 v196, v196
    v_exp_f32 v197, v197
    v_exp_f32 v198, v198
    v_exp_f32 v199, v199
    v_exp_f32 v200, v200
    v_exp_f32 v201, v201
    v_smfmac_f32_32x32x32_bf16 v[64:79], v[120:123], v[192:199], v2
    ds_write_b128 v6, v[60:63] offset:3072
    v_exp_f32 v202, v202
    v_exp_f32 v203, v203
    v_exp_f32 v204, v204
    v_exp_f32 v205, v205
    v_exp_f32 v206, v206
    v_exp_f32 v207, v207
    s_nop 1
    v_smfmac_f32_32x32x32_bf16 v[64:79], v[124:127], v[200:207], v2
    s_lshl2_add_u32 s67, s64, s57
    s_lshl4_add_u32 s67, s67, s63
    s_lshl_b32 s70, s67, 11
    s_add_u32 s70, s70, 8388608
    s_lshl_b32 s71, s67, 7
    s_add_u32 s71, s71, 196608
    s_mov_b32 s72, 0x7b800000
    s_mov_b32 s73, 0xd800000
    s_mov_b32 s74, 0xa800000
    s_waitcnt lgkmcnt(0)
    s_setprio 2
    s_barrier
    s_mov_b64 exec, 255
    buffer_store_dwordx4 v[248:251], v1, s[32:35], s71 offen sc1
    s_mov_b64 exec, -1
L_nofl:
    s_nop 0
    ds_read_b128 v[140:143], v7 offset:3072
    ds_read_b128 v[156:159], v7 offset:19456
    ds_read_b128 v[172:175], v7 offset:35840
    ds_read_b128 v[128:131], v7 offset:0
    ds_read_b128 v[144:147], v7 offset:16384
    ds_read_b128 v[160:163], v7 offset:32768
    ds_read_b128 v[132:135], v7 offset:1024
    ds_read_b128 v[148:151], v7 offset:17408
    ds_read_b128 v[164:167], v7 offset:33792
    ds_read_b128 v[136:139], v7 offset:2048
    ds_read_b128 v[152:155], v7 offset:18432
    ds_read_b128 v[168:171], v7 offset:34816
    s_waitcnt lgkmcnt(10)
    v_pk_add_f32 v[76:77], v[76:77], v[140:141]
    v_pk_add_f32 v[78:79], v[78:79], v[142:143]
    v_pk_add_f32 v[76:77], v[76:77], v[156:157]
    v_pk_add_f32 v[78:79], v[78:79], v[158:159]
    s_waitcnt lgkmcnt(9)
    v_pk_add_f32 v[76:77], v[76:77], v[172:173]
    v_pk_add_f32 v[78:79], v[78:79], v[174:175]
    v_mov_b32 v8, v76
    v_mov_b32 v9, v76
    s_nop 1
    v_permlane32_swap_b32 v8, v9
    v_rcp_f32 v10, v9
    s_waitcnt lgkmcnt(7)
    v_pk_add_f32 v[64:65], v[64:65], v[128:129]
    v_pk_add_f32 v[66:67], v[66:67], v[130:131]
    v_pk_add_f32 v[64:65], v[64:65], v[144:145]
    v_pk_add_f32 v[66:67], v[66:67], v[146:147]
    s_waitcnt lgkmcnt(6)
    v_pk_add_f32 v[64:65], v[64:65], v[160:161]
    v_pk_add_f32 v[66:67], v[66:67], v[162:163]
    s_waitcnt lgkmcnt(4)
    v_pk_add_f32 v[68:69], v[68:69], v[132:133]
    v_pk_add_f32 v[70:71], v[70:71], v[134:135]
    v_pk_add_f32 v[68:69], v[68:69], v[148:149]
    v_pk_add_f32 v[70:71], v[70:71], v[150:151]
    s_waitcnt lgkmcnt(3)
    v_pk_add_f32 v[68:69], v[68:69], v[164:165]
    v_pk_add_f32 v[70:71], v[70:71], v[166:167]
    s_waitcnt lgkmcnt(1)
    v_pk_add_f32 v[72:73], v[72:73], v[136:137]
    v_pk_add_f32 v[74:75], v[74:75], v[138:139]
    v_pk_add_f32 v[72:73], v[72:73], v[152:153]
    v_pk_add_f32 v[74:75], v[74:75], v[154:155]
    s_waitcnt lgkmcnt(0)
    v_pk_add_f32 v[72:73], v[72:73], v[168:169]
    v_pk_add_f32 v[74:75], v[74:75], v[170:171]
    v_mov_b64 v[12:13], 0
    ds_write_b64 v7, v[12:13] offset:32768
    v_maximum3_f32 v8, |v64|, |v65|, |v66|
    v_maximum3_f32 v8, |v67|, |v68|, v8
    v_maximum3_f32 v8, |v69|, |v70|, v8
    v_maximum3_f32 v8, |v71|, |v72|, v8
    v_maximum3_f32 v8, |v73|, |v74|, v8
    v_cmp_ngt_f32 s[78:79], v8, s74
    v_maximum3_f32 v8, |v75|, |v76|, v8
    v_maximum3_f32 v8, |v77|, |v78|, v8
    v_maximum3_f32 v8, |v79|, v9, v8
    v_cmp_nlt_f32 vcc, v8, s72
    v_cmp_ngt_f32 s[76:77], v9, s73
    v_pk_mul_f32 v[64:65], v[64:65], v[10:11] op_sel_hi:[1,0]
    v_pk_mul_f32 v[66:67], v[66:67], v[10:11] op_sel_hi:[1,0]
    v_pk_mul_f32 v[68:69], v[68:69], v[10:11] op_sel_hi:[1,0]
    v_pk_mul_f32 v[70:71], v[70:71], v[10:11] op_sel_hi:[1,0]
    v_pk_mul_f32 v[72:73], v[72:73], v[10:11] op_sel_hi:[1,0]
    v_pk_mul_f32 v[74:75], v[74:75], v[10:11] op_sel_hi:[1,0]
    v_pk_mul_f32 v[76:77], v[76:77], v[10:11] op_sel_hi:[1,0]
    v_pk_mul_f32 v[78:79], v[78:79], v[10:11] op_sel_hi:[1,0]
    v_cvt_pk_bf16_f32 v214, v76, v77
    v_cvt_pk_bf16_f32 v215, v78, v79
    v_cvt_pk_bf16_f32 v208, v64, v65
    v_cvt_pk_bf16_f32 v209, v66, v67
    v_cvt_pk_bf16_f32 v210, v68, v69
    v_cvt_pk_bf16_f32 v211, v70, v71
    v_cvt_pk_bf16_f32 v212, v72, v73
    v_cvt_pk_bf16_f32 v213, v74, v75
    v_permlane32_swap_b32 v214, v215
    v_perm_b32 v215, v253, v211, s86
    v_perm_b32 v211, v253, v211, s87
    s_or_b64 vcc, vcc, s[76:77]
    s_or_b64 vcc, vcc, s[78:79]
    s_cbranch_vccnz L_fallback
L_ostore:
    buffer_store_dwordx4 v[208:211], v1, s[32:35], s70 offen offset:0 sc1
    buffer_store_dwordx4 v[212:215], v1, s[32:35], s70 offen offset:1024 sc1
    s_waitcnt lgkmcnt(0)
    s_barrier
    s_cmp_ge_u32 s59, 28
    s_cbranch_scc1 L_fin
    s_mov_b32 s76, s85
    s_add_u32 s77, s85, 4096
    s_add_u32 s78, s85, 8192
    s_add_u32 s79, s85, 12288
    s_lshl_b32 s82, s57, 12
    s_add_u32 s82, s82, 147456
    v_mov_b32 v10, s82
    v_xor_b32 v11, 8192, v10
    s_setprio 2
L_p3_wait:
    s_mov_b64 exec, 255
    s_mov_b32 s90, 0x40000
L_poll_3:
    buffer_load_dwordx2 v[14:15], v247, s[32:35], 0 offen sc1
    s_waitcnt vmcnt(0)
    v_cmp_ne_u64 vcc, v[248:249], v[14:15]
    s_cbranch_vccz L_polld_4
    s_mov_b64 exec, vcc
    s_sleep 1
    s_sub_u32 s90, s90, 1
    s_cbranch_scc0 L_poll_3
L_polld_4:
    s_mov_b64 exec, -1
    s_mov_b32 s90, 0x40000
L_p3_load:
    buffer_load_dwordx4 v[112:115], v1, s[32:35], s76 offen offset:0 sc1
    buffer_load_dwordx4 v[116:119], v1, s[32:35], s76 offen offset:1024 sc1
    buffer_load_dwordx4 v[120:123], v1, s[32:35], s76 offen offset:2048 sc1
    buffer_load_dwordx4 v[124:127], v1, s[32:35], s76 offen offset:3072 sc1
    buffer_load_dwordx4 v[128:131], v1, s[32:35], s77 offen offset:0 sc1
    buffer_load_dwordx4 v[132:135], v1, s[32:35], s77 offen offset:1024 sc1
    buffer_load_dwordx4 v[136:139], v1, s[32:35], s77 offen offset:2048 sc1
    buffer_load_dwordx4 v[140:143], v1, s[32:35], s77 offen offset:3072 sc1
    buffer_load_dwordx4 v[144:147], v1, s[32:35], s78 offen offset:0 sc1
    buffer_load_dwordx4 v[148:151], v1, s[32:35], s78 offen offset:1024 sc1
    buffer_load_dwordx4 v[152:155], v1, s[32:35], s78 offen offset:2048 sc1
    buffer_load_dwordx4 v[156:159], v1, s[32:35], s78 offen offset:3072 sc1
    buffer_load_dwordx4 v[160:163], v1, s[32:35], s79 offen offset:0 sc1
    buffer_load_dwordx4 v[164:167], v1, s[32:35], s79 offen offset:1024 sc1
    buffer_load_dwordx4 v[168:171], v1, s[32:35], s79 offen offset:2048 sc1
    buffer_load_dwordx4 v[172:175], v1, s[32:35], s79 offen offset:3072 sc1
L_p3:
    ds_read_b64_tr_b16 v[212:213], v241 offset:0
    ds_read_b64_tr_b16 v[214:215], v241 offset:1024
    ds_read_b64_tr_b16 v[208:209], v240 offset:0
    ds_read_b64_tr_b16 v[210:211], v240 offset:1024
    ds_read_b64_tr_b16 v[220:221], v241 offset:2048
    ds_read_b64_tr_b16 v[222:223], v243 offset:0
    ds_read_b64_tr_b16 v[216:217], v240 offset:2048
    ds_read_b64_tr_b16 v[218:219], v242 offset:0
    s_waitcnt vmcnt(15)
    v_xor_b32 v115, v115, v253
    v_or_b32 v12, v115, v115
    s_waitcnt lgkmcnt(4)
    v_mfma_f32_32x32x16_bf16 v[192:207], v[212:215], v[112:115], 0
    ds_read_b64_tr_b16 v[228:229], v241 offset:3584
    ds_read_b64_tr_b16 v[230:231], v241 offset:4608
    ds_read_b64_tr_b16 v[224:225], v240 offset:3584
    ds_read_b64_tr_b16 v[226:227], v240 offset:4608
    v_mfma_f32_32x32x16_bf16 v[176:191], v[208:211], v[112:115], 0
    s_waitcnt vmcnt(14)
    v_xor_b32 v119, v119, v253
    v_or_b32 v12, v119, v12
    s_waitcnt lgkmcnt(4)
    v_mfma_f32_32x32x16_bf16 v[192:207], v[220:223], v[116:119], v[192:207]
    ds_read_b64_tr_b16 v[236:237], v241 offset:5632
    ds_read_b64_tr_b16 v[238:239], v243 offset:3584
    ds_read_b64_tr_b16 v[232:233], v240 offset:5632
    ds_read_b64_tr_b16 v[234:235], v242 offset:3584
    v_mfma_f32_32x32x16_bf16 v[176:191], v[216:219], v[116:119], v[176:191]
    s_waitcnt vmcnt(13)
    v_xor_b32 v123, v123, v253
    v_or_b32 v12, v123, v12
    s_waitcnt lgkmcnt(4)
    v_mfma_f32_32x32x16_bf16 v[192:207], v[228:231], v[120:123], v[192:207]
    ds_read_b64_tr_b16 v[212:213], v241 offset:7168
    ds_read_b64_tr_b16 v[214:215], v241 offset:8192
    ds_read_b64_tr_b16 v[208:209], v240 offset:7168
    ds_read_b64_tr_b16 v[210:211], v240 offset:8192
    v_mfma_f32_32x32x16_bf16 v[176:191], v[224:227], v[120:123], v[176:191]
    s_waitcnt vmcnt(12)
    v_xor_b32 v127, v127, v253
    v_or_b32 v12, v127, v12
    s_waitcnt lgkmcnt(4)
    v_mfma_f32_32x32x16_bf16 v[192:207], v[236:239], v[124:127], v[192:207]
    ds_read_b64_tr_b16 v[220:221], v241 offset:9216
    ds_read_b64_tr_b16 v[222:223], v243 offset:7168
    ds_read_b64_tr_b16 v[216:217], v240 offset:9216
    ds_read_b64_tr_b16 v[218:219], v242 offset:7168
    v_mfma_f32_32x32x16_bf16 v[176:191], v[232:235], v[124:127], v[176:191]
    s_waitcnt vmcnt(11)
    v_xor_b32 v131, v131, v253
    v_or_b32 v12, v131, v12
    s_waitcnt lgkmcnt(4)
    v_mfma_f32_32x32x16_bf16 v[192:207], v[212:215], v[128:131], v[192:207]
    ds_read_b64_tr_b16 v[228:229], v241 offset:10752
    ds_read_b64_tr_b16 v[230:231], v241 offset:11776
    ds_read_b64_tr_b16 v[224:225], v240 offset:10752
    ds_read_b64_tr_b16 v[226:227], v240 offset:11776
    v_mfma_f32_32x32x16_bf16 v[176:191], v[208:211], v[128:131], v[176:191]
    s_waitcnt vmcnt(10)
    v_xor_b32 v135, v135, v253
    v_or_b32 v12, v135, v12
    s_waitcnt lgkmcnt(4)
    v_mfma_f32_32x32x16_bf16 v[192:207], v[220:223], v[132:135], v[192:207]
    ds_read_b64_tr_b16 v[236:237], v241 offset:12800
    ds_read_b64_tr_b16 v[238:239], v243 offset:10752
    ds_read_b64_tr_b16 v[232:233], v240 offset:12800
    ds_read_b64_tr_b16 v[234:235], v242 offset:10752
    v_mfma_f32_32x32x16_bf16 v[176:191], v[216:219], v[132:135], v[176:191]
    s_waitcnt vmcnt(9)
    v_xor_b32 v139, v139, v253
    v_or_b32 v12, v139, v12
    s_waitcnt lgkmcnt(4)
    v_mfma_f32_32x32x16_bf16 v[192:207], v[228:231], v[136:139], v[192:207]
    ds_read_b64_tr_b16 v[212:213], v241 offset:14336
    ds_read_b64_tr_b16 v[214:215], v241 offset:15360
    ds_read_b64_tr_b16 v[208:209], v240 offset:14336
    ds_read_b64_tr_b16 v[210:211], v240 offset:15360
    v_mfma_f32_32x32x16_bf16 v[176:191], v[224:227], v[136:139], v[176:191]
    s_waitcnt vmcnt(8)
    v_xor_b32 v143, v143, v253
    v_or_b32 v12, v143, v12
    s_waitcnt lgkmcnt(4)
    v_mfma_f32_32x32x16_bf16 v[192:207], v[236:239], v[140:143], v[192:207]
    ds_read_b64_tr_b16 v[220:221], v241 offset:16384
    ds_read_b64_tr_b16 v[222:223], v243 offset:14336
    ds_read_b64_tr_b16 v[216:217], v240 offset:16384
    ds_read_b64_tr_b16 v[218:219], v242 offset:14336
    v_mfma_f32_32x32x16_bf16 v[176:191], v[232:235], v[140:143], v[176:191]
    s_waitcnt vmcnt(7)
    v_xor_b32 v147, v147, v253
    v_or_b32 v12, v147, v12
    s_waitcnt lgkmcnt(4)
    v_mfma_f32_32x32x16_bf16 v[192:207], v[212:215], v[144:147], v[192:207]
    ds_read_b64_tr_b16 v[228:229], v241 offset:17920
    ds_read_b64_tr_b16 v[230:231], v241 offset:18944
    ds_read_b64_tr_b16 v[224:225], v240 offset:17920
    ds_read_b64_tr_b16 v[226:227], v240 offset:18944
    v_mfma_f32_32x32x16_bf16 v[176:191], v[208:211], v[144:147], v[176:191]
    s_waitcnt vmcnt(6)
    v_xor_b32 v151, v151, v253
    v_or_b32 v12, v151, v12
    s_waitcnt lgkmcnt(4)
    v_mfma_f32_32x32x16_bf16 v[192:207], v[220:223], v[148:151], v[192:207]
    ds_read_b64_tr_b16 v[236:237], v241 offset:19968
    ds_read_b64_tr_b16 v[238:239], v243 offset:17920
    ds_read_b64_tr_b16 v[232:233], v240 offset:19968
    ds_read_b64_tr_b16 v[234:235], v242 offset:17920
    v_mfma_f32_32x32x16_bf16 v[176:191], v[216:219], v[148:151], v[176:191]
    s_waitcnt vmcnt(5)
    v_xor_b32 v155, v155, v253
    v_or_b32 v12, v155, v12
    s_waitcnt lgkmcnt(4)
    v_mfma_f32_32x32x16_bf16 v[192:207], v[228:231], v[152:155], v[192:207]
    ds_read_b64_tr_b16 v[212:213], v241 offset:21504
    ds_read_b64_tr_b16 v[214:215], v241 offset:22528
    ds_read_b64_tr_b16 v[208:209], v240 offset:21504
    ds_read_b64_tr_b16 v[210:211], v240 offset:22528
    v_mfma_f32_32x32x16_bf16 v[176:191], v[224:227], v[152:155], v[176:191]
    s_waitcnt vmcnt(4)
    v_xor_b32 v159, v159, v253
    v_or_b32 v12, v159, v12
    s_waitcnt lgkmcnt(4)
    v_mfma_f32_32x32x16_bf16 v[192:207], v[236:239], v[156:159], v[192:207]
    ds_read_b64_tr_b16 v[220:221], v241 offset:23552
    ds_read_b64_tr_b16 v[222:223], v243 offset:21504
    ds_read_b64_tr_b16 v[216:217], v240 offset:23552
    ds_read_b64_tr_b16 v[218:219], v242 offset:21504
    v_mfma_f32_32x32x16_bf16 v[176:191], v[232:235], v[156:159], v[176:191]
    s_waitcnt vmcnt(3)
    v_xor_b32 v163, v163, v253
    v_or_b32 v12, v163, v12
    s_waitcnt lgkmcnt(4)
    v_mfma_f32_32x32x16_bf16 v[192:207], v[212:215], v[160:163], v[192:207]
    ds_read_b64_tr_b16 v[228:229], v241 offset:25088
    ds_read_b64_tr_b16 v[230:231], v241 offset:26112
    ds_read_b64_tr_b16 v[224:225], v240 offset:25088
    ds_read_b64_tr_b16 v[226:227], v240 offset:26112
    v_mfma_f32_32x32x16_bf16 v[176:191], v[208:211], v[160:163], v[176:191]
    s_waitcnt vmcnt(2)
    v_xor_b32 v167, v167, v253
    v_or_b32 v12, v167, v12
    s_waitcnt lgkmcnt(4)
    v_mfma_f32_32x32x16_bf16 v[192:207], v[220:223], v[164:167], v[192:207]
    ds_read_b64_tr_b16 v[236:237], v241 offset:27136
    ds_read_b64_tr_b16 v[238:239], v243 offset:25088
    ds_read_b64_tr_b16 v[232:233], v240 offset:27136
    ds_read_b64_tr_b16 v[234:235], v242 offset:25088
    v_mfma_f32_32x32x16_bf16 v[176:191], v[216:219], v[164:167], v[176:191]
    s_waitcnt vmcnt(1)
    v_xor_b32 v171, v171, v253
    v_or_b32 v12, v171, v12
    s_waitcnt lgkmcnt(4)
    v_mfma_f32_32x32x16_bf16 v[192:207], v[228:231], v[168:171], v[192:207]
    v_mfma_f32_32x32x16_bf16 v[176:191], v[224:227], v[168:171], v[176:191]
    s_waitcnt vmcnt(0)
    v_xor_b32 v175, v175, v253
    v_or_b32 v12, v175, v12
    s_waitcnt lgkmcnt(0)
    v_mfma_f32_32x32x16_bf16 v[192:207], v[236:239], v[172:175], v[192:207]
    v_cmp_lt_u32 vcc, 0xffff, v12
    v_mfma_f32_32x32x16_bf16 v[176:191], v[232:235], v[172:175], v[176:191]
    s_cbranch_vccnz L_p3_again
L_p3_fin:
    v_xor_b32 v12, 16, v252
    v_xor_b32 v13, 32, v252
    v_xor_b32_e64 v14, 48, v252
    s_add_u32 s85, s84, 28672
    s_mov_b32 s90, 0x1000000
    s_nop 3
    ds_write_b128 v244, v[192:195] offset:0
    ds_write_b128 v244, v[196:199] offset:1024
    ds_write_b128 v244, v[200:203] offset:2048
    ds_write_b128 v244, v[204:207] offset:3072
    ds_write_b32 v10, v10
L_p3_x:
    ds_read_b32 v15, v11
    ds_read_b128 v[112:115], v245 offset:0
    ds_read_b128 v[116:119], v245 offset:1024
    ds_read_b128 v[120:123], v245 offset:2048
    ds_read_b128 v[124:127], v245 offset:3072
    s_waitcnt lgkmcnt(4)
    v_cmp_ne_u32 vcc, 0, v15
    s_cbranch_vccnz L_p3_xd
    s_waitcnt lgkmcnt(0)
    s_sub_u32 s90, s90, 1
    s_cbranch_scc0 L_p3_x
L_p3_xd:
    s_waitcnt lgkmcnt(3)
    v_add_f32 v176, v176, v112
    v_add_f32 v177, v177, v113
    v_add_f32 v178, v178, v114
    v_add_f32 v179, v179, v115
    v_cvt_pk_bf16_f32 v208, v176, v177
    v_cvt_pk_bf16_f32 v209, v178, v179
    s_waitcnt lgkmcnt(2)
    v_add_f32 v180, v180, v116
    v_add_f32 v181, v181, v117
    v_add_f32 v182, v182, v118
    v_add_f32 v183, v183, v119
    v_cvt_pk_bf16_f32 v210, v180, v181
    v_cvt_pk_bf16_f32 v211, v182, v183
    s_waitcnt lgkmcnt(1)
    v_add_f32 v184, v184, v120
    v_add_f32 v185, v185, v121
    v_add_f32 v186, v186, v122
    v_add_f32 v187, v187, v123
    v_cvt_pk_bf16_f32 v212, v184, v185
    v_cvt_pk_bf16_f32 v213, v186, v187
    s_waitcnt lgkmcnt(0)
    v_add_f32 v188, v188, v124
    v_add_f32 v189, v189, v125
    v_add_f32 v190, v190, v126
    v_add_f32 v191, v191, v127
    v_cvt_pk_bf16_f32 v214, v188, v189
    v_cvt_pk_bf16_f32 v215, v190, v191
    ds_write_b64 v252, v[208:209]
    ds_write_b64 v12, v[210:211]
    ds_write_b64 v13, v[212:213]
    ds_write_b64 v14, v[214:215]
    ds_read_b128 v[216:219], v245
    ds_read_b128 v[220:223], v245 offset:1024
    s_cmp_ge_u32 s56, 4
    s_cbranch_scc1 L_gst
    v_and_b32 v9, -8, v10
    s_mov_b32 s90, 0x100000
L_gw:
    ds_read_b32 v15, v9
    s_waitcnt lgkmcnt(0)
    v_cmp_ne_u32 vcc, 0, v15
    s_cbranch_vccnz L_gst
    s_sleep 1
    s_sub_u32 s90, s90, 1
    s_cbranch_scc0 L_gw
L_gst:
    s_waitcnt lgkmcnt(1)
    buffer_store_dwordx4 v[216:219], v246, s[40:43], s84 offen sc1
    s_waitcnt lgkmcnt(0)
    buffer_store_dwordx4 v[220:223], v246, s[40:43], s85 offen sc1
L_fin:
L_end:
    s_endpgm
L_p3_again:
    s_sub_u32 s90, s90, 1
    s_cbranch_scc0 L_p3_load
    s_branch L_p3_fin
L_G:
    s_and_b32 s58, s2, 7
    s_lshr_b32 s59, s2, 3
    s_and_b32 s60, s59, 1
    s_lshr_b32 s64, s59, 1
    s_lshr_b32 s67, s58, 1
    s_and_b32 s61, s64, 3
    s_lshl2_add_u32 s61, s67, s61
    s_and_b32 s67, s58, 1
    s_lshr_b32 s62, s64, 2
    s_lshl2_add_u32 s62, s67, s62
    s_and_b32 s57, s56, 3
    v_lshlrev_b32 v1, 4, v0
    s_lshr_b32 s70, s57, 1
    s_and_b32 s71, s57, 1
    s_getpc_b64 s[76:77]
L_pc:
    s_sub_u32 s76, s76, L_pc-concat_heads__softmax_full_mha__linear_kernel_hedgehog__prompt_kernel
    s_subb_u32 s77, s77, 0
    s_lshl2_add_u32 s67, s59, s57
    s_mulk_i32 s67, 384
    v_lshlrev_b32 v2, 7, v0
    v_add_u32 v2, s67, v2
    v_min_u32 v2, L_code_end-concat_heads__softmax_full_mha__linear_kernel_hedgehog__prompt_kernel-4, v2
    s_mov_b64 exec, 7
    global_load_dword v255, v2, s[76:77]
    s_mov_b64 exec, -1
    v_and_b32 v14, 31, v0
    v_lshrrev_b32 v15, 5, v0
    v_bfe_u32 v2, v14, 1, 3
    v_xor_b32 v2, v2, v15
    v_lshlrev_b32 v2, 4, v2
    v_lshl_or_b32 v2, v14, 7, v2
    s_lshl_b32 s67, s70, 13
    s_add_u32 s67, s67, 4096
    v_add_u32 v4, s67, v2
    v_xor_b32 v5, 32, v4
    v_xor_b32_e64 v6, 64, v4
    v_xor_b32 v7, 96, v4
    v_add_u32 v8, 106496, v4
    v_add_u32 v9, 106496, v5
    v_add_u32 v10, 106496, v6
    v_add_u32 v11, 106496, v7
    v_bfe_u32 v2, v0, 2, 2
    v_and_b32 v12, 3, v0
    v_lshlrev_b32 v12, 3, v12
    v_bfe_u32 v13, v0, 4, 1
    v_lshl_or_b32 v3, v13, 5, v12
    v_lshrrev_b32 v13, 1, v2
    v_lshlrev_b32 v13, 6, v13
    v_lshl_add_u32 v12, v15, 3, v2
    v_lshlrev_b32 v12, 7, v12
    v_add_u32 v12, 20480, v12
    s_mul_i32 s75, s71, 56
    s_waitcnt lgkmcnt(0)
    s_mov_b32 s32, s22
    s_mov_b32 s33, s23
    s_mov_b32 s34, 20971520
    s_mov_b32 s35, 0x20000
    s_mov_b32 s40, s18
    s_mov_b32 s41, s19
    s_mov_b32 s42, 3670016
    s_mov_b32 s43, 0x20000
    s_mov_b32 s44, s8
    s_mov_b32 s45, s9
    s_mov_b32 s46, 401408
    s_mov_b32 s47, 0x20000
    s_mov_b32 s48, s16
    s_mov_b32 s49, s17
    s_mov_b32 s50, 401408
    s_mov_b32 s51, 0x20000
    s_mov_b32 s36, s20
    s_mov_b32 s37, s21
    s_mov_b32 s38, 256
    s_mov_b32 s39, 0x20000
    s_mul_i32 s67, s59, 37
    s_lshr_b32 s67, s67, 8
    s_mul_i32 s68, s67, 7
    s_sub_u32 s65, s59, s68
    s_lshl_b32 s66, s58, 2
    s_add_u32 s66, s66, s67
    v_mov_b32 v20, v12
    v_mov_b32 v21, v13
    s_and_b32 s94, s57, 1
    s_lshr_b32 s95, s57, 1
    v_bfe_u32 v12, v0, 2, 2
    v_and_b32 v13, 3, v0
    v_lshlrev_b32 v13, 3, v13
    v_bfe_u32 v14, v0, 4, 1
    v_lshl_or_b32 v13, v14, 5, v13
    s_mul_i32 s96, s95, 28672
    s_add_u32 s96, s96, 0
    v_add_u32 v13, s96, v13
    v_lshrrev_b32 v14, 5, v0
    v_lshl_add_u32 v16, v14, 2, v12
    v_lshrrev_b32 v17, 1, v12
    v_xor_b32 v17, s95, v17
    v_lshl_add_u32 v17, v17, 6, v13
    v_lshl_add_u32 v240, v16, 7, v17
    v_xor_b32 v241, 64, v240
    v_mov_b32 v18, 0x1a0b1918
    v_mov_b32 v19, 0x180f1b1a
    v_lshlrev_b32 v16, 3, v16
    v_lshrrev_b64 v[16:17], v16, v[18:19]
    v_and_b32 v16, 255, v16
    v_bfe_u32 v17, v16, 1, 1
    v_xor_b32 v17, s95, v17
    v_lshl_add_u32 v17, v17, 6, v13
    v_lshl_add_u32 v242, v16, 7, v17
    v_xor_b32 v243, 64, v242
    s_lshl_b32 s96, s57, 12
    s_add_u32 s96, s96, 114688
    v_add_u32 v244, s96, v1
    s_xor_b32 s96, s57, 2
    s_lshl_b32 s96, s96, 12
    s_add_u32 s96, s96, 114688
    v_add_u32 v245, s96, v1
    v_and_b32 v12, 31, v0
    v_bfe_u32 v13, v12, 1, 2
    v_lshlrev_b32 v13, 4, v13
    v_lshl_or_b32 v13, v14, 3, v13
    v_lshl_or_b32 v13, v12, 6, v13
    v_add_u32 v252, s96, v13
    v_lshrrev_b32 v12, 2, v0
    v_bfe_u32 v14, v0, 3, 2
    v_xor_b32 v14, v14, v0
    v_and_b32 v14, 3, v14
    v_mul_u32_u24 v12, 1792, v12
    v_lshl_add_u32 v246, v14, 4, v12
    s_lshl1_add_u32 s96, s66, s94
    s_mul_i32 s84, s96, 57344
    s_lshl_b32 s98, s65, 7
    s_add_u32 s84, s84, s98
    s_lshl_b32 s98, s95, 6
    s_add_u32 s84, s84, s98
    s_add_u32 s84, s84, 896
    s_lshl1_add_u32 s99, s96, s95
    s_lshl_b32 s85, s99, 14
    s_add_u32 s85, s85, 10485760
    s_lshl1_add_u32 s99, s66, s95
    s_lshl_b32 s99, s99, 10
    s_add_u32 s99, s99, 65536
    v_lshlrev_b32 v247, 7, v0
    v_add_u32 v247, s99, v247
    v_mov_b32 v12, v20
    v_mov_b32 v13, v21
    v_lshrrev_b32 v16, 3, v0
    v_and_b32 v17, 7, v0
    v_bfe_u32 v18, v0, 4, 1
    v_lshlrev_b32 v18, 2, v18
    v_xor_b32 v17, v17, v18
    v_mul_u32_u24 v16, 896, v16
    v_lshl_add_u32 v224, v17, 4, v16
    v_add_u32 v225, 6144, v224
    v_add_u32 v226, 12288, v224
    v_add_u32 v227, 18432, v224
    v_mov_b64 v[228:229], 0
    s_mov_b32 exec_lo, 0x10000000
    s_mov_b32 exec_hi, 0x10000000
    v_mov_b32 v228, 0x3f803f80
    v_mov_b32 v229, 0x3f803f80
    s_mov_b64 exec, -1
    s_mov_b32 s100, 0xf0000000
    s_mov_b32 s101, 0xf0000000
    s_lshl1_add_u32 s72, s62, s71
    s_cmp_eq_u32 s60, 1
    s_cbranch_scc1 L_GB
    s_mul_i32 s76, s62, 336
    s_and_b32 s76, s76, 127
    s_add_u32 s76, s76, s75
    v_add_u32 v14, s76, v3
    v_lshrrev_b32 v15, 7, v14
    v_and_b32 v14, 127, v14
    v_xor_b32 v14, v14, v13
    v_lshl_add_u32 v14, v15, 13, v14
    v_add_u32 v208, v12, v14
    v_add_u32 v211, 106496, v208
    s_add_u32 s76, s76, 112
    v_add_u32 v14, s76, v3
    v_lshrrev_b32 v15, 7, v14
    v_and_b32 v14, 127, v14
    v_xor_b32 v14, v14, v13
    v_lshl_add_u32 v14, v15, 13, v14
    v_add_u32 v209, v12, v14
    v_add_u32 v212, 106496, v209
    s_add_u32 s76, s76, 112
    v_add_u32 v14, s76, v3
    v_lshrrev_b32 v15, 7, v14
    v_and_b32 v14, 127, v14
    v_xor_b32 v14, v14, v13
    v_lshl_add_u32 v14, v15, 13, v14
    v_add_u32 v210, v12, v14
    v_add_u32 v213, 106496, v210
    s_add_u32 s76, s76, 112
    v_and_b32 v2, 51, v0
    v_bfe_u32 v3, v0, 2, 1
    v_lshl_or_b32 v2, v3, 3, v2
    v_bfe_u32 v3, v0, 3, 1
    v_lshl_or_b32 v2, v3, 2, v2
    v_lshlrev_b32 v14, 4, v2
    s_mul_i32 s73, s62, 6
    s_add_u32 s73, s73, s71
    s_lshl1_add_u32 s74, s61, s70
    s_lshl_b32 s74, s74, 1
    s_add_u32 s82, s73, 0
    s_and_b32 s83, s82, 15
    s_lshl_b32 s83, s83, 6
    s_add_u32 s83, s83, s74
    s_cmp_lt_u32 s82, 16
    s_cselect_b32 s97, 11, 12
    s_cselect_b32 s98, 1, 4
    s_cselect_b32 s94, 0, 0x3f803f80
    s_lshl_b32 s83, s83, s97
    s_lshl_b32 s98, s98, 20
    s_add_u32 s76, s83, s98
    s_lshl_b32 s97, 1, s97
    s_add_u32 s77, s97, s76
    s_add_u32 s82, s73, 2
    s_and_b32 s83, s82, 15
    s_lshl_b32 s83, s83, 6
    s_add_u32 s83, s83, s74
    s_cmp_lt_u32 s82, 16
    s_cselect_b32 s97, 11, 12
    s_cselect_b32 s98, 1, 4
    s_cselect_b32 s95, 0, 0x3f803f80
    s_lshl_b32 s83, s83, s97
    s_lshl_b32 s98, s98, 20
    s_add_u32 s78, s83, s98
    s_lshl_b32 s97, 1, s97
    s_add_u32 s79, s97, s78
    s_add_u32 s82, s73, 4
    s_and_b32 s83, s82, 15
    s_lshl_b32 s83, s83, 6
    s_add_u32 s83, s83, s74
    s_cmp_lt_u32 s82, 16
    s_cselect_b32 s97, 11, 12
    s_cselect_b32 s98, 1, 4
    s_cselect_b32 s96, 0, 0x3f803f80
    s_lshl_b32 s83, s83, s97
    s_lshl_b32 s98, s98, 20
    s_add_u32 s80, s83, s98
    s_lshl_b32 s97, 1, s97
    s_add_u32 s81, s97, s80
    s_mov_b32 s98, 0x3e8b97f6
    s_mov_b32 s99, 0x3e8b97f6
    s_cmp_ge_u32 s62, 6
    s_cbranch_scc1 L_G_NNN
    s_cmp_eq_u32 s62, 5
    s_cbranch_scc1 L_G_TNN
L_G_TTT:
    s_barrier
    s_nop 0
    ds_read_b128 v[112:115], v4 offset:0
    ds_read_b128 v[116:119], v4 offset:4096
    ds_read_b64_tr_b16 v[120:121], v208 offset:0
    ds_read_b64_tr_b16 v[122:123], v208 offset:512
    ds_read_b64_tr_b16 v[124:125], v209 offset:0
    ds_read_b64_tr_b16 v[126:127], v209 offset:512
    ds_read_b64_tr_b16 v[128:129], v210 offset:0
    ds_read_b64_tr_b16 v[130:131], v210 offset:512
    s_waitcnt lgkmcnt(4)
    s_nop 0
    v_mfma_f32_32x32x16_bf16 v[16:31], v[120:123], v[112:115], 0
    ds_read_b128 v[132:135], v5 offset:0
    ds_read_b128 v[136:139], v5 offset:4096
    v_mfma_f32_32x32x16_bf16 v[32:47], v[120:123], v[116:119], 0
    ds_read_b64_tr_b16 v[140:141], v208 offset:2048
    ds_read_b64_tr_b16 v[142:143], v208 offset:2560
    s_waitcnt lgkmcnt(6)
    s_nop 0
    v_mfma_f32_32x32x16_bf16 v[48:63], v[124:127], v[112:115], 0
    ds_read_b64_tr_b16 v[144:145], v209 offset:2048
    ds_read_b64_tr_b16 v[146:147], v209 offset:2560
    v_mfma_f32_32x32x16_bf16 v[64:79], v[124:127], v[116:119], 0
    ds_read_b64_tr_b16 v[148:149], v210 offset:2048
    ds_read_b64_tr_b16 v[150:151], v210 offset:2560
    s_waitcnt lgkmcnt(8)
    v_mfma_f32_32x32x16_bf16 v[80:95], v[128:131], v[112:115], 0
    v_mfma_f32_32x32x16_bf16 v[96:111], v[128:131], v[116:119], 0
    s_waitcnt lgkmcnt(4)
    v_mfma_f32_32x32x16_bf16 v[16:31], v[140:143], v[132:135], v[16:31]
    ds_read_b128 v[112:115], v6 offset:0
    ds_read_b128 v[116:119], v6 offset:4096
    v_mfma_f32_32x32x16_bf16 v[32:47], v[140:143], v[136:139], v[32:47]
    ds_read_b64_tr_b16 v[120:121], v208 offset:4096
    ds_read_b64_tr_b16 v[122:123], v208 offset:4608
    s_waitcnt lgkmcnt(6)
    s_nop 0
    v_mfma_f32_32x32x16_bf16 v[48:63], v[144:147], v[132:135], v[48:63]
    ds_read_b64_tr_b16 v[124:125], v209 offset:4096
    ds_read_b64_tr_b16 v[126:127], v209 offset:4608
    v_mfma_f32_32x32x16_bf16 v[64:79], v[144:147], v[136:139], v[64:79]
    ds_read_b64_tr_b16 v[128:129], v210 offset:4096
    ds_read_b64_tr_b16 v[130:131], v210 offset:4608
    s_waitcnt lgkmcnt(8)
    v_mfma_f32_32x32x16_bf16 v[80:95], v[148:151], v[132:135], v[80:95]
    v_mfma_f32_32x32x16_bf16 v[96:111], v[148:151], v[136:139], v[96:111]
    s_waitcnt lgkmcnt(4)
    v_mfma_f32_32x32x16_bf16 v[16:31], v[120:123], v[112:115], v[16:31]
    ds_read_b128 v[132:135], v7 offset:0
    ds_read_b128 v[136:139], v7 offset:4096
    v_mfma_f32_32x32x16_bf16 v[32:47], v[120:123], v[116:119], v[32:47]
    ds_read_b64_tr_b16 v[140:141], v208 offset:6144
    ds_read_b64_tr_b16 v[142:143], v208 offset:6656
    s_waitcnt lgkmcnt(6)
    s_nop 0
    v_mfma_f32_32x32x16_bf16 v[48:63], v[124:127], v[112:115], v[48:63]
    ds_read_b64_tr_b16 v[144:145], v209 offset:6144
    ds_read_b64_tr_b16 v[146:147], v209 offset:6656
    v_mfma_f32_32x32x16_bf16 v[64:79], v[124:127], v[116:119], v[64:79]
    ds_read_b64_tr_b16 v[148:149], v210 offset:6144
    ds_read_b64_tr_b16 v[150:151], v210 offset:6656
    s_waitcnt lgkmcnt(8)
    v_mfma_f32_32x32x16_bf16 v[80:95], v[128:131], v[112:115], v[80:95]
    v_mfma_f32_32x32x16_bf16 v[96:111], v[128:131], v[116:119], v[96:111]
    s_waitcnt lgkmcnt(4)
    v_mfma_f32_32x32x16_bf16 v[16:31], v[140:143], v[132:135], v[16:31]
    v_mfma_f32_32x32x16_bf16 v[32:47], v[140:143], v[136:139], v[32:47]
    s_waitcnt lgkmcnt(2)
    v_mfma_f32_32x32x16_bf16 v[48:63], v[144:147], v[132:135], v[48:63]
    v_mfma_f32_32x32x16_bf16 v[64:79], v[144:147], v[136:139], v[64:79]
    s_waitcnt lgkmcnt(0)
    s_barrier
    s_nop 0
    ds_read_b128 v[112:115], v4 offset:53248
    ds_read_b128 v[116:119], v4 offset:57344
    ds_read_b64_tr_b16 v[120:121], v208 offset:53248
    ds_read_b64_tr_b16 v[122:123], v208 offset:53760
    v_mfma_f32_32x32x16_bf16 v[80:95], v[148:151], v[132:135], v[80:95]
    ds_read_b64_tr_b16 v[124:125], v209 offset:53248
    ds_read_b64_tr_b16 v[126:127], v209 offset:53760
    v_mfma_f32_32x32x16_bf16 v[96:111], v[148:151], v[136:139], v[96:111]
    ds_read_b64_tr_b16 v[128:129], v210 offset:53248
    ds_read_b64_tr_b16 v[130:131], v210 offset:53760
    s_waitcnt lgkmcnt(4)
    s_nop 0
    v_mfma_f32_32x32x16_bf16 v[16:31], v[120:123], v[112:115], v[16:31]
    ds_read_b128 v[132:135], v5 offset:53248
    ds_read_b128 v[136:139], v5 offset:57344
    v_mfma_f32_32x32x16_bf16 v[32:47], v[120:123], v[116:119], v[32:47]
    ds_read_b64_tr_b16 v[140:141], v208 offset:55296
    ds_read_b64_tr_b16 v[142:143], v208 offset:55808
    s_waitcnt lgkmcnt(6)
    s_nop 0
    v_mfma_f32_32x32x16_bf16 v[48:63], v[124:127], v[112:115], v[48:63]
    ds_read_b64_tr_b16 v[144:145], v209 offset:55296
    ds_read_b64_tr_b16 v[146:147], v209 offset:55808
    v_mfma_f32_32x32x16_bf16 v[64:79], v[124:127], v[116:119], v[64:79]
    ds_read_b64_tr_b16 v[148:149], v210 offset:55296
    ds_read_b64_tr_b16 v[150:151], v210 offset:55808
    s_waitcnt lgkmcnt(8)
    v_mfma_f32_32x32x16_bf16 v[80:95], v[128:131], v[112:115], v[80:95]
    v_mfma_f32_32x32x16_bf16 v[96:111], v[128:131], v[116:119], v[96:111]
    s_waitcnt lgkmcnt(4)
    v_mfma_f32_32x32x16_bf16 v[16:31], v[140:143], v[132:135], v[16:31]
    ds_read_b128 v[112:115], v6 offset:53248
    ds_read_b128 v[116:119], v6 offset:57344
    v_mfma_f32_32x32x16_bf16 v[32:47], v[140:143], v[136:139], v[32:47]
    ds_read_b64_tr_b16 v[120:121], v208 offset:57344
    ds_read_b64_tr_b16 v[122:123], v208 offset:57856
    s_waitcnt lgkmcnt(6)
    s_nop 0
    v_mfma_f32_32x32x16_bf16 v[48:63], v[144:147], v[132:135], v[48:63]
    ds_read_b64_tr_b16 v[124:125], v209 offset:57344
    ds_read_b64_tr_b16 v[126:127], v209 offset:57856
    v_mfma_f32_32x32x16_bf16 v[64:79], v[144:147], v[136:139], v[64:79]
    ds_read_b64_tr_b16 v[128:129], v210 offset:57344
    ds_read_b64_tr_b16 v[130:131], v210 offset:57856
    s_waitcnt lgkmcnt(8)
    v_mfma_f32_32x32x16_bf16 v[80:95], v[148:151], v[132:135], v[80:95]
    v_mfma_f32_32x32x16_bf16 v[96:111], v[148:151], v[136:139], v[96:111]
    s_waitcnt lgkmcnt(4)
    v_mfma_f32_32x32x16_bf16 v[16:31], v[120:123], v[112:115], v[16:31]
    ds_read_b128 v[132:135], v7 offset:53248
    ds_read_b128 v[136:139], v7 offset:57344
    v_mfma_f32_32x32x16_bf16 v[32:47], v[120:123], v[116:119], v[32:47]
    ds_read_b64_tr_b16 v[140:141], v208 offset:59392
    ds_read_b64_tr_b16 v[142:143], v208 offset:59904
    s_waitcnt lgkmcnt(6)
    s_nop 0
    v_mfma_f32_32x32x16_bf16 v[48:63], v[124:127], v[112:115], v[48:63]
    ds_read_b64_tr_b16 v[144:145], v209 offset:59392
    ds_read_b64_tr_b16 v[146:147], v209 offset:59904
    v_mfma_f32_32x32x16_bf16 v[64:79], v[124:127], v[116:119], v[64:79]
    ds_read_b64_tr_b16 v[148:149], v210 offset:59392
    ds_read_b64_tr_b16 v[150:151], v210 offset:59904
    s_waitcnt lgkmcnt(8)
    v_mfma_f32_32x32x16_bf16 v[80:95], v[128:131], v[112:115], v[80:95]
    v_mfma_f32_32x32x16_bf16 v[96:111], v[128:131], v[116:119], v[96:111]
    s_waitcnt lgkmcnt(4)
    v_mfma_f32_32x32x16_bf16 v[16:31], v[140:143], v[132:135], v[16:31]
    v_mfma_f32_32x32x16_bf16 v[32:47], v[140:143], v[136:139], v[32:47]
    s_waitcnt lgkmcnt(2)
    v_mfma_f32_32x32x16_bf16 v[48:63], v[144:147], v[132:135], v[48:63]
    v_mfma_f32_32x32x16_bf16 v[64:79], v[144:147], v[136:139], v[64:79]
    s_waitcnt lgkmcnt(0)
    s_barrier
    s_nop 0
    ds_read_b128 v[112:115], v8 offset:0
    ds_read_b128 v[116:119], v8 offset:4096
    ds_read_b64_tr_b16 v[120:121], v211 offset:0
    ds_read_b64_tr_b16 v[122:123], v211 offset:512
    v_mfma_f32_32x32x16_bf16 v[80:95], v[148:151], v[132:135], v[80:95]
    ds_read_b64_tr_b16 v[124:125], v212 offset:0
    ds_read_b64_tr_b16 v[126:127], v212 offset:512
    v_mfma_f32_32x32x16_bf16 v[96:111], v[148:151], v[136:139], v[96:111]
    ds_read_b64_tr_b16 v[128:129], v213 offset:0
    ds_read_b64_tr_b16 v[130:131], v213 offset:512
    s_waitcnt lgkmcnt(4)
    s_nop 0
    v_mfma_f32_32x32x16_bf16 v[16:31], v[120:123], v[112:115], v[16:31]
    ds_read_b128 v[132:135], v9 offset:0
    ds_read_b128 v[136:139], v9 offset:4096
    v_mfma_f32_32x32x16_bf16 v[32:47], v[120:123], v[116:119], v[32:47]
    ds_read_b64_tr_b16 v[140:141], v211 offset:2048
    ds_read_b64_tr_b16 v[142:143], v211 offset:2560
    s_waitcnt lgkmcnt(6)
    s_nop 0
    v_mfma_f32_32x32x16_bf16 v[48:63], v[124:127], v[112:115], v[48:63]
    ds_read_b64_tr_b16 v[144:145], v212 offset:2048
    ds_read_b64_tr_b16 v[146:147], v212 offset:2560
    v_mfma_f32_32x32x16_bf16 v[64:79], v[124:127], v[116:119], v[64:79]
    ds_read_b64_tr_b16 v[148:149], v213 offset:2048
    ds_read_b64_tr_b16 v[150:151], v213 offset:2560
    s_waitcnt lgkmcnt(8)
    v_mfma_f32_32x32x16_bf16 v[80:95], v[128:131], v[112:115], v[80:95]
    v_mfma_f32_32x32x16_bf16 v[96:111], v[128:131], v[116:119], v[96:111]
    s_waitcnt lgkmcnt(4)
    v_mfma_f32_32x32x16_bf16 v[16:31], v[140:143], v[132:135], v[16:31]
    ds_read_b128 v[112:115], v10 offset:0
    ds_read_b128 v[116:119], v10 offset:4096
    v_mfma_f32_32x32x16_bf16 v[32:47], v[140:143], v[136:139], v[32:47]
    ds_read_b64_tr_b16 v[120:121], v211 offset:4096
    ds_read_b64_tr_b16 v[122:123], v211 offset:4608
    s_waitcnt lgkmcnt(6)
    s_nop 0
    v_mfma_f32_32x32x16_bf16 v[48:63], v[144:147], v[132:135], v[48:63]
    ds_read_b64_tr_b16 v[124:125], v212 offset:4096
    ds_read_b64_tr_b16 v[126:127], v212 offset:4608
    v_mfma_f32_32x32x16_bf16 v[64:79], v[144:147], v[136:139], v[64:79]
    ds_read_b64_tr_b16 v[128:129], v213 offset:4096
    ds_read_b64_tr_b16 v[130:131], v213 offset:4608
    s_waitcnt lgkmcnt(8)
    v_mfma_f32_32x32x16_bf16 v[80:95], v[148:151], v[132:135], v[80:95]
    v_mfma_f32_32x32x16_bf16 v[96:111], v[148:151], v[136:139], v[96:111]
    s_waitcnt lgkmcnt(4)
    v_mfma_f32_32x32x16_bf16 v[16:31], v[120:123], v[112:115], v[16:31]
    ds_read_b128 v[132:135], v11 offset:0
    ds_read_b128 v[136:139], v11 offset:4096
    v_mfma_f32_32x32x16_bf16 v[32:47], v[120:123], v[116:119], v[32:47]
    ds_read_b64_tr_b16 v[140:141], v211 offset:6144
    ds_read_b64_tr_b16 v[142:143], v211 offset:6656
    s_waitcnt lgkmcnt(6)
    s_nop 0
    v_mfma_f32_32x32x16_bf16 v[48:63], v[124:127], v[112:115], v[48:63]
    ds_read_b64_tr_b16 v[144:145], v212 offset:6144
    ds_read_b64_tr_b16 v[146:147], v212 offset:6656
    v_mfma_f32_32x32x16_bf16 v[64:79], v[124:127], v[116:119], v[64:79]
    ds_read_b64_tr_b16 v[148:149], v213 offset:6144
    ds_read_b64_tr_b16 v[150:151], v213 offset:6656
    s_waitcnt lgkmcnt(8)
    v_mfma_f32_32x32x16_bf16 v[80:95], v[128:131], v[112:115], v[80:95]
    v_mfma_f32_32x32x16_bf16 v[96:111], v[128:131], v[116:119], v[96:111]
    s_waitcnt lgkmcnt(4)
    v_mfma_f32_32x32x16_bf16 v[16:31], v[140:143], v[132:135], v[16:31]
    v_mfma_f32_32x32x16_bf16 v[32:47], v[140:143], v[136:139], v[32:47]
    s_waitcnt lgkmcnt(2)
    v_mfma_f32_32x32x16_bf16 v[48:63], v[144:147], v[132:135], v[48:63]
    v_mfma_f32_32x32x16_bf16 v[64:79], v[144:147], v[136:139], v[64:79]
    s_waitcnt lgkmcnt(0)
    s_barrier
    s_nop 0
    ds_read_b128 v[112:115], v4 offset:0
    ds_read_b128 v[116:119], v4 offset:4096
    ds_read_b64_tr_b16 v[120:121], v208 offset:0
    ds_read_b64_tr_b16 v[122:123], v208 offset:512
    v_mfma_f32_32x32x16_bf16 v[80:95], v[148:151], v[132:135], v[80:95]
    ds_read_b64_tr_b16 v[124:125], v209 offset:0
    ds_read_b64_tr_b16 v[126:127], v209 offset:512
    v_mfma_f32_32x32x16_bf16 v[96:111], v[148:151], v[136:139], v[96:111]
    ds_read_b64_tr_b16 v[128:129], v210 offset:0
    ds_read_b64_tr_b16 v[130:131], v210 offset:512
    s_waitcnt lgkmcnt(4)
    s_nop 0
    v_mfma_f32_32x32x16_bf16 v[16:31], v[120:123], v[112:115], v[16:31]
    ds_read_b128 v[132:135], v5 offset:0
    ds_read_b128 v[136:139], v5 offset:4096
    v_mfma_f32_32x32x16_bf16 v[32:47], v[120:123], v[116:119], v[32:47]
    ds_read_b64_tr_b16 v[140:141], v208 offset:2048
    ds_read_b64_tr_b16 v[142:143], v208 offset:2560
    s_waitcnt lgkmcnt(6)
    s_nop 0
    v_mfma_f32_32x32x16_bf16 v[48:63], v[124:127], v[112:115], v[48:63]
    ds_read_b64_tr_b16 v[144:145], v209 offset:2048
    ds_read_b64_tr_b16 v[146:147], v209 offset:2560
    v_mfma_f32_32x32x16_bf16 v[64:79], v[124:127], v[116:119], v[64:79]
    ds_read_b64_tr_b16 v[148:149], v210 offset:2048
    ds_read_b64_tr_b16 v[150:151], v210 offset:2560
    s_waitcnt lgkmcnt(8)
    v_mfma_f32_32x32x16_bf16 v[80:95], v[128:131], v[112:115], v[80:95]
    v_mfma_f32_32x32x16_bf16 v[96:111], v[128:131], v[116:119], v[96:111]
    s_waitcnt lgkmcnt(4)
    v_mfma_f32_32x32x16_bf16 v[16:31], v[140:143], v[132:135], v[16:31]
    ds_read_b128 v[112:115], v6 offset:0
    ds_read_b128 v[116:119], v6 offset:4096
    v_mfma_f32_32x32x16_bf16 v[32:47], v[140:143], v[136:139], v[32:47]
    ds_read_b64_tr_b16 v[120:121], v208 offset:4096
    ds_read_b64_tr_b16 v[122:123], v208 offset:4608
    s_waitcnt lgkmcnt(6)
    s_nop 0
    v_mfma_f32_32x32x16_bf16 v[48:63], v[144:147], v[132:135], v[48:63]
    ds_read_b64_tr_b16 v[124:125], v209 offset:4096
    ds_read_b64_tr_b16 v[126:127], v209 offset:4608
    v_mfma_f32_32x32x16_bf16 v[64:79], v[144:147], v[136:139], v[64:79]
    ds_read_b64_tr_b16 v[128:129], v210 offset:4096
    ds_read_b64_tr_b16 v[130:131], v210 offset:4608
    s_waitcnt lgkmcnt(8)
    v_mfma_f32_32x32x16_bf16 v[80:95], v[148:151], v[132:135], v[80:95]
    v_mfma_f32_32x32x16_bf16 v[96:111], v[148:151], v[136:139], v[96:111]
    s_waitcnt lgkmcnt(4)
    v_mfma_f32_32x32x16_bf16 v[16:31], v[120:123], v[112:115], v[16:31]
    ds_read_b128 v[132:135], v7 offset:0
    ds_read_b128 v[136:139], v7 offset:4096
    v_mfma_f32_32x32x16_bf16 v[32:47], v[120:123], v[116:119], v[32:47]
    ds_read_b64_tr_b16 v[140:141], v208 offset:6144
    ds_read_b64_tr_b16 v[142:143], v208 offset:6656
    s_waitcnt lgkmcnt(6)
    s_nop 0
    v_mfma_f32_32x32x16_bf16 v[48:63], v[124:127], v[112:115], v[48:63]
    ds_read_b64_tr_b16 v[144:145], v209 offset:6144
    ds_read_b64_tr_b16 v[146:147], v209 offset:6656
    v_mfma_f32_32x32x16_bf16 v[64:79], v[124:127], v[116:119], v[64:79]
    ds_read_b64_tr_b16 v[148:149], v210 offset:6144
    ds_read_b64_tr_b16 v[150:151], v210 offset:6656
    s_waitcnt lgkmcnt(8)
    v_mfma_f32_32x32x16_bf16 v[80:95], v[128:131], v[112:115], v[80:95]
    v_mfma_f32_32x32x16_bf16 v[96:111], v[128:131], v[116:119], v[96:111]
    s_waitcnt lgkmcnt(4)
    v_mfma_f32_32x32x16_bf16 v[16:31], v[140:143], v[132:135], v[16:31]
    v_mfma_f32_32x32x16_bf16 v[32:47], v[140:143], v[136:139], v[32:47]
    s_waitcnt lgkmcnt(2)
    v_mfma_f32_32x32x16_bf16 v[48:63], v[144:147], v[132:135], v[48:63]
    v_mfma_f32_32x32x16_bf16 v[64:79], v[144:147], v[136:139], v[64:79]
    s_waitcnt lgkmcnt(0)
    s_barrier
    s_nop 0
    ds_read_b128 v[112:115], v4 offset:53248
    ds_read_b128 v[116:119], v4 offset:57344
    ds_read_b64_tr_b16 v[120:121], v208 offset:53248
    ds_read_b64_tr_b16 v[122:123], v208 offset:53760
    v_mfma_f32_32x32x16_bf16 v[80:95], v[148:151], v[132:135], v[80:95]
    ds_read_b64_tr_b16 v[124:125], v209 offset:53248
    ds_read_b64_tr_b16 v[126:127], v209 offset:53760
    v_mfma_f32_32x32x16_bf16 v[96:111], v[148:151], v[136:139], v[96:111]
    ds_read_b64_tr_b16 v[128:129], v210 offset:53248
    ds_read_b64_tr_b16 v[130:131], v210 offset:53760
    s_waitcnt lgkmcnt(4)
    s_nop 0
    v_mfma_f32_32x32x16_bf16 v[16:31], v[120:123], v[112:115], v[16:31]
    ds_read_b128 v[132:135], v5 offset:53248
    ds_read_b128 v[136:139], v5 offset:57344
    v_mfma_f32_32x32x16_bf16 v[32:47], v[120:123], v[116:119], v[32:47]
    ds_read_b64_tr_b16 v[140:141], v208 offset:55296
    ds_read_b64_tr_b16 v[142:143], v208 offset:55808
    s_waitcnt lgkmcnt(6)
    s_nop 0
    v_mfma_f32_32x32x16_bf16 v[48:63], v[124:127], v[112:115], v[48:63]
    ds_read_b64_tr_b16 v[144:145], v209 offset:55296
    ds_read_b64_tr_b16 v[146:147], v209 offset:55808
    v_mfma_f32_32x32x16_bf16 v[64:79], v[124:127], v[116:119], v[64:79]
    ds_read_b64_tr_b16 v[148:149], v210 offset:55296
    ds_read_b64_tr_b16 v[150:151], v210 offset:55808
    s_waitcnt lgkmcnt(8)
    v_mfma_f32_32x32x16_bf16 v[80:95], v[128:131], v[112:115], v[80:95]
    v_mfma_f32_32x32x16_bf16 v[96:111], v[128:131], v[116:119], v[96:111]
    s_waitcnt lgkmcnt(4)
    v_mfma_f32_32x32x16_bf16 v[16:31], v[140:143], v[132:135], v[16:31]
    ds_read_b128 v[112:115], v6 offset:53248
    ds_read_b128 v[116:119], v6 offset:57344
    v_mfma_f32_32x32x16_bf16 v[32:47], v[140:143], v[136:139], v[32:47]
    ds_read_b64_tr_b16 v[120:121], v208 offset:57344
    ds_read_b64_tr_b16 v[122:123], v208 offset:57856
    s_waitcnt lgkmcnt(6)
    s_nop 0
    v_mfma_f32_32x32x16_bf16 v[48:63], v[144:147], v[132:135], v[48:63]
    ds_read_b64_tr_b16 v[124:125], v209 offset:57344
    ds_read_b64_tr_b16 v[126:127], v209 offset:57856
    v_mfma_f32_32x32x16_bf16 v[64:79], v[144:147], v[136:139], v[64:79]
    ds_read_b64_tr_b16 v[128:129], v210 offset:57344
    ds_read_b64_tr_b16 v[130:131], v210 offset:57856
    s_waitcnt lgkmcnt(8)
    v_mfma_f32_32x32x16_bf16 v[80:95], v[148:151], v[132:135], v[80:95]
    v_mfma_f32_32x32x16_bf16 v[96:111], v[148:151], v[136:139], v[96:111]
    s_waitcnt lgkmcnt(4)
    v_mfma_f32_32x32x16_bf16 v[16:31], v[120:123], v[112:115], v[16:31]
    ds_read_b128 v[132:135], v7 offset:53248
    ds_read_b128 v[136:139], v7 offset:57344
    v_mfma_f32_32x32x16_bf16 v[32:47], v[120:123], v[116:119], v[32:47]
    ds_read_b64_tr_b16 v[140:141], v208 offset:59392
    ds_read_b64_tr_b16 v[142:143], v208 offset:59904
    s_waitcnt lgkmcnt(6)
    s_nop 0
    v_mfma_f32_32x32x16_bf16 v[48:63], v[124:127], v[112:115], v[48:63]
    ds_read_b64_tr_b16 v[144:145], v209 offset:59392
    ds_read_b64_tr_b16 v[146:147], v209 offset:59904
    v_mfma_f32_32x32x16_bf16 v[64:79], v[124:127], v[116:119], v[64:79]
    ds_read_b64_tr_b16 v[148:149], v210 offset:59392
    ds_read_b64_tr_b16 v[150:151], v210 offset:59904
    s_waitcnt lgkmcnt(8)
    v_mfma_f32_32x32x16_bf16 v[80:95], v[128:131], v[112:115], v[80:95]
    v_mfma_f32_32x32x16_bf16 v[96:111], v[128:131], v[116:119], v[96:111]
    s_waitcnt lgkmcnt(4)
    v_mfma_f32_32x32x16_bf16 v[16:31], v[140:143], v[132:135], v[16:31]
    v_mfma_f32_32x32x16_bf16 v[32:47], v[140:143], v[136:139], v[32:47]
    s_waitcnt lgkmcnt(2)
    v_mfma_f32_32x32x16_bf16 v[48:63], v[144:147], v[132:135], v[48:63]
    v_mfma_f32_32x32x16_bf16 v[64:79], v[144:147], v[136:139], v[64:79]
    s_waitcnt lgkmcnt(0)
    s_barrier
    s_nop 0
    ds_read_b128 v[112:115], v8 offset:0
    ds_read_b128 v[116:119], v8 offset:4096
    v_mfma_f32_32x32x16_bf16 v[80:95], v[148:151], v[132:135], v[80:95]
    ds_read_b64_tr_b16 v[120:121], v211 offset:0
    ds_read_b64_tr_b16 v[122:123], v211 offset:512
    v_mfma_f32_32x32x16_bf16 v[96:111], v[148:151], v[136:139], v[96:111]
    ds_read_b64_tr_b16 v[124:125], v212 offset:0
    ds_read_b64_tr_b16 v[126:127], v212 offset:512
    s_waitcnt lgkmcnt(2)
    s_nop 0
    v_mfma_f32_32x32x16_bf16 v[16:31], v[120:123], v[112:115], v[16:31]
    ds_read_b128 v[132:135], v9 offset:0
    ds_read_b128 v[136:139], v9 offset:4096
    v_mfma_f32_32x32x16_bf16 v[32:47], v[120:123], v[116:119], v[32:47]
    ds_read_b64_tr_b16 v[140:141], v211 offset:2048
    ds_read_b64_tr_b16 v[142:143], v211 offset:2560
    s_waitcnt lgkmcnt(4)
    v_mfma_f32_32x32x16_bf16 v[48:63], v[124:127], v[112:115], v[48:63]
    ds_read_b64_tr_b16 v[144:145], v212 offset:2048
    ds_read_b64_tr_b16 v[146:147], v212 offset:2560
    v_mfma_f32_32x32x16_bf16 v[64:79], v[124:127], v[116:119], v[64:79]
    s_waitcnt lgkmcnt(2)
    v_mfma_f32_32x32x16_bf16 v[16:31], v[140:143], v[132:135], v[16:31]
    ds_read_b128 v[112:115], v10 offset:0
    ds_read_b128 v[116:119], v10 offset:4096
    v_mfma_f32_32x32x16_bf16 v[32:47], v[140:143], v[136:139], v[32:47]
    ds_read_b64_tr_b16 v[120:121], v211 offset:4096
    ds_read_b64_tr_b16 v[122:123], v211 offset:4608
    s_waitcnt lgkmcnt(4)
    v_mfma_f32_32x32x16_bf16 v[48:63], v[144:147], v[132:135], v[48:63]
    ds_read_b64_tr_b16 v[124:125], v212 offset:4096
    ds_read_b64_tr_b16 v[126:127], v212 offset:4608
    v_mfma_f32_32x32x16_bf16 v[64:79], v[144:147], v[136:139], v[64:79]
    s_waitcnt lgkmcnt(2)
    v_mfma_f32_32x32x16_bf16 v[16:31], v[120:123], v[112:115], v[16:31]
    ds_read_b128 v[132:135], v11 offset:0
    ds_read_b128 v[136:139], v11 offset:4096
    v_mfma_f32_32x32x16_bf16 v[32:47], v[120:123], v[116:119], v[32:47]
    ds_read_b64_tr_b16 v[140:141], v211 offset:6144
    ds_read_b64_tr_b16 v[142:143], v211 offset:6656
    s_waitcnt lgkmcnt(4)
    v_mfma_f32_32x32x16_bf16 v[48:63], v[124:127], v[112:115], v[48:63]
    ds_read_b64_tr_b16 v[144:145], v212 offset:6144
    ds_read_b64_tr_b16 v[146:147], v212 offset:6656
    v_mfma_f32_32x32x16_bf16 v[64:79], v[124:127], v[116:119], v[64:79]
    s_waitcnt lgkmcnt(2)
    v_mfma_f32_32x32x16_bf16 v[16:31], v[140:143], v[132:135], v[16:31]
    v_mfma_f32_32x32x16_bf16 v[32:47], v[140:143], v[136:139], v[32:47]
    s_waitcnt lgkmcnt(0)
    s_barrier
    ds_read_b128 v[152:155], v4 offset:0
    ds_read_b128 v[156:159], v4 offset:4096
    ds_read_b64_tr_b16 v[184:185], v208 offset:0
    ds_read_b64_tr_b16 v[186:187], v208 offset:512
    v_mfma_f32_32x32x16_bf16 v[48:63], v[144:147], v[132:135], v[48:63]
    ds_read_b128 v[160:163], v5 offset:0
    ds_read_b128 v[164:167], v5 offset:4096
    ds_read_b64_tr_b16 v[188:189], v208 offset:2048
    ds_read_b64_tr_b16 v[190:191], v208 offset:2560
    v_mfma_f32_32x32x16_bf16 v[64:79], v[144:147], v[136:139], v[64:79]
    s_waitcnt lgkmcnt(4)
    s_nop 0
    v_mfma_f32_32x32x16_bf16 v[16:31], v[184:187], v[152:155], v[16:31]
    ds_read_b128 v[168:171], v6 offset:0
    ds_read_b128 v[172:175], v6 offset:4096
    ds_read_b64_tr_b16 v[192:193], v208 offset:4096
    ds_read_b64_tr_b16 v[194:195], v208 offset:4608
    v_mfma_f32_32x32x16_bf16 v[32:47], v[184:187], v[156:159], v[32:47]
    s_waitcnt lgkmcnt(4)
    s_nop 0
    v_mfma_f32_32x32x16_bf16 v[16:31], v[188:191], v[160:163], v[16:31]
    ds_read_b128 v[176:179], v7 offset:0
    ds_read_b128 v[180:183], v7 offset:4096
    ds_read_b64_tr_b16 v[196:197], v208 offset:6144
    ds_read_b64_tr_b16 v[198:199], v208 offset:6656
    v_mfma_f32_32x32x16_bf16 v[32:47], v[188:191], v[164:167], v[32:47]
    s_waitcnt lgkmcnt(4)
    v_mfma_f32_32x32x16_bf16 v[16:31], v[192:195], v[168:171], v[16:31]
    s_barrier
    ds_read_b64_tr_b16 v[184:185], v209 offset:0
    ds_read_b64_tr_b16 v[186:187], v209 offset:512
    v_mfma_f32_32x32x16_bf16 v[32:47], v[192:195], v[172:175], v[32:47]
    s_waitcnt lgkmcnt(2)
    v_mfma_f32_32x32x16_bf16 v[16:31], v[196:199], v[176:179], v[16:31]
    ds_read_b64_tr_b16 v[188:189], v209 offset:2048
    ds_read_b64_tr_b16 v[190:191], v209 offset:2560
    v_mfma_f32_32x32x16_bf16 v[32:47], v[196:199], v[180:183], v[32:47]
    s_waitcnt lgkmcnt(2)
    v_mfma_f32_32x32x16_bf16 v[48:63], v[184:187], v[152:155], v[48:63]
    ds_read_b64_tr_b16 v[192:193], v209 offset:4096
    ds_read_b64_tr_b16 v[194:195], v209 offset:4608
    s_nop 6
    s_nop 0
    v_cvt_pk_bf16_f32 v112, v16, v17
    v_cvt_pk_bf16_f32 v113, v18, v19
    v_mfma_f32_32x32x16_bf16 v[64:79], v[184:187], v[156:159], v[64:79]
    v_cvt_pk_bf16_f32 v114, v20, v21
    v_cvt_pk_bf16_f32 v115, v22, v23
    buffer_store_dwordx4 v[112:115], v14, s[32:35], s76 offen offset:0 sc1
    v_cvt_pk_bf16_f32 v116, v24, v25
    s_waitcnt lgkmcnt(2)
    s_nop 0
    v_mfma_f32_32x32x16_bf16 v[48:63], v[188:191], v[160:163], v[48:63]
    ds_read_b64_tr_b16 v[196:197], v209 offset:6144
    ds_read_b64_tr_b16 v[198:199], v209 offset:6656
    v_cvt_pk_bf16_f32 v117, v26, v27
    v_cvt_pk_bf16_f32 v118, v28, v29
    v_cvt_pk_bf16_f32 v119, v30, v31
    v_mfma_f32_32x32x16_bf16 v[64:79], v[188:191], v[164:167], v[64:79]
    s_mov_b32 exec_lo, 0
    v_mov_b32 v118, s94
    v_mov_b32 v119, 0
    s_mov_b32 exec_lo, -1
    s_waitcnt lgkmcnt(2)
    v_mfma_f32_32x32x16_bf16 v[48:63], v[192:195], v[168:171], v[48:63]
    s_barrier
    buffer_load_dwordx4 v[248:251], off, s[36:39], 0 sc1
    ds_read_b64_tr_b16 v[184:185], v210 offset:0
    ds_read_b64_tr_b16 v[186:187], v210 offset:512
    buffer_store_dwordx4 v[116:119], v14, s[32:35], s76 offen offset:1024 sc1
    v_cvt_pk_bf16_f32 v120, v32, v33
    v_cvt_pk_bf16_f32 v121, v34, v35
    v_mfma_f32_32x32x16_bf16 v[64:79], v[192:195], v[172:175], v[64:79]
    v_cvt_pk_bf16_f32 v122, v36, v37
    v_cvt_pk_bf16_f32 v123, v38, v39
    buffer_store_dwordx4 v[120:123], v14, s[32:35], s77 offen offset:0 sc1
    v_cvt_pk_bf16_f32 v124, v40, v41
    s_waitcnt lgkmcnt(2)
    s_nop 0
    v_mfma_f32_32x32x16_bf16 v[48:63], v[196:199], v[176:179], v[48:63]
    ds_read_b64_tr_b16 v[188:189], v210 offset:2048
    ds_read_b64_tr_b16 v[190:191], v210 offset:2560
    v_cvt_pk_bf16_f32 v125, v42, v43
    v_cvt_pk_bf16_f32 v126, v44, v45
    v_cvt_pk_bf16_f32 v127, v46, v47
    v_mfma_f32_32x32x16_bf16 v[64:79], v[196:199], v[180:183], v[64:79]
    s_mov_b32 exec_lo, 0
    v_mov_b32 v126, s94
    v_mov_b32 v127, 0
    s_mov_b32 exec_lo, -1
    s_waitcnt lgkmcnt(2)
    v_mfma_f32_32x32x16_bf16 v[80:95], v[184:187], v[152:155], v[80:95]
    ds_read_b64_tr_b16 v[192:193], v210 offset:4096
    ds_read_b64_tr_b16 v[194:195], v210 offset:4608
    buffer_store_dwordx4 v[124:127], v14, s[32:35], s77 offen offset:1024 sc1
    s_nop 6
    v_cvt_pk_bf16_f32 v128, v48, v49
    v_mfma_f32_32x32x16_bf16 v[96:111], v[184:187], v[156:159], v[96:111]
    v_cvt_pk_bf16_f32 v129, v50, v51
    v_cvt_pk_bf16_f32 v130, v52, v53
    v_cvt_pk_bf16_f32 v131, v54, v55
    buffer_store_dwordx4 v[128:131], v14, s[32:35], s78 offen offset:0 sc1
    s_waitcnt lgkmcnt(2)
    s_nop 0
    v_mfma_f32_32x32x16_bf16 v[80:95], v[188:191], v[160:163], v[80:95]
    ds_read_b64_tr_b16 v[196:197], v210 offset:6144
    ds_read_b64_tr_b16 v[198:199], v210 offset:6656
    v_cvt_pk_bf16_f32 v132, v56, v57
    v_cvt_pk_bf16_f32 v133, v58, v59
    v_cvt_pk_bf16_f32 v134, v60, v61
    v_mfma_f32_32x32x16_bf16 v[96:111], v[188:191], v[164:167], v[96:111]
    v_cvt_pk_bf16_f32 v135, v62, v63
    s_mov_b32 exec_lo, 0
    v_mov_b32 v134, s95
    v_mov_b32_e64 v135, 0
    s_mov_b32 exec_lo, -1
    s_waitcnt lgkmcnt(2)
    v_mfma_f32_32x32x16_bf16 v[80:95], v[192:195], v[168:171], v[80:95]
    ds_read_b128 v[152:155], v8 offset:0
    ds_read_b128 v[156:159], v8 offset:4096
    ds_read_b64_tr_b16 v[184:185], v213 offset:0
    ds_read_b64_tr_b16 v[186:187], v213 offset:512
    buffer_store_dwordx4 v[132:135], v14, s[32:35], s78 offen offset:1024 sc1
    v_cvt_pk_bf16_f32 v136, v64, v65
    v_cvt_pk_bf16_f32 v137, v66, v67
    v_mfma_f32_32x32x16_bf16 v[96:111], v[192:195], v[172:175], v[96:111]
    v_cvt_pk_bf16_f32 v138, v68, v69
    v_cvt_pk_bf16_f32 v139, v70, v71
    buffer_store_dwordx4 v[136:139], v14, s[32:35], s79 offen offset:0 sc1
    v_cvt_pk_bf16_f32 v140, v72, v73
    s_waitcnt lgkmcnt(4)
    s_nop 0
    v_mfma_f32_32x32x16_bf16 v[80:95], v[196:199], v[176:179], v[80:95]
    ds_read_b128 v[160:163], v9 offset:0
    ds_read_b128 v[164:167], v9 offset:4096
    ds_read_b64_tr_b16 v[188:189], v213 offset:2048
    ds_read_b64_tr_b16 v[190:191], v213 offset:2560
    v_cvt_pk_bf16_f32 v141, v74, v75
    v_cvt_pk_bf16_f32 v142, v76, v77
    v_cvt_pk_bf16_f32 v143, v78, v79
    v_mfma_f32_32x32x16_bf16 v[96:111], v[196:199], v[180:183], v[96:111]
    s_mov_b32 exec_lo, 0
    v_mov_b32 v142, s95
    v_mov_b32_e64 v143, 0
    s_mov_b32 exec_lo, -1
    s_waitcnt lgkmcnt(4)
    v_mfma_f32_32x32x16_bf16 v[80:95], v[184:187], v[152:155], v[80:95]
    ds_read_b128 v[168:171], v10 offset:0
    ds_read_b128 v[172:175], v10 offset:4096
    ds_read_b64_tr_b16 v[192:193], v213 offset:4096
    ds_read_b64_tr_b16 v[194:195], v213 offset:4608
    buffer_store_dwordx4 v[140:143], v14, s[32:35], s79 offen offset:1024 sc1
    v_mfma_f32_32x32x16_bf16 v[96:111], v[184:187], v[156:159], v[96:111]
    s_waitcnt lgkmcnt(4)
    s_nop 0
    v_mfma_f32_32x32x16_bf16 v[80:95], v[188:191], v[160:163], v[80:95]
    ds_read_b128 v[176:179], v11 offset:0
    ds_read_b128 v[180:183], v11 offset:4096
    ds_read_b64_tr_b16 v[196:197], v213 offset:6144
    ds_read_b64_tr_b16 v[198:199], v213 offset:6656
    v_mfma_f32_32x32x16_bf16 v[96:111], v[188:191], v[164:167], v[96:111]
    s_waitcnt lgkmcnt(4)
    v_mfma_f32_32x32x16_bf16 v[80:95], v[192:195], v[168:171], v[80:95]
    v_mfma_f32_32x32x16_bf16 v[96:111], v[192:195], v[172:175], v[96:111]
    s_waitcnt lgkmcnt(0)
    v_mfma_f32_32x32x16_bf16 v[80:95], v[196:199], v[176:179], v[80:95]
    v_mfma_f32_32x32x16_bf16 v[96:111], v[196:199], v[180:183], v[96:111]
    s_nop 10
    s_nop 0
    v_cvt_pk_bf16_f32 v112, v80, v81
    v_cvt_pk_bf16_f32 v113, v82, v83
    v_cvt_pk_bf16_f32 v114, v84, v85
    v_cvt_pk_bf16_f32 v115, v86, v87
    buffer_store_dwordx4 v[112:115], v14, s[32:35], s80 offen offset:0 sc1
    v_cvt_pk_bf16_f32 v116, v88, v89
    v_cvt_pk_bf16_f32 v117, v90, v91
    v_cvt_pk_bf16_f32 v118, v92, v93
    v_cvt_pk_bf16_f32 v119, v94, v95
    s_mov_b32 exec_lo, 0
    v_mov_b32 v118, s96
    v_mov_b32 v119, 0
    s_mov_b32 exec_lo, -1
    buffer_store_dwordx4 v[116:119], v14, s[32:35], s80 offen offset:1024 sc1
    v_cvt_pk_bf16_f32 v120, v96, v97
    v_cvt_pk_bf16_f32 v121, v98, v99
    v_cvt_pk_bf16_f32 v122, v100, v101
    v_cvt_pk_bf16_f32 v123, v102, v103
    buffer_store_dwordx4 v[120:123], v14, s[32:35], s81 offen offset:0 sc1
    v_cvt_pk_bf16_f32 v124, v104, v105
    v_cvt_pk_bf16_f32 v125, v106, v107
    v_cvt_pk_bf16_f32 v126, v108, v109
    v_cvt_pk_bf16_f32 v127, v110, v111
    s_mov_b32 exec_lo, 0
    v_mov_b32 v126, s96
    v_mov_b32 v127, 0
    s_mov_b32 exec_lo, -1
    buffer_store_dwordx4 v[124:127], v14, s[32:35], s81 offen offset:1024 sc1
    s_branch L_GA_done
L_G_TNN:
    s_barrier
    ds_read_b128 v[112:115], v4 offset:0
    ds_read_b128 v[116:119], v4 offset:4096
    ds_read_b64_tr_b16 v[120:121], v208 offset:0
    ds_read_b64_tr_b16 v[122:123], v208 offset:512
    ds_read_b64_tr_b16 v[124:125], v209 offset:0
    ds_read_b64_tr_b16 v[126:127], v209 offset:512
    ds_read_b64_tr_b16 v[128:129], v210 offset:0
    ds_read_b64_tr_b16 v[130:131], v210 offset:512
    s_waitcnt lgkmcnt(4)
    s_nop 0
    v_mfma_f32_32x32x16_bf16 v[16:31], v[120:123], v[112:115], 0
    ds_read_b128 v[132:135], v5 offset:0
    ds_read_b128 v[136:139], v5 offset:4096
    v_mfma_f32_32x32x16_bf16 v[32:47], v[120:123], v[116:119], 0
    ds_read_b64_tr_b16 v[140:141], v208 offset:2048
    ds_read_b64_tr_b16 v[142:143], v208 offset:2560
    s_waitcnt lgkmcnt(6)
    s_nop 0
    v_mfma_f32_32x32x16_bf16 v[48:63], v[112:115], v[124:127], 0
    ds_read_b64_tr_b16 v[144:145], v209 offset:2048
    ds_read_b64_tr_b16 v[146:147], v209 offset:2560
    v_mfma_f32_32x32x16_bf16 v[64:79], v[116:119], v[124:127], 0
    ds_read_b64_tr_b16 v[148:149], v210 offset:2048
    ds_read_b64_tr_b16 v[150:151], v210 offset:2560
    s_waitcnt lgkmcnt(8)
    v_mfma_f32_32x32x16_bf16 v[80:95], v[112:115], v[128:131], 0
    v_mfma_f32_32x32x16_bf16 v[96:111], v[116:119], v[128:131], 0
    s_waitcnt lgkmcnt(4)
    v_mfma_f32_32x32x16_bf16 v[16:31], v[140:143], v[132:135], v[16:31]
    ds_read_b128 v[112:115], v6 offset:0
    ds_read_b128 v[116:119], v6 offset:4096
    v_mfma_f32_32x32x16_bf16 v[32:47], v[140:143], v[136:139], v[32:47]
    ds_read_b64_tr_b16 v[120:121], v208 offset:4096
    ds_read_b64_tr_b16 v[122:123], v208 offset:4608
    s_waitcnt lgkmcnt(6)
    s_nop 0
    v_mfma_f32_32x32x16_bf16 v[48:63], v[132:135], v[144:147], v[48:63]
    ds_read_b64_tr_b16 v[124:125], v209 offset:4096
    ds_read_b64_tr_b16 v[126:127], v209 offset:4608
    v_mfma_f32_32x32x16_bf16 v[64:79], v[136:139], v[144:147], v[64:79]
    ds_read_b64_tr_b16 v[128:129], v210 offset:4096
    ds_read_b64_tr_b16 v[130:131], v210 offset:4608
    s_waitcnt lgkmcnt(8)
    v_mfma_f32_32x32x16_bf16 v[80:95], v[132:135], v[148:151], v[80:95]
    v_mfma_f32_32x32x16_bf16 v[96:111], v[136:139], v[148:151], v[96:111]
    s_waitcnt lgkmcnt(4)
    v_mfma_f32_32x32x16_bf16 v[16:31], v[120:123], v[112:115], v[16:31]
    ds_read_b128 v[132:135], v7 offset:0
    ds_read_b128 v[136:139], v7 offset:4096
    v_mfma_f32_32x32x16_bf16 v[32:47], v[120:123], v[116:119], v[32:47]
    ds_read_b64_tr_b16 v[140:141], v208 offset:6144
    ds_read_b64_tr_b16 v[142:143], v208 offset:6656
    s_waitcnt lgkmcnt(6)
    s_nop 0
    v_mfma_f32_32x32x16_bf16 v[48:63], v[112:115], v[124:127], v[48:63]
    ds_read_b64_tr_b16 v[144:145], v209 offset:6144
    ds_read_b64_tr_b16 v[146:147], v209 offset:6656
    v_mfma_f32_32x32x16_bf16 v[64:79], v[116:119], v[124:127], v[64:79]
    ds_read_b64_tr_b16 v[148:149], v210 offset:6144
    ds_read_b64_tr_b16 v[150:151], v210 offset:6656
    s_waitcnt lgkmcnt(8)
    v_mfma_f32_32x32x16_bf16 v[80:95], v[112:115], v[128:131], v[80:95]
    v_mfma_f32_32x32x16_bf16 v[96:111], v[116:119], v[128:131], v[96:111]
    s_waitcnt lgkmcnt(4)
    v_mfma_f32_32x32x16_bf16 v[16:31], v[140:143], v[132:135], v[16:31]
    v_mfma_f32_32x32x16_bf16 v[32:47], v[140:143], v[136:139], v[32:47]
    s_waitcnt lgkmcnt(2)
    v_mfma_f32_32x32x16_bf16 v[48:63], v[132:135], v[144:147], v[48:63]
    v_mfma_f32_32x32x16_bf16 v[64:79], v[136:139], v[144:147], v[64:79]
    s_waitcnt lgkmcnt(0)
    s_barrier
    s_nop 0
    ds_read_b128 v[112:115], v4 offset:53248
    ds_read_b128 v[116:119], v4 offset:57344
    ds_read_b64_tr_b16 v[120:121], v208 offset:53248
    ds_read_b64_tr_b16 v[122:123], v208 offset:53760
    v_mfma_f32_32x32x16_bf16 v[80:95], v[132:135], v[148:151], v[80:95]
    ds_read_b64_tr_b16 v[124:125], v209 offset:53248
    ds_read_b64_tr_b16 v[126:127], v209 offset:53760
    v_mfma_f32_32x32x16_bf16 v[96:111], v[136:139], v[148:151], v[96:111]
    ds_read_b64_tr_b16 v[128:129], v210 offset:53248
    ds_read_b64_tr_b16 v[130:131], v210 offset:53760
    s_waitcnt lgkmcnt(4)
    s_nop 0
    v_mfma_f32_32x32x16_bf16 v[16:31], v[120:123], v[112:115], v[16:31]
    ds_read_b128 v[132:135], v5 offset:53248
    ds_read_b128 v[136:139], v5 offset:57344
    v_mfma_f32_32x32x16_bf16 v[32:47], v[120:123], v[116:119], v[32:47]
    ds_read_b64_tr_b16 v[140:141], v208 offset:55296
    ds_read_b64_tr_b16 v[142:143], v208 offset:55808
    s_waitcnt lgkmcnt(6)
    s_nop 0
    v_mfma_f32_32x32x16_bf16 v[48:63], v[112:115], v[124:127], v[48:63]
    ds_read_b64_tr_b16 v[144:145], v209 offset:55296
    ds_read_b64_tr_b16 v[146:147], v209 offset:55808
    v_mfma_f32_32x32x16_bf16 v[64:79], v[116:119], v[124:127], v[64:79]
    ds_read_b64_tr_b16 v[148:149], v210 offset:55296
    ds_read_b64_tr_b16 v[150:151], v210 offset:55808
    s_waitcnt lgkmcnt(8)
    v_mfma_f32_32x32x16_bf16 v[80:95], v[112:115], v[128:131], v[80:95]
    v_mfma_f32_32x32x16_bf16 v[96:111], v[116:119], v[128:131], v[96:111]
    s_waitcnt lgkmcnt(4)
    v_mfma_f32_32x32x16_bf16 v[16:31], v[140:143], v[132:135], v[16:31]
    ds_read_b128 v[112:115], v6 offset:53248
    ds_read_b128 v[116:119], v6 offset:57344
    v_mfma_f32_32x32x16_bf16 v[32:47], v[140:143], v[136:139], v[32:47]
    ds_read_b64_tr_b16 v[120:121], v208 offset:57344
    ds_read_b64_tr_b16 v[122:123], v208 offset:57856
    s_waitcnt lgkmcnt(6)
    s_nop 0
    v_mfma_f32_32x32x16_bf16 v[48:63], v[132:135], v[144:147], v[48:63]
    ds_read_b64_tr_b16 v[124:125], v209 offset:57344
    ds_read_b64_tr_b16 v[126:127], v209 offset:57856
    v_mfma_f32_32x32x16_bf16 v[64:79], v[136:139], v[144:147], v[64:79]
    ds_read_b64_tr_b16 v[128:129], v210 offset:57344
    ds_read_b64_tr_b16 v[130:131], v210 offset:57856
    s_waitcnt lgkmcnt(8)
    v_mfma_f32_32x32x16_bf16 v[80:95], v[132:135], v[148:151], v[80:95]
    v_mfma_f32_32x32x16_bf16 v[96:111], v[136:139], v[148:151], v[96:111]
    s_waitcnt lgkmcnt(4)
    v_mfma_f32_32x32x16_bf16 v[16:31], v[120:123], v[112:115], v[16:31]
    ds_read_b128 v[132:135], v7 offset:53248
    ds_read_b128 v[136:139], v7 offset:57344
    v_mfma_f32_32x32x16_bf16 v[32:47], v[120:123], v[116:119], v[32:47]
    ds_read_b64_tr_b16 v[140:141], v208 offset:59392
    ds_read_b64_tr_b16 v[142:143], v208 offset:59904
    s_waitcnt lgkmcnt(6)
    s_nop 0
    v_mfma_f32_32x32x16_bf16 v[48:63], v[112:115], v[124:127], v[48:63]
    ds_read_b64_tr_b16 v[144:145], v209 offset:59392
    ds_read_b64_tr_b16 v[146:147], v209 offset:59904
    v_mfma_f32_32x32x16_bf16 v[64:79], v[116:119], v[124:127], v[64:79]
    ds_read_b64_tr_b16 v[148:149], v210 offset:59392
    ds_read_b64_tr_b16 v[150:151], v210 offset:59904
    s_waitcnt lgkmcnt(8)
    v_mfma_f32_32x32x16_bf16 v[80:95], v[112:115], v[128:131], v[80:95]
    v_mfma_f32_32x32x16_bf16 v[96:111], v[116:119], v[128:131], v[96:111]
    s_waitcnt lgkmcnt(4)
    v_mfma_f32_32x32x16_bf16 v[16:31], v[140:143], v[132:135], v[16:31]
    v_mfma_f32_32x32x16_bf16 v[32:47], v[140:143], v[136:139], v[32:47]
    s_waitcnt lgkmcnt(2)
    v_mfma_f32_32x32x16_bf16 v[48:63], v[132:135], v[144:147], v[48:63]
    v_mfma_f32_32x32x16_bf16 v[64:79], v[136:139], v[144:147], v[64:79]
    s_waitcnt lgkmcnt(0)
    s_barrier
    s_nop 0
    ds_read_b128 v[112:115], v8 offset:0
    ds_read_b128 v[116:119], v8 offset:4096
    ds_read_b64_tr_b16 v[120:121], v211 offset:0
    ds_read_b64_tr_b16 v[122:123], v211 offset:512
    v_mfma_f32_32x32x16_bf16 v[80:95], v[132:135], v[148:151], v[80:95]
    ds_read_b64_tr_b16 v[124:125], v212 offset:0
    ds_read_b64_tr_b16 v[126:127], v212 offset:512
    v_mfma_f32_32x32x16_bf16 v[96:111], v[136:139], v[148:151], v[96:111]
    ds_read_b64_tr_b16 v[128:129], v213 offset:0
    ds_read_b64_tr_b16 v[130:131], v213 offset:512
    s_waitcnt lgkmcnt(4)
    s_nop 0
    v_mfma_f32_32x32x16_bf16 v[16:31], v[120:123], v[112:115], v[16:31]
    ds_read_b128 v[132:135], v9 offset:0
    ds_read_b128 v[136:139], v9 offset:4096
    v_mfma_f32_32x32x16_bf16 v[32:47], v[120:123], v[116:119], v[32:47]
    ds_read_b64_tr_b16 v[140:141], v211 offset:2048
    ds_read_b64_tr_b16 v[142:143], v211 offset:2560
    s_waitcnt lgkmcnt(6)
    s_nop 0
    v_mfma_f32_32x32x16_bf16 v[48:63], v[112:115], v[124:127], v[48:63]
    ds_read_b64_tr_b16 v[144:145], v212 offset:2048
    ds_read_b64_tr_b16 v[146:147], v212 offset:2560
    v_mfma_f32_32x32x16_bf16 v[64:79], v[116:119], v[124:127], v[64:79]
    ds_read_b64_tr_b16 v[148:149], v213 offset:2048
    ds_read_b64_tr_b16 v[150:151], v213 offset:2560
    s_waitcnt lgkmcnt(8)
    v_mfma_f32_32x32x16_bf16 v[80:95], v[112:115], v[128:131], v[80:95]
    v_mfma_f32_32x32x16_bf16 v[96:111], v[116:119], v[128:131], v[96:111]
    s_waitcnt lgkmcnt(4)
    v_mfma_f32_32x32x16_bf16 v[16:31], v[140:143], v[132:135], v[16:31]
    ds_read_b128 v[112:115], v10 offset:0
    ds_read_b128 v[116:119], v10 offset:4096
    v_mfma_f32_32x32x16_bf16 v[32:47], v[140:143], v[136:139], v[32:47]
    ds_read_b64_tr_b16 v[120:121], v211 offset:4096
    ds_read_b64_tr_b16 v[122:123], v211 offset:4608
    s_waitcnt lgkmcnt(6)
    s_nop 0
    v_mfma_f32_32x32x16_bf16 v[48:63], v[132:135], v[144:147], v[48:63]
    ds_read_b64_tr_b16 v[124:125], v212 offset:4096
    ds_read_b64_tr_b16 v[126:127], v212 offset:4608
    v_mfma_f32_32x32x16_bf16 v[64:79], v[136:139], v[144:147], v[64:79]
    ds_read_b64_tr_b16 v[128:129], v213 offset:4096
    ds_read_b64_tr_b16 v[130:131], v213 offset:4608
    s_waitcnt lgkmcnt(8)
    v_mfma_f32_32x32x16_bf16 v[80:95], v[132:135], v[148:151], v[80:95]
    v_mfma_f32_32x32x16_bf16 v[96:111], v[136:139], v[148:151], v[96:111]
    s_waitcnt lgkmcnt(4)
    v_mfma_f32_32x32x16_bf16 v[16:31], v[120:123], v[112:115], v[16:31]
    ds_read_b128 v[132:135], v11 offset:0
    ds_read_b128 v[136:139], v11 offset:4096
    v_mfma_f32_32x32x16_bf16 v[32:47], v[120:123], v[116:119], v[32:47]
    ds_read_b64_tr_b16 v[140:141], v211 offset:6144
    ds_read_b64_tr_b16 v[142:143], v211 offset:6656
    s_waitcnt lgkmcnt(6)
    s_nop 0
    v_mfma_f32_32x32x16_bf16 v[48:63], v[112:115], v[124:127], v[48:63]
    ds_read_b64_tr_b16 v[144:145], v212 offset:6144
    ds_read_b64_tr_b16 v[146:147], v212 offset:6656
    v_mfma_f32_32x32x16_bf16 v[64:79], v[116:119], v[124:127], v[64:79]
    ds_read_b64_tr_b16 v[148:149], v213 offset:6144
    ds_read_b64_tr_b16 v[150:151], v213 offset:6656
    s_waitcnt lgkmcnt(8)
    v_mfma_f32_32x32x16_bf16 v[80:95], v[112:115], v[128:131], v[80:95]
    v_mfma_f32_32x32x16_bf16 v[96:111], v[116:119], v[128:131], v[96:111]
    s_waitcnt lgkmcnt(4)
    v_mfma_f32_32x32x16_bf16 v[16:31], v[140:143], v[132:135], v[16:31]
    v_mfma_f32_32x32x16_bf16 v[32:47], v[140:143], v[136:139], v[32:47]
    s_waitcnt lgkmcnt(2)
    v_mfma_f32_32x32x16_bf16 v[48:63], v[132:135], v[144:147], v[48:63]
    v_mfma_f32_32x32x16_bf16 v[64:79], v[136:139], v[144:147], v[64:79]
    s_waitcnt lgkmcnt(0)
    s_barrier
    s_nop 0
    ds_read_b128 v[112:115], v4 offset:0
    ds_read_b128 v[116:119], v4 offset:4096
    ds_read_b64_tr_b16 v[120:121], v208 offset:0
    ds_read_b64_tr_b16 v[122:123], v208 offset:512
    v_mfma_f32_32x32x16_bf16 v[80:95], v[132:135], v[148:151], v[80:95]
    ds_read_b64_tr_b16 v[124:125], v209 offset:0
    ds_read_b64_tr_b16 v[126:127], v209 offset:512
    v_mfma_f32_32x32x16_bf16 v[96:111], v[136:139], v[148:151], v[96:111]
    ds_read_b64_tr_b16 v[128:129], v210 offset:0
    ds_read_b64_tr_b16 v[130:131], v210 offset:512
    s_waitcnt lgkmcnt(4)
    s_nop 0
    v_mfma_f32_32x32x16_bf16 v[16:31], v[120:123], v[112:115], v[16:31]
    ds_read_b128 v[132:135], v5 offset:0
    ds_read_b128 v[136:139], v5 offset:4096
    v_mfma_f32_32x32x16_bf16 v[32:47], v[120:123], v[116:119], v[32:47]
    ds_read_b64_tr_b16 v[140:141], v208 offset:2048
    ds_read_b64_tr_b16 v[142:143], v208 offset:2560
    s_waitcnt lgkmcnt(6)
    s_nop 0
    v_mfma_f32_32x32x16_bf16 v[48:63], v[112:115], v[124:127], v[48:63]
    ds_read_b64_tr_b16 v[144:145], v209 offset:2048
    ds_read_b64_tr_b16 v[146:147], v209 offset:2560
    v_mfma_f32_32x32x16_bf16 v[64:79], v[116:119], v[124:127], v[64:79]
    ds_read_b64_tr_b16 v[148:149], v210 offset:2048
    ds_read_b64_tr_b16 v[150:151], v210 offset:2560
    s_waitcnt lgkmcnt(8)
    v_mfma_f32_32x32x16_bf16 v[80:95], v[112:115], v[128:131], v[80:95]
    v_mfma_f32_32x32x16_bf16 v[96:111], v[116:119], v[128:131], v[96:111]
    s_waitcnt lgkmcnt(4)
    v_mfma_f32_32x32x16_bf16 v[16:31], v[140:143], v[132:135], v[16:31]
    ds_read_b128 v[112:115], v6 offset:0
    ds_read_b128 v[116:119], v6 offset:4096
    v_mfma_f32_32x32x16_bf16 v[32:47], v[140:143], v[136:139], v[32:47]
    ds_read_b64_tr_b16 v[120:121], v208 offset:4096
    ds_read_b64_tr_b16 v[122:123], v208 offset:4608
    s_waitcnt lgkmcnt(6)
    s_nop 0
    v_mfma_f32_32x32x16_bf16 v[48:63], v[132:135], v[144:147], v[48:63]
    ds_read_b64_tr_b16 v[124:125], v209 offset:4096
    ds_read_b64_tr_b16 v[126:127], v209 offset:4608
    v_mfma_f32_32x32x16_bf16 v[64:79], v[136:139], v[144:147], v[64:79]
    ds_read_b64_tr_b16 v[128:129], v210 offset:4096
    ds_read_b64_tr_b16 v[130:131], v210 offset:4608
    s_waitcnt lgkmcnt(8)
    v_mfma_f32_32x32x16_bf16 v[80:95], v[132:135], v[148:151], v[80:95]
    v_mfma_f32_32x32x16_bf16 v[96:111], v[136:139], v[148:151], v[96:111]
    s_waitcnt lgkmcnt(4)
    v_mfma_f32_32x32x16_bf16 v[16:31], v[120:123], v[112:115], v[16:31]
    ds_read_b128 v[132:135], v7 offset:0
    ds_read_b128 v[136:139], v7 offset:4096
    v_mfma_f32_32x32x16_bf16 v[32:47], v[120:123], v[116:119], v[32:47]
    ds_read_b64_tr_b16 v[140:141], v208 offset:6144
    ds_read_b64_tr_b16 v[142:143], v208 offset:6656
    s_waitcnt lgkmcnt(6)
    s_nop 0
    v_mfma_f32_32x32x16_bf16 v[48:63], v[112:115], v[124:127], v[48:63]
    ds_read_b64_tr_b16 v[144:145], v209 offset:6144
    ds_read_b64_tr_b16 v[146:147], v209 offset:6656
    v_mfma_f32_32x32x16_bf16 v[64:79], v[116:119], v[124:127], v[64:79]
    ds_read_b64_tr_b16 v[148:149], v210 offset:6144
    ds_read_b64_tr_b16 v[150:151], v210 offset:6656
    s_waitcnt lgkmcnt(8)
    v_mfma_f32_32x32x16_bf16 v[80:95], v[112:115], v[128:131], v[80:95]
    v_mfma_f32_32x32x16_bf16 v[96:111], v[116:119], v[128:131], v[96:111]
    s_waitcnt lgkmcnt(4)
    v_mfma_f32_32x32x16_bf16 v[16:31], v[140:143], v[132:135], v[16:31]
    v_mfma_f32_32x32x16_bf16 v[32:47], v[140:143], v[136:139], v[32:47]
    s_waitcnt lgkmcnt(2)
    v_mfma_f32_32x32x16_bf16 v[48:63], v[132:135], v[144:147], v[48:63]
    v_mfma_f32_32x32x16_bf16 v[64:79], v[136:139], v[144:147], v[64:79]
    s_waitcnt lgkmcnt(0)
    s_barrier
    s_nop 0
    ds_read_b128 v[112:115], v4 offset:53248
    ds_read_b128 v[116:119], v4 offset:57344
    ds_read_b64_tr_b16 v[120:121], v208 offset:53248
    ds_read_b64_tr_b16 v[122:123], v208 offset:53760
    v_mfma_f32_32x32x16_bf16 v[80:95], v[132:135], v[148:151], v[80:95]
    ds_read_b64_tr_b16 v[124:125], v209 offset:53248
    ds_read_b64_tr_b16 v[126:127], v209 offset:53760
    v_mfma_f32_32x32x16_bf16 v[96:111], v[136:139], v[148:151], v[96:111]
    ds_read_b64_tr_b16 v[128:129], v210 offset:53248
    ds_read_b64_tr_b16 v[130:131], v210 offset:53760
    s_waitcnt lgkmcnt(4)
    s_nop 0
    v_mfma_f32_32x32x16_bf16 v[16:31], v[120:123], v[112:115], v[16:31]
    ds_read_b128 v[132:135], v5 offset:53248
    ds_read_b128 v[136:139], v5 offset:57344
    v_mfma_f32_32x32x16_bf16 v[32:47], v[120:123], v[116:119], v[32:47]
    ds_read_b64_tr_b16 v[140:141], v208 offset:55296
    ds_read_b64_tr_b16 v[142:143], v208 offset:55808
    s_waitcnt lgkmcnt(6)
    s_nop 0
    v_mfma_f32_32x32x16_bf16 v[48:63], v[112:115], v[124:127], v[48:63]
    ds_read_b64_tr_b16 v[144:145], v209 offset:55296
    ds_read_b64_tr_b16 v[146:147], v209 offset:55808
    v_mfma_f32_32x32x16_bf16 v[64:79], v[116:119], v[124:127], v[64:79]
    ds_read_b64_tr_b16 v[148:149], v210 offset:55296
    ds_read_b64_tr_b16 v[150:151], v210 offset:55808
    s_waitcnt lgkmcnt(8)
    v_mfma_f32_32x32x16_bf16 v[80:95], v[112:115], v[128:131], v[80:95]
    v_mfma_f32_32x32x16_bf16 v[96:111], v[116:119], v[128:131], v[96:111]
    s_waitcnt lgkmcnt(4)
    v_mfma_f32_32x32x16_bf16 v[16:31], v[140:143], v[132:135], v[16:31]
    ds_read_b128 v[112:115], v6 offset:53248
    ds_read_b128 v[116:119], v6 offset:57344
    v_mfma_f32_32x32x16_bf16 v[32:47], v[140:143], v[136:139], v[32:47]
    ds_read_b64_tr_b16 v[120:121], v208 offset:57344
    ds_read_b64_tr_b16 v[122:123], v208 offset:57856
    s_waitcnt lgkmcnt(6)
    s_nop 0
    v_mfma_f32_32x32x16_bf16 v[48:63], v[132:135], v[144:147], v[48:63]
    ds_read_b64_tr_b16 v[124:125], v209 offset:57344
    ds_read_b64_tr_b16 v[126:127], v209 offset:57856
    v_mfma_f32_32x32x16_bf16 v[64:79], v[136:139], v[144:147], v[64:79]
    ds_read_b64_tr_b16 v[128:129], v210 offset:57344
    ds_read_b64_tr_b16 v[130:131], v210 offset:57856
    s_waitcnt lgkmcnt(8)
    v_mfma_f32_32x32x16_bf16 v[80:95], v[132:135], v[148:151], v[80:95]
    v_mfma_f32_32x32x16_bf16 v[96:111], v[136:139], v[148:151], v[96:111]
    s_waitcnt lgkmcnt(4)
    v_mfma_f32_32x32x16_bf16 v[16:31], v[120:123], v[112:115], v[16:31]
    ds_read_b128 v[132:135], v7 offset:53248
    ds_read_b128 v[136:139], v7 offset:57344
    v_mfma_f32_32x32x16_bf16 v[32:47], v[120:123], v[116:119], v[32:47]
    ds_read_b64_tr_b16 v[140:141], v208 offset:59392
    ds_read_b64_tr_b16 v[142:143], v208 offset:59904
    s_waitcnt lgkmcnt(6)
    s_nop 0
    v_mfma_f32_32x32x16_bf16 v[48:63], v[112:115], v[124:127], v[48:63]
    ds_read_b64_tr_b16 v[144:145], v209 offset:59392
    ds_read_b64_tr_b16 v[146:147], v209 offset:59904
    v_mfma_f32_32x32x16_bf16 v[64:79], v[116:119], v[124:127], v[64:79]
    ds_read_b64_tr_b16 v[148:149], v210 offset:59392
    ds_read_b64_tr_b16 v[150:151], v210 offset:59904
    s_waitcnt lgkmcnt(8)
    v_mfma_f32_32x32x16_bf16 v[80:95], v[112:115], v[128:131], v[80:95]
    v_mfma_f32_32x32x16_bf16 v[96:111], v[116:119], v[128:131], v[96:111]
    s_waitcnt lgkmcnt(4)
    v_mfma_f32_32x32x16_bf16 v[16:31], v[140:143], v[132:135], v[16:31]
    v_mfma_f32_32x32x16_bf16 v[32:47], v[140:143], v[136:139], v[32:47]
    s_waitcnt lgkmcnt(2)
    v_mfma_f32_32x32x16_bf16 v[48:63], v[132:135], v[144:147], v[48:63]
    v_mfma_f32_32x32x16_bf16 v[64:79], v[136:139], v[144:147], v[64:79]
    s_waitcnt lgkmcnt(0)
    s_barrier
    s_nop 0
    ds_read_b128 v[112:115], v8 offset:0
    ds_read_b128 v[116:119], v8 offset:4096
    v_mfma_f32_32x32x16_bf16 v[80:95], v[132:135], v[148:151], v[80:95]
    ds_read_b64_tr_b16 v[120:121], v211 offset:0
    ds_read_b64_tr_b16 v[122:123], v211 offset:512
    v_mfma_f32_32x32x16_bf16 v[96:111], v[136:139], v[148:151], v[96:111]
    ds_read_b64_tr_b16 v[124:125], v212 offset:0
    ds_read_b64_tr_b16 v[126:127], v212 offset:512
    s_waitcnt lgkmcnt(2)
    s_nop 0
    v_mfma_f32_32x32x16_bf16 v[16:31], v[120:123], v[112:115], v[16:31]
    ds_read_b128 v[132:135], v9 offset:0
    ds_read_b128 v[136:139], v9 offset:4096
    v_mfma_f32_32x32x16_bf16 v[32:47], v[120:123], v[116:119], v[32:47]
    ds_read_b64_tr_b16 v[140:141], v211 offset:2048
    ds_read_b64_tr_b16 v[142:143], v211 offset:2560
    s_waitcnt lgkmcnt(4)
    v_mfma_f32_32x32x16_bf16 v[48:63], v[112:115], v[124:127], v[48:63]
    ds_read_b64_tr_b16 v[144:145], v212 offset:2048
    ds_read_b64_tr_b16 v[146:147], v212 offset:2560
    v_mfma_f32_32x32x16_bf16 v[64:79], v[116:119], v[124:127], v[64:79]
    s_waitcnt lgkmcnt(2)
    v_mfma_f32_32x32x16_bf16 v[16:31], v[140:143], v[132:135], v[16:31]
    ds_read_b128 v[112:115], v10 offset:0
    ds_read_b128 v[116:119], v10 offset:4096
    v_mfma_f32_32x32x16_bf16 v[32:47], v[140:143], v[136:139], v[32:47]
    ds_read_b64_tr_b16 v[120:121], v211 offset:4096
    ds_read_b64_tr_b16 v[122:123], v211 offset:4608
    s_waitcnt lgkmcnt(4)
    v_mfma_f32_32x32x16_bf16 v[48:63], v[132:135], v[144:147], v[48:63]
    ds_read_b64_tr_b16 v[124:125], v212 offset:4096
    ds_read_b64_tr_b16 v[126:127], v212 offset:4608
    v_mfma_f32_32x32x16_bf16 v[64:79], v[136:139], v[144:147], v[64:79]
    s_waitcnt lgkmcnt(2)
    v_mfma_f32_32x32x16_bf16 v[16:31], v[120:123], v[112:115], v[16:31]
    ds_read_b128 v[132:135], v11 offset:0
    ds_read_b128 v[136:139], v11 offset:4096
    v_mfma_f32_32x32x16_bf16 v[32:47], v[120:123], v[116:119], v[32:47]
    ds_read_b64_tr_b16 v[140:141], v211 offset:6144
    ds_read_b64_tr_b16 v[142:143], v211 offset:6656
    s_waitcnt lgkmcnt(4)
    v_mfma_f32_32x32x16_bf16 v[48:63], v[112:115], v[124:127], v[48:63]
    ds_read_b64_tr_b16 v[144:145], v212 offset:6144
    ds_read_b64_tr_b16 v[146:147], v212 offset:6656
    v_mfma_f32_32x32x16_bf16 v[64:79], v[116:119], v[124:127], v[64:79]
    s_waitcnt lgkmcnt(2)
    v_mfma_f32_32x32x16_bf16 v[16:31], v[140:143], v[132:135], v[16:31]
    v_mfma_f32_32x32x16_bf16 v[32:47], v[140:143], v[136:139], v[32:47]
    s_waitcnt lgkmcnt(0)
    s_barrier
    ds_read_b128 v[152:155], v4 offset:0
    ds_read_b128 v[156:159], v4 offset:4096
    ds_read_b64_tr_b16 v[184:185], v208 offset:0
    ds_read_b64_tr_b16 v[186:187], v208 offset:512
    v_mfma_f32_32x32x16_bf16 v[48:63], v[132:135], v[144:147], v[48:63]
    ds_read_b128 v[160:163], v5 offset:0
    ds_read_b128 v[164:167], v5 offset:4096
    ds_read_b64_tr_b16 v[188:189], v208 offset:2048
    ds_read_b64_tr_b16 v[190:191], v208 offset:2560
    v_mfma_f32_32x32x16_bf16 v[64:79], v[136:139], v[144:147], v[64:79]
    s_waitcnt lgkmcnt(4)
    s_nop 0
    v_mfma_f32_32x32x16_bf16 v[16:31], v[184:187], v[152:155], v[16:31]
    ds_read_b128 v[168:171], v6 offset:0
    ds_read_b128 v[172:175], v6 offset:4096
    ds_read_b64_tr_b16 v[192:193], v208 offset:4096
    ds_read_b64_tr_b16 v[194:195], v208 offset:4608
    v_mfma_f32_32x32x16_bf16 v[32:47], v[184:187], v[156:159], v[32:47]
    s_waitcnt lgkmcnt(4)
    s_nop 0
    v_mfma_f32_32x32x16_bf16 v[16:31], v[188:191], v[160:163], v[16:31]
    ds_read_b128 v[176:179], v7 offset:0
    ds_read_b128 v[180:183], v7 offset:4096
    ds_read_b64_tr_b16 v[196:197], v208 offset:6144
    ds_read_b64_tr_b16 v[198:199], v208 offset:6656
    v_mfma_f32_32x32x16_bf16 v[32:47], v[188:191], v[164:167], v[32:47]
    s_waitcnt lgkmcnt(4)
    v_mfma_f32_32x32x16_bf16 v[16:31], v[192:195], v[168:171], v[16:31]
    s_barrier
    ds_read_b64_tr_b16 v[184:185], v209 offset:0
    ds_read_b64_tr_b16 v[186:187], v209 offset:512
    v_mfma_f32_32x32x16_bf16 v[32:47], v[192:195], v[172:175], v[32:47]
    s_waitcnt lgkmcnt(2)
    v_mfma_f32_32x32x16_bf16 v[16:31], v[196:199], v[176:179], v[16:31]
    ds_read_b64_tr_b16 v[188:189], v209 offset:2048
    ds_read_b64_tr_b16 v[190:191], v209 offset:2560
    v_mfma_f32_32x32x16_bf16 v[32:47], v[196:199], v[180:183], v[32:47]
    s_waitcnt lgkmcnt(2)
    v_mfma_f32_32x32x16_bf16 v[48:63], v[152:155], v[184:187], v[48:63]
    ds_read_b64_tr_b16 v[192:193], v209 offset:4096
    ds_read_b64_tr_b16 v[194:195], v209 offset:4608
    s_nop 6
    s_nop 0
    v_cvt_pk_bf16_f32 v112, v16, v17
    v_cvt_pk_bf16_f32 v113, v18, v19
    v_mfma_f32_32x32x16_bf16 v[64:79], v[156:159], v[184:187], v[64:79]
    v_cvt_pk_bf16_f32 v114, v20, v21
    v_cvt_pk_bf16_f32 v115, v22, v23
    buffer_store_dwordx4 v[112:115], v14, s[32:35], s76 offen offset:0 sc1
    v_cvt_pk_bf16_f32 v116, v24, v25
    s_waitcnt lgkmcnt(2)
    s_nop 0
    v_mfma_f32_32x32x16_bf16 v[48:63], v[160:163], v[188:191], v[48:63]
    ds_read_b64_tr_b16 v[196:197], v209 offset:6144
    ds_read_b64_tr_b16 v[198:199], v209 offset:6656
    v_cvt_pk_bf16_f32 v117, v26, v27
    v_cvt_pk_bf16_f32 v118, v28, v29
    v_cvt_pk_bf16_f32 v119, v30, v31
    v_mfma_f32_32x32x16_bf16 v[64:79], v[164:167], v[188:191], v[64:79]
    s_mov_b32 exec_lo, 0
    v_mov_b32 v118, s94
    v_mov_b32 v119, 0
    s_mov_b32 exec_lo, -1
    s_waitcnt lgkmcnt(2)
    v_mfma_f32_32x32x16_bf16 v[48:63], v[168:171], v[192:195], v[48:63]
    s_barrier
    buffer_load_dwordx4 v[248:251], off, s[36:39], 0 sc1
    ds_read_b64_tr_b16 v[184:185], v210 offset:0
    ds_read_b64_tr_b16 v[186:187], v210 offset:512
    buffer_store_dwordx4 v[116:119], v14, s[32:35], s76 offen offset:1024 sc1
    v_cvt_pk_bf16_f32 v120, v32, v33
    v_cvt_pk_bf16_f32 v121, v34, v35
    v_mfma_f32_32x32x16_bf16 v[64:79], v[172:175], v[192:195], v[64:79]
    v_cvt_pk_bf16_f32 v122, v36, v37
    v_cvt_pk_bf16_f32 v123, v38, v39
    buffer_store_dwordx4 v[120:123], v14, s[32:35], s77 offen offset:0 sc1
    v_cvt_pk_bf16_f32 v124, v40, v41
    s_waitcnt lgkmcnt(2)
    s_nop 0
    v_mfma_f32_32x32x16_bf16 v[48:63], v[176:179], v[196:199], v[48:63]
    ds_read_b64_tr_b16 v[188:189], v210 offset:2048
    ds_read_b64_tr_b16 v[190:191], v210 offset:2560
    v_cvt_pk_bf16_f32 v125, v42, v43
    v_cvt_pk_bf16_f32 v126, v44, v45
    v_cvt_pk_bf16_f32 v127, v46, v47
    v_mfma_f32_32x32x16_bf16 v[64:79], v[180:183], v[196:199], v[64:79]
    s_mov_b32 exec_lo, 0
    v_mov_b32 v126, s94
    v_mov_b32 v127, 0
    s_mov_b32 exec_lo, -1
    s_waitcnt lgkmcnt(2)
    v_mfma_f32_32x32x16_bf16 v[80:95], v[152:155], v[184:187], v[80:95]
    ds_read_b64_tr_b16 v[192:193], v210 offset:4096
    ds_read_b64_tr_b16 v[194:195], v210 offset:4608
    buffer_store_dwordx4 v[124:127], v14, s[32:35], s77 offen offset:1024 sc1
    s_nop 6
    v_cvt_pk_bf16_f32 v128, v48, v49
    v_mfma_f32_32x32x16_bf16 v[96:111], v[156:159], v[184:187], v[96:111]
    v_cvt_pk_bf16_f32 v129, v50, v51
    v_cvt_pk_bf16_f32 v130, v52, v53
    v_cvt_pk_bf16_f32 v131, v54, v55
    s_mov_b64 exec, s[100:101]
    v_mov_b64 v[128:129], v[228:229]
    v_mov_b64_e64 v[130:131], v[228:229]
    s_mov_b64 exec, -1
    s_waitcnt lgkmcnt(2)
    v_mfma_f32_32x32x16_bf16 v[80:95], v[160:163], v[188:191], v[80:95]
    ds_read_b64_tr_b16 v[196:197], v210 offset:6144
    ds_read_b64_tr_b16 v[198:199], v210 offset:6656
    buffer_store_dwordx4 v[128:131], v1, s[32:35], s78 offen offset:2048 sc1
    v_cvt_pk_bf16_f32 v132, v56, v57
    v_cvt_pk_bf16_f32 v133, v58, v59
    v_mfma_f32_32x32x16_bf16 v[96:111], v[164:167], v[188:191], v[96:111]
    v_cvt_pk_bf16_f32 v134, v60, v61
    v_cvt_pk_bf16_f32 v135, v62, v63
    s_mov_b64 exec, s[100:101]
    v_mov_b64 v[132:133], v[228:229]
    v_mov_b64_e64 v[134:135], v[228:229]
    s_mov_b64 exec, -1
    s_waitcnt lgkmcnt(2)
    v_mfma_f32_32x32x16_bf16 v[80:95], v[168:171], v[192:195], v[80:95]
    ds_read_b128 v[152:155], v8 offset:0
    ds_read_b128 v[156:159], v8 offset:4096
    ds_read_b64_tr_b16 v[184:185], v213 offset:0
    ds_read_b64_tr_b16 v[186:187], v213 offset:512
    buffer_store_dwordx4 v[132:135], v1, s[32:35], s78 offen offset:3072 sc1
    v_cvt_pk_bf16_f32 v136, v64, v65
    v_cvt_pk_bf16_f32 v137, v66, v67
    v_mfma_f32_32x32x16_bf16 v[96:111], v[172:175], v[192:195], v[96:111]
    v_cvt_pk_bf16_f32 v138, v68, v69
    v_cvt_pk_bf16_f32 v139, v70, v71
    s_mov_b64 exec, s[100:101]
    v_mov_b64 v[136:137], v[228:229]
    v_mov_b64_e64 v[138:139], v[228:229]
    s_mov_b64 exec, -1
    s_waitcnt lgkmcnt(4)
    v_mfma_f32_32x32x16_bf16 v[80:95], v[176:179], v[196:199], v[80:95]
    ds_read_b128 v[160:163], v9 offset:0
    ds_read_b128 v[164:167], v9 offset:4096
    ds_read_b64_tr_b16 v[188:189], v213 offset:2048
    ds_read_b64_tr_b16 v[190:191], v213 offset:2560
    buffer_store_dwordx4 v[136:139], v1, s[32:35], s79 offen offset:2048 sc1
    v_cvt_pk_bf16_f32 v140, v72, v73
    v_cvt_pk_bf16_f32 v141, v74, v75
    v_mfma_f32_32x32x16_bf16 v[96:111], v[180:183], v[196:199], v[96:111]
    v_cvt_pk_bf16_f32 v142, v76, v77
    v_cvt_pk_bf16_f32 v143, v78, v79
    s_mov_b64 exec, s[100:101]
    v_mov_b64 v[140:141], v[228:229]
    v_mov_b64_e64 v[142:143], v[228:229]
    s_mov_b64 exec, -1
    s_waitcnt lgkmcnt(4)
    v_mfma_f32_32x32x16_bf16 v[80:95], v[152:155], v[184:187], v[80:95]
    ds_read_b128 v[168:171], v10 offset:0
    ds_read_b128 v[172:175], v10 offset:4096
    ds_read_b64_tr_b16 v[192:193], v213 offset:4096
    ds_read_b64_tr_b16 v[194:195], v213 offset:4608
    buffer_store_dwordx4 v[140:143], v1, s[32:35], s79 offen offset:3072 sc1
    v_mfma_f32_32x32x16_bf16 v[96:111], v[156:159], v[184:187], v[96:111]
    s_waitcnt lgkmcnt(4)
    s_nop 0
    v_mfma_f32_32x32x16_bf16 v[80:95], v[160:163], v[188:191], v[80:95]
    ds_read_b128 v[176:179], v11 offset:0
    ds_read_b128 v[180:183], v11 offset:4096
    ds_read_b64_tr_b16 v[196:197], v213 offset:6144
    ds_read_b64_tr_b16 v[198:199], v213 offset:6656
    v_mfma_f32_32x32x16_bf16 v[96:111], v[164:167], v[188:191], v[96:111]
    s_waitcnt lgkmcnt(4)
    v_mfma_f32_32x32x16_bf16 v[80:95], v[168:171], v[192:195], v[80:95]
    v_mfma_f32_32x32x16_bf16 v[96:111], v[172:175], v[192:195], v[96:111]
    s_waitcnt lgkmcnt(0)
    v_mfma_f32_32x32x16_bf16 v[80:95], v[176:179], v[196:199], v[80:95]
    v_mfma_f32_32x32x16_bf16 v[96:111], v[180:183], v[196:199], v[96:111]
    s_nop 10
    v_cvt_pk_bf16_f32 v112, v80, v81
    v_cvt_pk_bf16_f32 v113, v82, v83
    v_cvt_pk_bf16_f32 v114, v84, v85
    v_cvt_pk_bf16_f32 v115, v86, v87
    s_mov_b64 exec, s[100:101]
    v_mov_b64 v[112:113], v[228:229]
    v_mov_b64_e64 v[114:115], v[228:229]
    s_mov_b64 exec, -1
    buffer_store_dwordx4 v[112:115], v1, s[32:35], s80 offen offset:2048 sc1
    v_cvt_pk_bf16_f32 v116, v88, v89
    v_cvt_pk_bf16_f32 v117, v90, v91
    v_cvt_pk_bf16_f32 v118, v92, v93
    v_cvt_pk_bf16_f32 v119, v94, v95
    s_mov_b64 exec, s[100:101]
    v_mov_b64 v[116:117], v[228:229]
    v_mov_b64 v[118:119], v[228:229]
    s_mov_b64 exec, -1
    buffer_store_dwordx4 v[116:119], v1, s[32:35], s80 offen offset:3072 sc1
    v_cvt_pk_bf16_f32 v120, v96, v97
    v_cvt_pk_bf16_f32 v121, v98, v99
    v_cvt_pk_bf16_f32 v122, v100, v101
    v_cvt_pk_bf16_f32 v123, v102, v103
    s_mov_b64 exec, s[100:101]
    v_mov_b64 v[120:121], v[228:229]
    v_mov_b64 v[122:123], v[228:229]
    s_mov_b64 exec, -1
    buffer_store_dwordx4 v[120:123], v1, s[32:35], s81 offen offset:2048 sc1
    v_cvt_pk_bf16_f32 v124, v104, v105
    v_cvt_pk_bf16_f32 v125, v106, v107
    v_cvt_pk_bf16_f32 v126, v108, v109
    v_cvt_pk_bf16_f32 v127, v110, v111
    s_mov_b64 exec, s[100:101]
    v_mov_b64 v[124:125], v[228:229]
    v_mov_b64 v[126:127], v[228:229]
    s_mov_b64 exec, -1
    buffer_store_dwordx4 v[124:127], v1, s[32:35], s81 offen offset:3072 sc1
    s_branch L_GA_done
L_G_NNN:
    s_barrier
    ds_read_b128 v[112:115], v4 offset:0
    ds_read_b128 v[116:119], v4 offset:4096
    ds_read_b64_tr_b16 v[120:121], v208 offset:0
    ds_read_b64_tr_b16 v[122:123], v208 offset:512
    ds_read_b64_tr_b16 v[124:125], v209 offset:0
    ds_read_b64_tr_b16 v[126:127], v209 offset:512
    ds_read_b64_tr_b16 v[128:129], v210 offset:0
    ds_read_b64_tr_b16 v[130:131], v210 offset:512
    s_waitcnt lgkmcnt(4)
    s_nop 0
    v_mfma_f32_32x32x16_bf16 v[16:31], v[112:115], v[120:123], 0
    ds_read_b128 v[132:135], v5 offset:0
    ds_read_b128 v[136:139], v5 offset:4096
    v_mfma_f32_32x32x16_bf16 v[32:47], v[116:119], v[120:123], 0
    ds_read_b64_tr_b16 v[140:141], v208 offset:2048
    ds_read_b64_tr_b16 v[142:143], v208 offset:2560
    s_waitcnt lgkmcnt(6)
    s_nop 0
    v_mfma_f32_32x32x16_bf16 v[48:63], v[112:115], v[124:127], 0
    ds_read_b64_tr_b16 v[144:145], v209 offset:2048
    ds_read_b64_tr_b16 v[146:147], v209 offset:2560
    v_mfma_f32_32x32x16_bf16 v[64:79], v[116:119], v[124:127], 0
    ds_read_b64_tr_b16 v[148:149], v210 offset:2048
    ds_read_b64_tr_b16 v[150:151], v210 offset:2560
    s_waitcnt lgkmcnt(8)
    v_mfma_f32_32x32x16_bf16 v[80:95], v[112:115], v[128:131], 0
    v_mfma_f32_32x32x16_bf16 v[96:111], v[116:119], v[128:131], 0
    s_waitcnt lgkmcnt(4)
    v_mfma_f32_32x32x16_bf16 v[16:31], v[132:135], v[140:143], v[16:31]
    ds_read_b128 v[112:115], v6 offset:0
    ds_read_b128 v[116:119], v6 offset:4096
    v_mfma_f32_32x32x16_bf16 v[32:47], v[136:139], v[140:143], v[32:47]
    ds_read_b64_tr_b16 v[120:121], v208 offset:4096
    ds_read_b64_tr_b16 v[122:123], v208 offset:4608
    s_waitcnt lgkmcnt(6)
    s_nop 0
    v_mfma_f32_32x32x16_bf16 v[48:63], v[132:135], v[144:147], v[48:63]
    ds_read_b64_tr_b16 v[124:125], v209 offset:4096
    ds_read_b64_tr_b16 v[126:127], v209 offset:4608
    v_mfma_f32_32x32x16_bf16 v[64:79], v[136:139], v[144:147], v[64:79]
    ds_read_b64_tr_b16 v[128:129], v210 offset:4096
    ds_read_b64_tr_b16 v[130:131], v210 offset:4608
    s_waitcnt lgkmcnt(8)
    v_mfma_f32_32x32x16_bf16 v[80:95], v[132:135], v[148:151], v[80:95]
    v_mfma_f32_32x32x16_bf16 v[96:111], v[136:139], v[148:151], v[96:111]
    s_waitcnt lgkmcnt(4)
    v_mfma_f32_32x32x16_bf16 v[16:31], v[112:115], v[120:123], v[16:31]
    ds_read_b128 v[132:135], v7 offset:0
    ds_read_b128 v[136:139], v7 offset:4096
    v_mfma_f32_32x32x16_bf16 v[32:47], v[116:119], v[120:123], v[32:47]
    ds_read_b64_tr_b16 v[140:141], v208 offset:6144
    ds_read_b64_tr_b16 v[142:143], v208 offset:6656
    s_waitcnt lgkmcnt(6)
    s_nop 0
    v_mfma_f32_32x32x16_bf16 v[48:63], v[112:115], v[124:127], v[48:63]
    ds_read_b64_tr_b16 v[144:145], v209 offset:6144
    ds_read_b64_tr_b16 v[146:147], v209 offset:6656
    v_mfma_f32_32x32x16_bf16 v[64:79], v[116:119], v[124:127], v[64:79]
    ds_read_b64_tr_b16 v[148:149], v210 offset:6144
    ds_read_b64_tr_b16 v[150:151], v210 offset:6656
    s_waitcnt lgkmcnt(8)
    v_mfma_f32_32x32x16_bf16 v[80:95], v[112:115], v[128:131], v[80:95]
    v_mfma_f32_32x32x16_bf16 v[96:111], v[116:119], v[128:131], v[96:111]
    s_waitcnt lgkmcnt(4)
    v_mfma_f32_32x32x16_bf16 v[16:31], v[132:135], v[140:143], v[16:31]
    v_mfma_f32_32x32x16_bf16 v[32:47], v[136:139], v[140:143], v[32:47]
    s_waitcnt lgkmcnt(2)
    v_mfma_f32_32x32x16_bf16 v[48:63], v[132:135], v[144:147], v[48:63]
    v_mfma_f32_32x32x16_bf16 v[64:79], v[136:139], v[144:147], v[64:79]
    s_waitcnt lgkmcnt(0)
    s_barrier
    s_nop 0
    ds_read_b128 v[112:115], v4 offset:53248
    ds_read_b128 v[116:119], v4 offset:57344
    ds_read_b64_tr_b16 v[120:121], v208 offset:53248
    ds_read_b64_tr_b16 v[122:123], v208 offset:53760
    v_mfma_f32_32x32x16_bf16 v[80:95], v[132:135], v[148:151], v[80:95]
    ds_read_b64_tr_b16 v[124:125], v209 offset:53248
    ds_read_b64_tr_b16 v[126:127], v209 offset:53760
    v_mfma_f32_32x32x16_bf16 v[96:111], v[136:139], v[148:151], v[96:111]
    ds_read_b64_tr_b16 v[128:129], v210 offset:53248
    ds_read_b64_tr_b16 v[130:131], v210 offset:53760
    s_waitcnt lgkmcnt(4)
    s_nop 0
    v_mfma_f32_32x32x16_bf16 v[16:31], v[112:115], v[120:123], v[16:31]
    ds_read_b128 v[132:135], v5 offset:53248
    ds_read_b128 v[136:139], v5 offset:57344
    v_mfma_f32_32x32x16_bf16 v[32:47], v[116:119], v[120:123], v[32:47]
    ds_read_b64_tr_b16 v[140:141], v208 offset:55296
    ds_read_b64_tr_b16 v[142:143], v208 offset:55808
    s_waitcnt lgkmcnt(6)
    s_nop 0
    v_mfma_f32_32x32x16_bf16 v[48:63], v[112:115], v[124:127], v[48:63]
    ds_read_b64_tr_b16 v[144:145], v209 offset:55296
    ds_read_b64_tr_b16 v[146:147], v209 offset:55808
    v_mfma_f32_32x32x16_bf16 v[64:79], v[116:119], v[124:127], v[64:79]
    ds_read_b64_tr_b16 v[148:149], v210 offset:55296
    ds_read_b64_tr_b16 v[150:151], v210 offset:55808
    s_waitcnt lgkmcnt(8)
    v_mfma_f32_32x32x16_bf16 v[80:95], v[112:115], v[128:131], v[80:95]
    v_mfma_f32_32x32x16_bf16 v[96:111], v[116:119], v[128:131], v[96:111]
    s_waitcnt lgkmcnt(4)
    v_mfma_f32_32x32x16_bf16 v[16:31], v[132:135], v[140:143], v[16:31]
    ds_read_b128 v[112:115], v6 offset:53248
    ds_read_b128 v[116:119], v6 offset:57344
    v_mfma_f32_32x32x16_bf16 v[32:47], v[136:139], v[140:143], v[32:47]
    ds_read_b64_tr_b16 v[120:121], v208 offset:57344
    ds_read_b64_tr_b16 v[122:123], v208 offset:57856
    s_waitcnt lgkmcnt(6)
    s_nop 0
    v_mfma_f32_32x32x16_bf16 v[48:63], v[132:135], v[144:147], v[48:63]
    ds_read_b64_tr_b16 v[124:125], v209 offset:57344
    ds_read_b64_tr_b16 v[126:127], v209 offset:57856
    v_mfma_f32_32x32x16_bf16 v[64:79], v[136:139], v[144:147], v[64:79]
    ds_read_b64_tr_b16 v[128:129], v210 offset:57344
    ds_read_b64_tr_b16 v[130:131], v210 offset:57856
    s_waitcnt lgkmcnt(8)
    v_mfma_f32_32x32x16_bf16 v[80:95], v[132:135], v[148:151], v[80:95]
    v_mfma_f32_32x32x16_bf16 v[96:111], v[136:139], v[148:151], v[96:111]
    s_waitcnt lgkmcnt(4)
    v_mfma_f32_32x32x16_bf16 v[16:31], v[112:115], v[120:123], v[16:31]
    ds_read_b128 v[132:135], v7 offset:53248
    ds_read_b128 v[136:139], v7 offset:57344
    v_mfma_f32_32x32x16_bf16 v[32:47], v[116:119], v[120:123], v[32:47]
    ds_read_b64_tr_b16 v[140:141], v208 offset:59392
    ds_read_b64_tr_b16 v[142:143], v208 offset:59904
    s_waitcnt lgkmcnt(6)
    s_nop 0
    v_mfma_f32_32x32x16_bf16 v[48:63], v[112:115], v[124:127], v[48:63]
    ds_read_b64_tr_b16 v[144:145], v209 offset:59392
    ds_read_b64_tr_b16 v[146:147], v209 offset:59904
    v_mfma_f32_32x32x16_bf16 v[64:79], v[116:119], v[124:127], v[64:79]
    ds_read_b64_tr_b16 v[148:149], v210 offset:59392
    ds_read_b64_tr_b16 v[150:151], v210 offset:59904
    s_waitcnt lgkmcnt(8)
    v_mfma_f32_32x32x16_bf16 v[80:95], v[112:115], v[128:131], v[80:95]
    v_mfma_f32_32x32x16_bf16 v[96:111], v[116:119], v[128:131], v[96:111]
    s_waitcnt lgkmcnt(4)
    v_mfma_f32_32x32x16_bf16 v[16:31], v[132:135], v[140:143], v[16:31]
    v_mfma_f32_32x32x16_bf16 v[32:47], v[136:139], v[140:143], v[32:47]
    s_waitcnt lgkmcnt(2)
    v_mfma_f32_32x32x16_bf16 v[48:63], v[132:135], v[144:147], v[48:63]
    v_mfma_f32_32x32x16_bf16 v[64:79], v[136:139], v[144:147], v[64:79]
    s_waitcnt lgkmcnt(0)
    s_barrier
    s_nop 0
    ds_read_b128 v[112:115], v8 offset:0
    ds_read_b128 v[116:119], v8 offset:4096
    ds_read_b64_tr_b16 v[120:121], v211 offset:0
    ds_read_b64_tr_b16 v[122:123], v211 offset:512
    v_mfma_f32_32x32x16_bf16 v[80:95], v[132:135], v[148:151], v[80:95]
    ds_read_b64_tr_b16 v[124:125], v212 offset:0
    ds_read_b64_tr_b16 v[126:127], v212 offset:512
    v_mfma_f32_32x32x16_bf16 v[96:111], v[136:139], v[148:151], v[96:111]
    ds_read_b64_tr_b16 v[128:129], v213 offset:0
    ds_read_b64_tr_b16 v[130:131], v213 offset:512
    s_waitcnt lgkmcnt(4)
    s_nop 0
    v_mfma_f32_32x32x16_bf16 v[16:31], v[112:115], v[120:123], v[16:31]
    ds_read_b128 v[132:135], v9 offset:0
    ds_read_b128 v[136:139], v9 offset:4096
    v_mfma_f32_32x32x16_bf16 v[32:47], v[116:119], v[120:123], v[32:47]
    ds_read_b64_tr_b16 v[140:141], v211 offset:2048
    ds_read_b64_tr_b16 v[142:143], v211 offset:2560
    s_waitcnt lgkmcnt(6)
    s_nop 0
    v_mfma_f32_32x32x16_bf16 v[48:63], v[112:115], v[124:127], v[48:63]
    ds_read_b64_tr_b16 v[144:145], v212 offset:2048
    ds_read_b64_tr_b16 v[146:147], v212 offset:2560
    v_mfma_f32_32x32x16_bf16 v[64:79], v[116:119], v[124:127], v[64:79]
    ds_read_b64_tr_b16 v[148:149], v213 offset:2048
    ds_read_b64_tr_b16 v[150:151], v213 offset:2560
    s_waitcnt lgkmcnt(8)
    v_mfma_f32_32x32x16_bf16 v[80:95], v[112:115], v[128:131], v[80:95]
    v_mfma_f32_32x32x16_bf16 v[96:111], v[116:119], v[128:131], v[96:111]
    s_waitcnt lgkmcnt(4)
    v_mfma_f32_32x32x16_bf16 v[16:31], v[132:135], v[140:143], v[16:31]
    ds_read_b128 v[112:115], v10 offset:0
    ds_read_b128 v[116:119], v10 offset:4096
    v_mfma_f32_32x32x16_bf16 v[32:47], v[136:139], v[140:143], v[32:47]
    ds_read_b64_tr_b16 v[120:121], v211 offset:4096
    ds_read_b64_tr_b16 v[122:123], v211 offset:4608
    s_waitcnt lgkmcnt(6)
    s_nop 0
    v_mfma_f32_32x32x16_bf16 v[48:63], v[132:135], v[144:147], v[48:63]
    ds_read_b64_tr_b16 v[124:125], v212 offset:4096
    ds_read_b64_tr_b16 v[126:127], v212 offset:4608
    v_mfma_f32_32x32x16_bf16 v[64:79], v[136:139], v[144:147], v[64:79]
    ds_read_b64_tr_b16 v[128:129], v213 offset:4096
    ds_read_b64_tr_b16 v[130:131], v213 offset:4608
    s_waitcnt lgkmcnt(8)
    v_mfma_f32_32x32x16_bf16 v[80:95], v[132:135], v[148:151], v[80:95]
    v_mfma_f32_32x32x16_bf16 v[96:111], v[136:139], v[148:151], v[96:111]
    s_waitcnt lgkmcnt(4)
    v_mfma_f32_32x32x16_bf16 v[16:31], v[112:115], v[120:123], v[16:31]
    ds_read_b128 v[132:135], v11 offset:0
    ds_read_b128 v[136:139], v11 offset:4096
    v_mfma_f32_32x32x16_bf16 v[32:47], v[116:119], v[120:123], v[32:47]
    ds_read_b64_tr_b16 v[140:141], v211 offset:6144
    ds_read_b64_tr_b16 v[142:143], v211 offset:6656
    s_waitcnt lgkmcnt(6)
    s_nop 0
    v_mfma_f32_32x32x16_bf16 v[48:63], v[112:115], v[124:127], v[48:63]
    ds_read_b64_tr_b16 v[144:145], v212 offset:6144
    ds_read_b64_tr_b16 v[146:147], v212 offset:6656
    v_mfma_f32_32x32x16_bf16 v[64:79], v[116:119], v[124:127], v[64:79]
    ds_read_b64_tr_b16 v[148:149], v213 offset:6144
    ds_read_b64_tr_b16 v[150:151], v213 offset:6656
    s_waitcnt lgkmcnt(8)
    v_mfma_f32_32x32x16_bf16 v[80:95], v[112:115], v[128:131], v[80:95]
    v_mfma_f32_32x32x16_bf16 v[96:111], v[116:119], v[128:131], v[96:111]
    s_waitcnt lgkmcnt(4)
    v_mfma_f32_32x32x16_bf16 v[16:31], v[132:135], v[140:143], v[16:31]
    v_mfma_f32_32x32x16_bf16 v[32:47], v[136:139], v[140:143], v[32:47]
    s_waitcnt lgkmcnt(2)
    v_mfma_f32_32x32x16_bf16 v[48:63], v[132:135], v[144:147], v[48:63]
    v_mfma_f32_32x32x16_bf16 v[64:79], v[136:139], v[144:147], v[64:79]
    s_waitcnt lgkmcnt(0)
    s_barrier
    s_nop 0
    ds_read_b128 v[112:115], v4 offset:0
    ds_read_b128 v[116:119], v4 offset:4096
    ds_read_b64_tr_b16 v[120:121], v208 offset:0
    ds_read_b64_tr_b16 v[122:123], v208 offset:512
    v_mfma_f32_32x32x16_bf16 v[80:95], v[132:135], v[148:151], v[80:95]
    ds_read_b64_tr_b16 v[124:125], v209 offset:0
    ds_read_b64_tr_b16 v[126:127], v209 offset:512
    v_mfma_f32_32x32x16_bf16 v[96:111], v[136:139], v[148:151], v[96:111]
    ds_read_b64_tr_b16 v[128:129], v210 offset:0
    ds_read_b64_tr_b16 v[130:131], v210 offset:512
    s_waitcnt lgkmcnt(4)
    s_nop 0
    v_mfma_f32_32x32x16_bf16 v[16:31], v[112:115], v[120:123], v[16:31]
    ds_read_b128 v[132:135], v5 offset:0
    ds_read_b128 v[136:139], v5 offset:4096
    v_mfma_f32_32x32x16_bf16 v[32:47], v[116:119], v[120:123], v[32:47]
    ds_read_b64_tr_b16 v[140:141], v208 offset:2048
    ds_read_b64_tr_b16 v[142:143], v208 offset:2560
    s_waitcnt lgkmcnt(6)
    s_nop 0
    v_mfma_f32_32x32x16_bf16 v[48:63], v[112:115], v[124:127], v[48:63]
    ds_read_b64_tr_b16 v[144:145], v209 offset:2048
    ds_read_b64_tr_b16 v[146:147], v209 offset:2560
    v_mfma_f32_32x32x16_bf16 v[64:79], v[116:119], v[124:127], v[64:79]
    ds_read_b64_tr_b16 v[148:149], v210 offset:2048
    ds_read_b64_tr_b16 v[150:151], v210 offset:2560
    s_waitcnt lgkmcnt(8)
    v_mfma_f32_32x32x16_bf16 v[80:95], v[112:115], v[128:131], v[80:95]
    v_mfma_f32_32x32x16_bf16 v[96:111], v[116:119], v[128:131], v[96:111]
    s_waitcnt lgkmcnt(4)
    v_mfma_f32_32x32x16_bf16 v[16:31], v[132:135], v[140:143], v[16:31]
    ds_read_b128 v[112:115], v6 offset:0
    ds_read_b128 v[116:119], v6 offset:4096
    v_mfma_f32_32x32x16_bf16 v[32:47], v[136:139], v[140:143], v[32:47]
    ds_read_b64_tr_b16 v[120:121], v208 offset:4096
    ds_read_b64_tr_b16 v[122:123], v208 offset:4608
    s_waitcnt lgkmcnt(6)
    s_nop 0
    v_mfma_f32_32x32x16_bf16 v[48:63], v[132:135], v[144:147], v[48:63]
    ds_read_b64_tr_b16 v[124:125], v209 offset:4096
    ds_read_b64_tr_b16 v[126:127], v209 offset:4608
    v_mfma_f32_32x32x16_bf16 v[64:79], v[136:139], v[144:147], v[64:79]
    ds_read_b64_tr_b16 v[128:129], v210 offset:4096
    ds_read_b64_tr_b16 v[130:131], v210 offset:4608
    s_waitcnt lgkmcnt(8)
    v_mfma_f32_32x32x16_bf16 v[80:95], v[132:135], v[148:151], v[80:95]
    v_mfma_f32_32x32x16_bf16 v[96:111], v[136:139], v[148:151], v[96:111]
    s_waitcnt lgkmcnt(4)
    v_mfma_f32_32x32x16_bf16 v[16:31], v[112:115], v[120:123], v[16:31]
    ds_read_b128 v[132:135], v7 offset:0
    ds_read_b128 v[136:139], v7 offset:4096
    v_mfma_f32_32x32x16_bf16 v[32:47], v[116:119], v[120:123], v[32:47]
    ds_read_b64_tr_b16 v[140:141], v208 offset:6144
    ds_read_b64_tr_b16 v[142:143], v208 offset:6656
    s_waitcnt lgkmcnt(6)
    s_nop 0
    v_mfma_f32_32x32x16_bf16 v[48:63], v[112:115], v[124:127], v[48:63]
    ds_read_b64_tr_b16 v[144:145], v209 offset:6144
    ds_read_b64_tr_b16 v[146:147], v209 offset:6656
    v_mfma_f32_32x32x16_bf16 v[64:79], v[116:119], v[124:127], v[64:79]
    ds_read_b64_tr_b16 v[148:149], v210 offset:6144
    ds_read_b64_tr_b16 v[150:151], v210 offset:6656
    s_waitcnt lgkmcnt(8)
    v_mfma_f32_32x32x16_bf16 v[80:95], v[112:115], v[128:131], v[80:95]
    v_mfma_f32_32x32x16_bf16 v[96:111], v[116:119], v[128:131], v[96:111]
    s_waitcnt lgkmcnt(4)
    v_mfma_f32_32x32x16_bf16 v[16:31], v[132:135], v[140:143], v[16:31]
    v_mfma_f32_32x32x16_bf16 v[32:47], v[136:139], v[140:143], v[32:47]
    s_waitcnt lgkmcnt(2)
    v_mfma_f32_32x32x16_bf16 v[48:63], v[132:135], v[144:147], v[48:63]
    v_mfma_f32_32x32x16_bf16 v[64:79], v[136:139], v[144:147], v[64:79]
    s_waitcnt lgkmcnt(0)
    s_barrier
    s_nop 0
    ds_read_b128 v[112:115], v4 offset:53248
    ds_read_b128 v[116:119], v4 offset:57344
    ds_read_b64_tr_b16 v[120:121], v208 offset:53248
    ds_read_b64_tr_b16 v[122:123], v208 offset:53760
    v_mfma_f32_32x32x16_bf16 v[80:95], v[132:135], v[148:151], v[80:95]
    ds_read_b64_tr_b16 v[124:125], v209 offset:53248
    ds_read_b64_tr_b16 v[126:127], v209 offset:53760
    v_mfma_f32_32x32x16_bf16 v[96:111], v[136:139], v[148:151], v[96:111]
    ds_read_b64_tr_b16 v[128:129], v210 offset:53248
    ds_read_b64_tr_b16 v[130:131], v210 offset:53760
    s_waitcnt lgkmcnt(4)
    s_nop 0
    v_mfma_f32_32x32x16_bf16 v[16:31], v[112:115], v[120:123], v[16:31]
    ds_read_b128 v[132:135], v5 offset:53248
    ds_read_b128 v[136:139], v5 offset:57344
    v_mfma_f32_32x32x16_bf16 v[32:47], v[116:119], v[120:123], v[32:47]
    ds_read_b64_tr_b16 v[140:141], v208 offset:55296
    ds_read_b64_tr_b16 v[142:143], v208 offset:55808
    s_waitcnt lgkmcnt(6)
    s_nop 0
    v_mfma_f32_32x32x16_bf16 v[48:63], v[112:115], v[124:127], v[48:63]
    ds_read_b64_tr_b16 v[144:145], v209 offset:55296
    ds_read_b64_tr_b16 v[146:147], v209 offset:55808
    v_mfma_f32_32x32x16_bf16 v[64:79], v[116:119], v[124:127], v[64:79]
    ds_read_b64_tr_b16 v[148:149], v210 offset:55296
    ds_read_b64_tr_b16 v[150:151], v210 offset:55808
    s_waitcnt lgkmcnt(8)
    v_mfma_f32_32x32x16_bf16 v[80:95], v[112:115], v[128:131], v[80:95]
    v_mfma_f32_32x32x16_bf16 v[96:111], v[116:119], v[128:131], v[96:111]
    s_waitcnt lgkmcnt(4)
    v_mfma_f32_32x32x16_bf16 v[16:31], v[132:135], v[140:143], v[16:31]
    ds_read_b128 v[112:115], v6 offset:53248
    ds_read_b128 v[116:119], v6 offset:57344
    v_mfma_f32_32x32x16_bf16 v[32:47], v[136:139], v[140:143], v[32:47]
    ds_read_b64_tr_b16 v[120:121], v208 offset:57344
    ds_read_b64_tr_b16 v[122:123], v208 offset:57856
    s_waitcnt lgkmcnt(6)
    s_nop 0
    v_mfma_f32_32x32x16_bf16 v[48:63], v[132:135], v[144:147], v[48:63]
    ds_read_b64_tr_b16 v[124:125], v209 offset:57344
    ds_read_b64_tr_b16 v[126:127], v209 offset:57856
    v_mfma_f32_32x32x16_bf16 v[64:79], v[136:139], v[144:147], v[64:79]
    ds_read_b64_tr_b16 v[128:129], v210 offset:57344
    ds_read_b64_tr_b16 v[130:131], v210 offset:57856
    s_waitcnt lgkmcnt(8)
    v_mfma_f32_32x32x16_bf16 v[80:95], v[132:135], v[148:151], v[80:95]
    v_mfma_f32_32x32x16_bf16 v[96:111], v[136:139], v[148:151], v[96:111]
    s_waitcnt lgkmcnt(4)
    v_mfma_f32_32x32x16_bf16 v[16:31], v[112:115], v[120:123], v[16:31]
    ds_read_b128 v[132:135], v7 offset:53248
    ds_read_b128 v[136:139], v7 offset:57344
    v_mfma_f32_32x32x16_bf16 v[32:47], v[116:119], v[120:123], v[32:47]
    ds_read_b64_tr_b16 v[140:141], v208 offset:59392
    ds_read_b64_tr_b16 v[142:143], v208 offset:59904
    s_waitcnt lgkmcnt(6)
    s_nop 0
    v_mfma_f32_32x32x16_bf16 v[48:63], v[112:115], v[124:127], v[48:63]
    ds_read_b64_tr_b16 v[144:145], v209 offset:59392
    ds_read_b64_tr_b16 v[146:147], v209 offset:59904
    v_mfma_f32_32x32x16_bf16 v[64:79], v[116:119], v[124:127], v[64:79]
    ds_read_b64_tr_b16 v[148:149], v210 offset:59392
    ds_read_b64_tr_b16 v[150:151], v210 offset:59904
    s_waitcnt lgkmcnt(8)
    v_mfma_f32_32x32x16_bf16 v[80:95], v[112:115], v[128:131], v[80:95]
    v_mfma_f32_32x32x16_bf16 v[96:111], v[116:119], v[128:131], v[96:111]
    s_waitcnt lgkmcnt(4)
    v_mfma_f32_32x32x16_bf16 v[16:31], v[132:135], v[140:143], v[16:31]
    v_mfma_f32_32x32x16_bf16 v[32:47], v[136:139], v[140:143], v[32:47]
    s_waitcnt lgkmcnt(2)
    v_mfma_f32_32x32x16_bf16 v[48:63], v[132:135], v[144:147], v[48:63]
    v_mfma_f32_32x32x16_bf16 v[64:79], v[136:139], v[144:147], v[64:79]
    s_waitcnt lgkmcnt(0)
    s_barrier
    s_nop 0
    ds_read_b128 v[112:115], v8 offset:0
    ds_read_b128 v[116:119], v8 offset:4096
    v_mfma_f32_32x32x16_bf16 v[80:95], v[132:135], v[148:151], v[80:95]
    ds_read_b64_tr_b16 v[120:121], v211 offset:0
    ds_read_b64_tr_b16 v[122:123], v211 offset:512
    v_mfma_f32_32x32x16_bf16 v[96:111], v[136:139], v[148:151], v[96:111]
    ds_read_b64_tr_b16 v[124:125], v212 offset:0
    ds_read_b64_tr_b16 v[126:127], v212 offset:512
    s_waitcnt lgkmcnt(2)
    s_nop 0
    v_mfma_f32_32x32x16_bf16 v[16:31], v[112:115], v[120:123], v[16:31]
    ds_read_b128 v[132:135], v9 offset:0
    ds_read_b128 v[136:139], v9 offset:4096
    v_mfma_f32_32x32x16_bf16 v[32:47], v[116:119], v[120:123], v[32:47]
    ds_read_b64_tr_b16 v[140:141], v211 offset:2048
    ds_read_b64_tr_b16 v[142:143], v211 offset:2560
    s_waitcnt lgkmcnt(4)
    v_mfma_f32_32x32x16_bf16 v[48:63], v[112:115], v[124:127], v[48:63]
    ds_read_b64_tr_b16 v[144:145], v212 offset:2048
    ds_read_b64_tr_b16 v[146:147], v212 offset:2560
    v_mfma_f32_32x32x16_bf16 v[64:79], v[116:119], v[124:127], v[64:79]
    s_waitcnt lgkmcnt(2)
    v_mfma_f32_32x32x16_bf16 v[16:31], v[132:135], v[140:143], v[16:31]
    ds_read_b128 v[112:115], v10 offset:0
    ds_read_b128 v[116:119], v10 offset:4096
    v_mfma_f32_32x32x16_bf16 v[32:47], v[136:139], v[140:143], v[32:47]
    ds_read_b64_tr_b16 v[120:121], v211 offset:4096
    ds_read_b64_tr_b16 v[122:123], v211 offset:4608
    s_waitcnt lgkmcnt(4)
    v_mfma_f32_32x32x16_bf16 v[48:63], v[132:135], v[144:147], v[48:63]
    ds_read_b64_tr_b16 v[124:125], v212 offset:4096
    ds_read_b64_tr_b16 v[126:127], v212 offset:4608
    v_mfma_f32_32x32x16_bf16 v[64:79], v[136:139], v[144:147], v[64:79]
    s_waitcnt lgkmcnt(2)
    v_mfma_f32_32x32x16_bf16 v[16:31], v[112:115], v[120:123], v[16:31]
    ds_read_b128 v[132:135], v11 offset:0
    ds_read_b128 v[136:139], v11 offset:4096
    v_mfma_f32_32x32x16_bf16 v[32:47], v[116:119], v[120:123], v[32:47]
    ds_read_b64_tr_b16 v[140:141], v211 offset:6144
    ds_read_b64_tr_b16 v[142:143], v211 offset:6656
    s_waitcnt lgkmcnt(4)
    v_mfma_f32_32x32x16_bf16 v[48:63], v[112:115], v[124:127], v[48:63]
    ds_read_b64_tr_b16 v[144:145], v212 offset:6144
    ds_read_b64_tr_b16 v[146:147], v212 offset:6656
    v_mfma_f32_32x32x16_bf16 v[64:79], v[116:119], v[124:127], v[64:79]
    s_waitcnt lgkmcnt(2)
    v_mfma_f32_32x32x16_bf16 v[16:31], v[132:135], v[140:143], v[16:31]
    v_mfma_f32_32x32x16_bf16 v[32:47], v[136:139], v[140:143], v[32:47]
    s_waitcnt lgkmcnt(0)
    s_barrier
    ds_read_b128 v[152:155], v4 offset:0
    ds_read_b128 v[156:159], v4 offset:4096
    ds_read_b64_tr_b16 v[184:185], v208 offset:0
    ds_read_b64_tr_b16 v[186:187], v208 offset:512
    v_mfma_f32_32x32x16_bf16 v[48:63], v[132:135], v[144:147], v[48:63]
    ds_read_b128 v[160:163], v5 offset:0
    ds_read_b128 v[164:167], v5 offset:4096
    ds_read_b64_tr_b16 v[188:189], v208 offset:2048
    ds_read_b64_tr_b16 v[190:191], v208 offset:2560
    v_mfma_f32_32x32x16_bf16 v[64:79], v[136:139], v[144:147], v[64:79]
    s_waitcnt lgkmcnt(4)
    s_nop 0
    v_mfma_f32_32x32x16_bf16 v[16:31], v[152:155], v[184:187], v[16:31]
    ds_read_b128 v[168:171], v6 offset:0
    ds_read_b128 v[172:175], v6 offset:4096
    ds_read_b64_tr_b16 v[192:193], v208 offset:4096
    ds_read_b64_tr_b16 v[194:195], v208 offset:4608
    v_mfma_f32_32x32x16_bf16 v[32:47], v[156:159], v[184:187], v[32:47]
    s_waitcnt lgkmcnt(4)
    s_nop 0
    v_mfma_f32_32x32x16_bf16 v[16:31], v[160:163], v[188:191], v[16:31]
    ds_read_b128 v[176:179], v7 offset:0
    ds_read_b128 v[180:183], v7 offset:4096
    ds_read_b64_tr_b16 v[196:197], v208 offset:6144
    ds_read_b64_tr_b16 v[198:199], v208 offset:6656
    v_mfma_f32_32x32x16_bf16 v[32:47], v[164:167], v[188:191], v[32:47]
    s_waitcnt lgkmcnt(4)
    v_mfma_f32_32x32x16_bf16 v[16:31], v[168:171], v[192:195], v[16:31]
    s_barrier
    ds_read_b64_tr_b16 v[184:185], v209 offset:0
    ds_read_b64_tr_b16 v[186:187], v209 offset:512
    v_mfma_f32_32x32x16_bf16 v[32:47], v[172:175], v[192:195], v[32:47]
    s_waitcnt lgkmcnt(2)
    v_mfma_f32_32x32x16_bf16 v[16:31], v[176:179], v[196:199], v[16:31]
    ds_read_b64_tr_b16 v[188:189], v209 offset:2048
    ds_read_b64_tr_b16 v[190:191], v209 offset:2560
    v_mfma_f32_32x32x16_bf16 v[32:47], v[180:183], v[196:199], v[32:47]
    s_waitcnt lgkmcnt(2)
    v_mfma_f32_32x32x16_bf16 v[48:63], v[152:155], v[184:187], v[48:63]
    ds_read_b64_tr_b16 v[192:193], v209 offset:4096
    ds_read_b64_tr_b16 v[194:195], v209 offset:4608
    s_nop 6
    s_nop 0
    v_cvt_pk_bf16_f32 v112, v16, v17
    v_cvt_pk_bf16_f32 v113, v18, v19
    v_mfma_f32_32x32x16_bf16 v[64:79], v[156:159], v[184:187], v[64:79]
    v_cvt_pk_bf16_f32 v114, v20, v21
    v_cvt_pk_bf16_f32 v115, v22, v23
    s_mov_b64 exec, s[100:101]
    v_mov_b64 v[112:113], v[228:229]
    v_mov_b64_e64 v[114:115], v[228:229]
    s_mov_b64 exec, -1
    s_waitcnt lgkmcnt(2)
    v_mfma_f32_32x32x16_bf16 v[48:63], v[160:163], v[188:191], v[48:63]
    ds_read_b64_tr_b16 v[196:197], v209 offset:6144
    ds_read_b64_tr_b16 v[198:199], v209 offset:6656
    buffer_store_dwordx4 v[112:115], v1, s[32:35], s76 offen offset:2048 sc1
    v_cvt_pk_bf16_f32 v116, v24, v25
    v_cvt_pk_bf16_f32 v117, v26, v27
    v_mfma_f32_32x32x16_bf16 v[64:79], v[164:167], v[188:191], v[64:79]
    v_cvt_pk_bf16_f32 v118, v28, v29
    v_cvt_pk_bf16_f32 v119, v30, v31
    s_mov_b64 exec, s[100:101]
    v_mov_b64 v[116:117], v[228:229]
    v_mov_b64 v[118:119], v[228:229]
    s_mov_b64 exec, -1
    s_waitcnt lgkmcnt(2)
    v_mfma_f32_32x32x16_bf16 v[48:63], v[168:171], v[192:195], v[48:63]
    s_barrier
    buffer_load_dwordx4 v[248:251], off, s[36:39], 0 sc1
    ds_read_b64_tr_b16 v[184:185], v210 offset:0
    ds_read_b64_tr_b16 v[186:187], v210 offset:512
    buffer_store_dwordx4 v[116:119], v1, s[32:35], s76 offen offset:3072 sc1
    v_cvt_pk_bf16_f32 v120, v32, v33
    v_cvt_pk_bf16_f32 v121, v34, v35
    v_mfma_f32_32x32x16_bf16 v[64:79], v[172:175], v[192:195], v[64:79]
    v_cvt_pk_bf16_f32 v122, v36, v37
    v_cvt_pk_bf16_f32 v123, v38, v39
    s_mov_b64 exec, s[100:101]
    v_mov_b64 v[120:121], v[228:229]
    v_mov_b64_e64 v[122:123], v[228:229]
    s_mov_b64 exec, -1
    s_waitcnt lgkmcnt(2)
    v_mfma_f32_32x32x16_bf16 v[48:63], v[176:179], v[196:199], v[48:63]
    ds_read_b64_tr_b16 v[188:189], v210 offset:2048
    ds_read_b64_tr_b16 v[190:191], v210 offset:2560
    buffer_store_dwordx4 v[120:123], v1, s[32:35], s77 offen offset:2048 sc1
    v_cvt_pk_bf16_f32 v124, v40, v41
    v_cvt_pk_bf16_f32 v125, v42, v43
    v_mfma_f32_32x32x16_bf16 v[64:79], v[180:183], v[196:199], v[64:79]
    v_cvt_pk_bf16_f32 v126, v44, v45
    v_cvt_pk_bf16_f32 v127, v46, v47
    s_mov_b64 exec, s[100:101]
    v_mov_b64 v[124:125], v[228:229]
    v_mov_b64 v[126:127], v[228:229]
    s_mov_b64 exec, -1
    s_waitcnt lgkmcnt(2)
    v_mfma_f32_32x32x16_bf16 v[80:95], v[152:155], v[184:187], v[80:95]
    ds_read_b64_tr_b16 v[192:193], v210 offset:4096
    ds_read_b64_tr_b16 v[194:195], v210 offset:4608
    buffer_store_dwordx4 v[124:127], v1, s[32:35], s77 offen offset:3072 sc1
    s_nop 6
    v_cvt_pk_bf16_f32 v128, v48, v49
    v_mfma_f32_32x32x16_bf16 v[96:111], v[156:159], v[184:187], v[96:111]
    v_cvt_pk_bf16_f32 v129, v50, v51
    v_cvt_pk_bf16_f32 v130, v52, v53
    v_cvt_pk_bf16_f32 v131, v54, v55
    s_mov_b64 exec, s[100:101]
    v_mov_b64 v[128:129], v[228:229]
    v_mov_b64_e64 v[130:131], v[228:229]
    s_mov_b64 exec, -1
    s_waitcnt lgkmcnt(2)
    v_mfma_f32_32x32x16_bf16 v[80:95], v[160:163], v[188:191], v[80:95]
    ds_read_b64_tr_b16 v[196:197], v210 offset:6144
    ds_read_b64_tr_b16 v[198:199], v210 offset:6656
    buffer_store_dwordx4 v[128:131], v1, s[32:35], s78 offen offset:2048 sc1
    v_cvt_pk_bf16_f32 v132, v56, v57
    v_cvt_pk_bf16_f32 v133, v58, v59
    v_mfma_f32_32x32x16_bf16 v[96:111], v[164:167], v[188:191], v[96:111]
    v_cvt_pk_bf16_f32 v134, v60, v61
    v_cvt_pk_bf16_f32 v135, v62, v63
    s_mov_b64 exec, s[100:101]
    v_mov_b64 v[132:133], v[228:229]
    v_mov_b64_e64 v[134:135], v[228:229]
    s_mov_b64 exec, -1
    s_waitcnt lgkmcnt(2)
    v_mfma_f32_32x32x16_bf16 v[80:95], v[168:171], v[192:195], v[80:95]
    ds_read_b128 v[152:155], v8 offset:0
    ds_read_b128 v[156:159], v8 offset:4096
    ds_read_b64_tr_b16 v[184:185], v213 offset:0
    ds_read_b64_tr_b16 v[186:187], v213 offset:512
    buffer_store_dwordx4 v[132:135], v1, s[32:35], s78 offen offset:3072 sc1
    v_cvt_pk_bf16_f32 v136, v64, v65
    v_cvt_pk_bf16_f32 v137, v66, v67
    v_mfma_f32_32x32x16_bf16 v[96:111], v[172:175], v[192:195], v[96:111]
    v_cvt_pk_bf16_f32 v138, v68, v69
    v_cvt_pk_bf16_f32 v139, v70, v71
    s_mov_b64 exec, s[100:101]
    v_mov_b64 v[136:137], v[228:229]
    v_mov_b64_e64 v[138:139], v[228:229]
    s_mov_b64 exec, -1
    s_waitcnt lgkmcnt(4)
    v_mfma_f32_32x32x16_bf16 v[80:95], v[176:179], v[196:199], v[80:95]
    ds_read_b128 v[160:163], v9 offset:0
    ds_read_b128 v[164:167], v9 offset:4096
    ds_read_b64_tr_b16 v[188:189], v213 offset:2048
    ds_read_b64_tr_b16 v[190:191], v213 offset:2560
    buffer_store_dwordx4 v[136:139], v1, s[32:35], s79 offen offset:2048 sc1
    v_cvt_pk_bf16_f32 v140, v72, v73
    v_cvt_pk_bf16_f32 v141, v74, v75
    v_mfma_f32_32x32x16_bf16 v[96:111], v[180:183], v[196:199], v[96:111]
    v_cvt_pk_bf16_f32 v142, v76, v77
    v_cvt_pk_bf16_f32 v143, v78, v79
    s_mov_b64 exec, s[100:101]
    v_mov_b64 v[140:141], v[228:229]
    v_mov_b64_e64 v[142:143], v[228:229]
    s_mov_b64 exec, -1
    s_waitcnt lgkmcnt(4)
    v_mfma_f32_32x32x16_bf16 v[80:95], v[152:155], v[184:187], v[80:95]
    ds_read_b128 v[168:171], v10 offset:0
    ds_read_b128 v[172:175], v10 offset:4096
    ds_read_b64_tr_b16 v[192:193], v213 offset:4096
    ds_read_b64_tr_b16 v[194:195], v213 offset:4608
    buffer_store_dwordx4 v[140:143], v1, s[32:35], s79 offen offset:3072 sc1
    v_mfma_f32_32x32x16_bf16 v[96:111], v[156:159], v[184:187], v[96:111]
    s_waitcnt lgkmcnt(4)
    s_nop 0
    v_mfma_f32_32x32x16_bf16 v[80:95], v[160:163], v[188:191], v[80:95]
    ds_read_b128 v[176:179], v11 offset:0
    ds_read_b128 v[180:183], v11 offset:4096
    ds_read_b64_tr_b16 v[196:197], v213 offset:6144
    ds_read_b64_tr_b16 v[198:199], v213 offset:6656
    v_mfma_f32_32x32x16_bf16 v[96:111], v[164:167], v[188:191], v[96:111]
    s_waitcnt lgkmcnt(4)
    v_mfma_f32_32x32x16_bf16 v[80:95], v[168:171], v[192:195], v[80:95]
    v_mfma_f32_32x32x16_bf16 v[96:111], v[172:175], v[192:195], v[96:111]
    s_waitcnt lgkmcnt(0)
    v_mfma_f32_32x32x16_bf16 v[80:95], v[176:179], v[196:199], v[80:95]
    v_mfma_f32_32x32x16_bf16 v[96:111], v[180:183], v[196:199], v[96:111]
    s_nop 10
    v_cvt_pk_bf16_f32 v112, v80, v81
    v_cvt_pk_bf16_f32 v113, v82, v83
    v_cvt_pk_bf16_f32 v114, v84, v85
    v_cvt_pk_bf16_f32 v115, v86, v87
    s_mov_b64 exec, s[100:101]
    v_mov_b64 v[112:113], v[228:229]
    v_mov_b64_e64 v[114:115], v[228:229]
    s_mov_b64 exec, -1
    buffer_store_dwordx4 v[112:115], v1, s[32:35], s80 offen offset:2048 sc1
    v_cvt_pk_bf16_f32 v116, v88, v89
    v_cvt_pk_bf16_f32 v117, v90, v91
    v_cvt_pk_bf16_f32 v118, v92, v93
    v_cvt_pk_bf16_f32 v119, v94, v95
    s_mov_b64 exec, s[100:101]
    v_mov_b64 v[116:117], v[228:229]
    v_mov_b64 v[118:119], v[228:229]
    s_mov_b64 exec, -1
    buffer_store_dwordx4 v[116:119], v1, s[32:35], s80 offen offset:3072 sc1
    v_cvt_pk_bf16_f32 v120, v96, v97
    v_cvt_pk_bf16_f32 v121, v98, v99
    v_cvt_pk_bf16_f32 v122, v100, v101
    v_cvt_pk_bf16_f32 v123, v102, v103
    s_mov_b64 exec, s[100:101]
    v_mov_b64 v[120:121], v[228:229]
    v_mov_b64 v[122:123], v[228:229]
    s_mov_b64 exec, -1
    buffer_store_dwordx4 v[120:123], v1, s[32:35], s81 offen offset:2048 sc1
    v_cvt_pk_bf16_f32 v124, v104, v105
    v_cvt_pk_bf16_f32 v125, v106, v107
    v_cvt_pk_bf16_f32 v126, v108, v109
    v_cvt_pk_bf16_f32 v127, v110, v111
    s_mov_b64 exec, s[100:101]
    v_mov_b64 v[124:125], v[228:229]
    v_mov_b64 v[126:127], v[228:229]
    s_mov_b64 exec, -1
    buffer_store_dwordx4 v[124:127], v1, s[32:35], s81 offen offset:3072 sc1
L_GA_done:
    s_mul_i32 s76, s62, 48
    s_add_u32 s76, s76, s61
    s_lshl_b32 s76, s76, 7
    v_lshrrev_b32 v2, 3, v0
    v_and_b32 v3, 7, v0
    v_lshlrev_b32 v3, 4, v3
    v_lshl_add_u32 v2, v2, 11, v3
    s_cmp_lg_u32 s56, 0
    s_waitcnt vmcnt(0)
    s_barrier
    s_cbranch_scc1 L_GA_nf
    s_mov_b64 exec, 986895
    buffer_store_dwordx4 v[248:251], v2, s[32:35], s76 offen sc1
    s_mov_b64 exec, -1
L_GA_nf:
    v_and_b32 v2, 3, v0
    v_lshlrev_b32 v2, 4, v2
    v_lshrrev_b64 v[2:3], v2, v[248:249]
    v_lshlrev_b32 v253, 16, v2
    s_mov_b32 s86, 0x07060302
    s_mov_b32 s87, 0x07060100
    s_barrier
    s_barrier
    s_cmp_ge_u32 s59, 28
    s_cbranch_scc1 L_nowo_5
    s_lshl_b32 s96, s65, 7
    s_mul_i32 s94, s57, 100352
    s_add_u32 s96, s96, s94
    s_mul_i32 s95, s57, 14336
    s_add_u32 m0, s95, 0
    s_add_u32 s94, s96, 0
    buffer_load_dwordx4 v224, s[48:51], s94 offen offset:0 lds
    s_waitcnt vmcnt(1)
    buffer_load_dwordx4 v225, s[48:51], s94 offen offset:1024 lds
    s_waitcnt vmcnt(1)
    buffer_load_dwordx4 v226, s[48:51], s94 offen offset:2048 lds
    s_waitcnt vmcnt(1)
    buffer_load_dwordx4 v227, s[48:51], s94 offen offset:3072 lds
    s_waitcnt vmcnt(1)
    s_add_u32 m0, s95, 4096
    s_add_u32 s94, s96, 28672
    buffer_load_dwordx4 v224, s[48:51], s94 offen offset:0 lds
    s_waitcnt vmcnt(1)
    buffer_load_dwordx4 v225, s[48:51], s94 offen offset:1024 lds
    s_waitcnt vmcnt(1)
    buffer_load_dwordx4 v226, s[48:51], s94 offen offset:2048 lds
    s_waitcnt vmcnt(1)
L_nowo_5:
    s_cmp_lg_u32 s56, 0
    s_cbranch_scc1 L_GA_wo
    s_lshl4_add_u32 s76, s62, s61
    s_lshr_b32 s77, s76, 2
    s_lshl_b32 s78, s77, 11
    s_add_u32 s80, s78, 131072
    s_lshl_b32 s82, s76, 7
    s_add_u32 s82, s82, 327680
    s_lshl_b32 s78, s77, 16
    s_and_b32 s79, s76, 3
    s_lshl_b32 s79, s79, 10
    s_add_u32 s78, s78, s79
    s_add_u32 s78, s78, 12582912
    v_lshlrev_b32 v15, 7, v0
    v_add_u32 v15, s80, v15
    s_mov_b64 exec, 65535
    s_mov_b32 s90, 0x40000
L_poll_6:
    buffer_load_dwordx2 v[2:3], v15, s[32:35], 0 offen sc1
    s_waitcnt vmcnt(0)
    v_cmp_ne_u64 vcc, v[248:249], v[2:3]
    s_cbranch_vccz L_polld_7
    s_mov_b64 exec, vcc
    s_sleep 4
    s_sub_u32 s90, s90, 1
    s_cbranch_scc0 L_poll_6
L_polld_7:
    s_mov_b64 exec, -1
    s_nop 0
    buffer_load_dwordx4 v[16:19], v1, s[32:35], s78 offen sc1
    s_add_u32 s78, s78, 4096
    buffer_load_dwordx4 v[20:23], v1, s[32:35], s78 offen sc1
    s_add_u32 s78, s78, 4096
    buffer_load_dwordx4 v[24:27], v1, s[32:35], s78 offen sc1
    s_add_u32 s78, s78, 4096
    buffer_load_dwordx4 v[28:31], v1, s[32:35], s78 offen sc1
    s_add_u32 s78, s78, 4096
    buffer_load_dwordx4 v[32:35], v1, s[32:35], s78 offen sc1
    s_add_u32 s78, s78, 4096
    buffer_load_dwordx4 v[36:39], v1, s[32:35], s78 offen sc1
    s_add_u32 s78, s78, 4096
    buffer_load_dwordx4 v[40:43], v1, s[32:35], s78 offen sc1
    s_add_u32 s78, s78, 4096
    buffer_load_dwordx4 v[44:47], v1, s[32:35], s78 offen sc1
    s_add_u32 s78, s78, 4096
    buffer_load_dwordx4 v[48:51], v1, s[32:35], s78 offen sc1
    s_add_u32 s78, s78, 4096
    buffer_load_dwordx4 v[52:55], v1, s[32:35], s78 offen sc1
    s_add_u32 s78, s78, 4096
    buffer_load_dwordx4 v[56:59], v1, s[32:35], s78 offen sc1
    s_add_u32 s78, s78, 4096
    buffer_load_dwordx4 v[60:63], v1, s[32:35], s78 offen sc1
    s_add_u32 s78, s78, 4096
    buffer_load_dwordx4 v[64:67], v1, s[32:35], s78 offen sc1
    s_add_u32 s78, s78, 4096
    buffer_load_dwordx4 v[68:71], v1, s[32:35], s78 offen sc1
    s_add_u32 s78, s78, 4096
    buffer_load_dwordx4 v[72:75], v1, s[32:35], s78 offen sc1
    s_add_u32 s78, s78, 4096
    buffer_load_dwordx4 v[76:79], v1, s[32:35], s78 offen sc1
    s_lshr_b32 s78, s76, 1
    s_lshl_b32 s78, s78, 10
    s_and_b32 s79, s76, 1
    s_lshl3_add_u32 s78, s79, s78
    s_add_u32 s78, s78, 589824
    s_waitcnt vmcnt(11)
    v_add_f32 v16, v16, v20
    v_add_f32 v17, v17, v21
    v_add_f32 v18, v18, v22
    v_add_f32 v19, v19, v23
    v_add_f32 v16, v16, v24
    v_add_f32 v17, v17, v25
    v_add_f32 v18, v18, v26
    v_add_f32 v19, v19, v27
    v_add_f32 v16, v16, v28
    v_add_f32 v17, v17, v29
    v_add_f32 v18, v18, v30
    v_add_f32 v19, v19, v31
    v_add_f32 v16, v16, v32
    v_add_f32 v17, v17, v33
    v_add_f32 v18, v18, v34
    v_add_f32 v19, v19, v35
    s_waitcnt vmcnt(7)
    v_add_f32 v16, v16, v36
    v_add_f32 v17, v17, v37
    v_add_f32 v18, v18, v38
    v_add_f32 v19, v19, v39
    v_add_f32 v16, v16, v40
    v_add_f32 v17, v17, v41
    v_add_f32 v18, v18, v42
    v_add_f32 v19, v19, v43
    v_add_f32 v16, v16, v44
    v_add_f32 v17, v17, v45
    v_add_f32 v18, v18, v46
    v_add_f32 v19, v19, v47
    v_add_f32 v16, v16, v48
    v_add_f32 v17, v17, v49
    v_add_f32 v18, v18, v50
    v_add_f32 v19, v19, v51
    s_waitcnt vmcnt(3)
    v_add_f32 v16, v16, v52
    v_add_f32 v17, v17, v53
    v_add_f32 v18, v18, v54
    v_add_f32 v19, v19, v55
    v_add_f32 v16, v16, v56
    v_add_f32 v17, v17, v57
    v_add_f32 v18, v18, v58
    v_add_f32 v19, v19, v59
    v_add_f32 v16, v16, v60
    v_add_f32 v17, v17, v61
    v_add_f32 v18, v18, v62
    v_add_f32 v19, v19, v63
    v_add_f32 v16, v16, v64
    v_add_f32 v17, v17, v65
    v_add_f32 v18, v18, v66
    v_add_f32 v19, v19, v67
    s_waitcnt vmcnt(0)
    v_add_f32 v16, v16, v68
    v_add_f32 v17, v17, v69
    v_add_f32 v18, v18, v70
    v_add_f32 v19, v19, v71
    v_add_f32 v16, v16, v72
    v_add_f32 v17, v17, v73
    v_add_f32 v18, v18, v74
    v_add_f32 v19, v19, v75
    v_add_f32 v16, v16, v76
    v_add_f32 v17, v17, v77
    v_add_f32 v18, v18, v78
    v_add_f32 v19, v19, v79
    v_cvt_pk_bf16_f32 v16, v16, v17
    v_cvt_pk_bf16_f32 v17, v18, v19
    buffer_store_dwordx2 v[16:17], v1, s[32:35], s78 offen sc1
    v_lshrrev_b32 v6, 3, v0
    v_and_b32 v7, 127, v1
    v_lshl_add_u32 v6, v6, 14, v7
    s_waitcnt vmcnt(0)
    s_mov_b32 exec_hi, 0
    s_mov_b32 exec_lo, -1
    buffer_store_dwordx4 v[248:251], v6, s[32:35], s82 offen sc1
    s_mov_b64 exec, -1
L_GA_wo:
    s_cmp_ge_u32 s59, 28
    s_cbranch_scc1 L_nowo_8
    s_lshl_b32 s96, s65, 7
    s_mul_i32 s94, s57, 100352
    s_add_u32 s96, s96, s94
    s_mul_i32 s95, s57, 14336
    s_add_u32 m0, s95, 4096
    s_add_u32 s94, s96, 28672
    buffer_load_dwordx4 v227, s[48:51], s94 offen offset:3072 lds
    s_waitcnt vmcnt(1)
    s_add_u32 m0, s95, 8192
    s_add_u32 s94, s96, 57344
    buffer_load_dwordx4 v224, s[48:51], s94 offen offset:0 lds
    s_waitcnt vmcnt(1)
    buffer_load_dwordx4 v225, s[48:51], s94 offen offset:1024 lds
    s_waitcnt vmcnt(1)
    buffer_load_dwordx4 v226, s[48:51], s94 offen offset:2048 lds
    s_waitcnt vmcnt(1)
    buffer_load_dwordx4 v227, s[48:51], s94 offen offset:3072 lds
    s_waitcnt vmcnt(1)
    s_add_u32 m0, s95, 12288
    s_add_u32 s94, s96, 86016
    buffer_load_dwordx4 v224, s[48:51], s94 offen offset:0 lds
    s_waitcnt vmcnt(1)
    buffer_load_dwordx4 v225, s[48:51], s94 offen offset:1024 lds
    s_waitcnt vmcnt(1)
    s_add_u32 m0, s95, 57344
    s_add_u32 s94, s96, 0
    buffer_load_dwordx4 v224, s[44:47], s94 offen offset:0 lds
    s_waitcnt vmcnt(1)
    buffer_load_dwordx4 v225, s[44:47], s94 offen offset:1024 lds
    s_waitcnt vmcnt(1)
L_nowo_8:
    s_add_u32 s82, s57, 3
    s_and_b32 s82, s82, 3
    s_lshl_b32 s82, s82, 12
    s_add_u32 s82, s82, 151040
    v_mov_b32 v9, s82
    s_movk_i32 s90, 64
L_go_9:
    ds_read_b32 v13, v9
    s_waitcnt lgkmcnt(0)
    v_cmp_ne_u32 vcc, 0, v13
    s_cbranch_vccnz L_god_10
    s_sleep 3
    s_sub_u32 s90, s90, 1
    s_cbranch_scc0 L_go_9
L_god_10:
    s_cmp_ge_u32 s59, 28
    s_cbranch_scc1 L_nowo_11
    s_lshl_b32 s96, s65, 7
    s_mul_i32 s94, s57, 100352
    s_add_u32 s96, s96, s94
    s_mul_i32 s95, s57, 14336
    s_add_u32 m0, s95, 57344
    s_add_u32 s94, s96, 0
    buffer_load_dwordx4 v226, s[44:47], s94 offen offset:2048 lds
    s_waitcnt vmcnt(8)
    buffer_load_dwordx4 v227, s[44:47], s94 offen offset:3072 lds
    s_waitcnt vmcnt(8)
    s_add_u32 m0, s95, 61440
    s_add_u32 s94, s96, 28672
    buffer_load_dwordx4 v224, s[44:47], s94 offen offset:0 lds
    s_waitcnt vmcnt(8)
    buffer_load_dwordx4 v225, s[44:47], s94 offen offset:1024 lds
    s_waitcnt vmcnt(8)
    buffer_load_dwordx4 v226, s[44:47], s94 offen offset:2048 lds
    s_waitcnt vmcnt(8)
    buffer_load_dwordx4 v227, s[44:47], s94 offen offset:3072 lds
    s_waitcnt vmcnt(8)
    s_add_u32 m0, s95, 65536
    s_add_u32 s94, s96, 57344
    buffer_load_dwordx4 v224, s[44:47], s94 offen offset:0 lds
    s_waitcnt vmcnt(8)
    buffer_load_dwordx4 v225, s[44:47], s94 offen offset:1024 lds
    s_waitcnt vmcnt(8)
    buffer_load_dwordx4 v226, s[44:47], s94 offen offset:2048 lds
    s_waitcnt vmcnt(8)
    buffer_load_dwordx4 v227, s[44:47], s94 offen offset:3072 lds
    s_waitcnt vmcnt(8)
    s_add_u32 m0, s95, 69632
    s_add_u32 s94, s96, 86016
    buffer_load_dwordx4 v224, s[44:47], s94 offen offset:0 lds
    s_waitcnt vmcnt(8)
    buffer_load_dwordx4 v225, s[44:47], s94 offen offset:1024 lds
    s_waitcnt vmcnt(8)
L_nowo_11:
    s_branch L_G_p3
L_GB:
    s_mul_i32 s76, s62, 112
    s_and_b32 s76, s76, 127
    s_lshr_b32 s77, s76, 6
    s_add_u32 s76, s76, s75
    v_add_u32 v14, s76, v3
    v_lshrrev_b32 v16, 7, v14
    v_xor_b32 v16, s77, v16
    v_cmp_eq_u32 vcc, 0, v16
    v_and_b32 v17, 127, v14
    v_and_b32 v18, 63, v14
    v_add_u32 v18, 8192, v18
    v_cndmask_b32 v14, v18, v17, vcc
    v_xor_b32 v14, v14, v13
    v_mov_b32 v17, 4096
    v_cndmask_b32 v17, 64, v17, vcc
    v_xor_b32 v17, v17, v14
    v_add_u32 v208, v12, v14
    v_add_u32_e64 v209, v12, v17
    v_add_u32 v210, 53248, v208
    v_add_u32 v211, 53248, v209
    v_add_u32 v212, 106496, v208
    v_add_u32 v213, 106496, v209
    v_lshl_add_u32 v2, v15, 2, v2
    v_mul_u32_u24 v14, 56, v2
    v_min_u32 v16, 48, v3
    s_mul_i32 s76, s71, 1568
    v_add3_u32 v14, v14, v16, s76
    s_mov_b32 s76, 0x3fb8aa3b
    s_mov_b32 s77, 0x3fb8aa3b
    s_lshl_b32 s78, s71, 14
    s_add_u32 s78, s78, 73728
    s_lshl_b32 s79, s70, 12
    v_and_b32 v16, 31, v0
    v_bfe_u32 v17, v16, 1, 3
    v_xor_b32 v17, v17, v15
    v_lshlrev_b32 v17, 3, v17
    v_lshl_or_b32 v17, v16, 6, v17
    s_add_u32 s80, s78, s79
    v_add_u32 v200, s80, v17
    v_xor_b32 v201, 16, v200
    v_xor_b32 v202, 32, v200
    v_xor_b32 v203, 48, v200
    v_lshrrev_b32 v16, 1, v2
    v_lshlrev_b32 v16, 3, v16
    v_xor_b32 v16, v16, v3
    v_lshl_or_b32 v16, v2, 6, v16
    s_lshl1_add_u32 s80, s79, s78
    s_add_u32 s81, s80, s79
    v_add_u32 v204, s81, v16
    v_xor_b32 v205, 32, v204
    v_xor_b32 v206, 4096, v204
    v_xor_b32 v207, 32, v206
    s_lshl_b32 s80, s57, 12
    s_add_u32 s80, s80, 126976
    v_add_u32 v214, s80, v1
    s_xor_b32 s80, s57, 2
    s_lshl_b32 s80, s80, 12
    s_add_u32 s80, s80, 126976
    v_add_u32 v215, s80, v1
    s_lshl_b32 s80, s57, 2
    s_add_u32 s80, s80, 65536
    v_mov_b32 v12, s80
    v_xor_b32 v13, 8, v12
    v_mul_u32_u24 v15, 255, v15
    v_lshlrev_b32 v15, 23, v15
    s_lshl1_add_u32 s78, s72, s70
    s_lshl4_add_u32 s78, s78, s61
    s_lshl_b32 s82, s78, 7
    s_add_u32 s82, s82, 131072
    s_lshl_b32 s78, s78, 12
    s_add_u32 s78, s78, 12582912
    s_barrier
    ds_read_b128 v[112:115], v4 offset:0
    ds_read_b128 v[116:119], v4 offset:4096
    ds_read_b64_tr_b16 v[124:125], v208 offset:12288
    ds_read_b64_tr_b16 v[126:127], v208 offset:12800
    ds_read_b64_tr_b16 v[120:121], v208 offset:0
    ds_read_b64_tr_b16 v[122:123], v208 offset:512
    ds_read_b64_tr_b16 v[128:129], v208 offset:24576
    ds_read_b64_tr_b16 v[130:131], v208 offset:25088
    s_waitcnt lgkmcnt(4)
    s_nop 0
    v_mfma_f32_32x32x16_bf16 v[48:63], v[124:127], v[112:115], 0
    ds_read_b128 v[132:135], v5 offset:0
    ds_read_b128 v[136:139], v5 offset:4096
    v_mfma_f32_32x32x16_bf16 v[64:79], v[124:127], v[116:119], 0
    ds_read_b64_tr_b16 v[144:145], v208 offset:14336
    ds_read_b64_tr_b16 v[146:147], v208 offset:14848
    s_waitcnt lgkmcnt(6)
    s_nop 0
    v_mfma_f32_32x32x16_bf16 v[16:31], v[120:123], v[112:115], 0
    ds_read_b64_tr_b16 v[140:141], v208 offset:2048
    ds_read_b64_tr_b16 v[142:143], v208 offset:2560
    v_mfma_f32_32x32x16_bf16 v[32:47], v[120:123], v[116:119], 0
    ds_read_b64_tr_b16 v[148:149], v208 offset:26624
    ds_read_b64_tr_b16 v[150:151], v208 offset:27136
    s_waitcnt lgkmcnt(8)
    v_mfma_f32_32x32x16_bf16 v[80:95], v[112:115], v[128:131], 0
    v_mfma_f32_32x32x16_bf16 v[96:111], v[116:119], v[128:131], 0
    s_waitcnt lgkmcnt(4)
    v_mfma_f32_32x32x16_bf16 v[48:63], v[144:147], v[132:135], v[48:63]
    ds_read_b128 v[112:115], v6 offset:0
    ds_read_b128 v[116:119], v6 offset:4096
    v_mfma_f32_32x32x16_bf16 v[64:79], v[144:147], v[136:139], v[64:79]
    ds_read_b64_tr_b16 v[124:125], v209 offset:12288
    ds_read_b64_tr_b16 v[126:127], v209 offset:12800
    s_waitcnt lgkmcnt(6)
    s_nop 0
    v_mfma_f32_32x32x16_bf16 v[16:31], v[140:143], v[132:135], v[16:31]
    ds_read_b64_tr_b16 v[120:121], v209 offset:0
    ds_read_b64_tr_b16 v[122:123], v209 offset:512
    v_mfma_f32_32x32x16_bf16 v[32:47], v[140:143], v[136:139], v[32:47]
    ds_read_b64_tr_b16 v[128:129], v209 offset:24576
    ds_read_b64_tr_b16 v[130:131], v209 offset:25088
    s_waitcnt lgkmcnt(8)
    v_mfma_f32_32x32x16_bf16 v[80:95], v[132:135], v[148:151], v[80:95]
    v_mfma_f32_32x32x16_bf16 v[96:111], v[136:139], v[148:151], v[96:111]
    s_waitcnt lgkmcnt(4)
    v_mfma_f32_32x32x16_bf16 v[48:63], v[124:127], v[112:115], v[48:63]
    ds_read_b128 v[132:135], v7 offset:0
    ds_read_b128 v[136:139], v7 offset:4096
    v_mfma_f32_32x32x16_bf16 v[64:79], v[124:127], v[116:119], v[64:79]
    ds_read_b64_tr_b16 v[144:145], v209 offset:14336
    ds_read_b64_tr_b16 v[146:147], v209 offset:14848
    s_waitcnt lgkmcnt(6)
    s_nop 0
    v_mfma_f32_32x32x16_bf16 v[16:31], v[120:123], v[112:115], v[16:31]
    ds_read_b64_tr_b16 v[140:141], v209 offset:2048
    ds_read_b64_tr_b16 v[142:143], v209 offset:2560
    v_mfma_f32_32x32x16_bf16 v[32:47], v[120:123], v[116:119], v[32:47]
    ds_read_b64_tr_b16 v[148:149], v209 offset:26624
    ds_read_b64_tr_b16 v[150:151], v209 offset:27136
    s_waitcnt lgkmcnt(8)
    v_mfma_f32_32x32x16_bf16 v[80:95], v[112:115], v[128:131], v[80:95]
    v_mfma_f32_32x32x16_bf16 v[96:111], v[116:119], v[128:131], v[96:111]
    s_waitcnt lgkmcnt(4)
    v_mfma_f32_32x32x16_bf16 v[48:63], v[144:147], v[132:135], v[48:63]
    v_mfma_f32_32x32x16_bf16 v[64:79], v[144:147], v[136:139], v[64:79]
    s_waitcnt lgkmcnt(2)
    v_mfma_f32_32x32x16_bf16 v[16:31], v[140:143], v[132:135], v[16:31]
    v_mfma_f32_32x32x16_bf16 v[32:47], v[140:143], v[136:139], v[32:47]
    s_waitcnt lgkmcnt(0)
    s_barrier
    s_nop 0
    ds_read_b128 v[112:115], v4 offset:53248
    ds_read_b128 v[116:119], v4 offset:57344
    ds_read_b64_tr_b16 v[124:125], v210 offset:12288
    ds_read_b64_tr_b16 v[126:127], v210 offset:12800
    v_mfma_f32_32x32x16_bf16 v[80:95], v[132:135], v[148:151], v[80:95]
    ds_read_b64_tr_b16 v[120:121], v210 offset:0
    ds_read_b64_tr_b16 v[122:123], v210 offset:512
    v_mfma_f32_32x32x16_bf16 v[96:111], v[136:139], v[148:151], v[96:111]
    ds_read_b64_tr_b16 v[128:129], v210 offset:24576
    ds_read_b64_tr_b16 v[130:131], v210 offset:25088
    s_waitcnt lgkmcnt(4)
    s_nop 0
    v_mfma_f32_32x32x16_bf16 v[48:63], v[124:127], v[112:115], v[48:63]
    ds_read_b128 v[132:135], v5 offset:53248
    ds_read_b128 v[136:139], v5 offset:57344
    v_mfma_f32_32x32x16_bf16 v[64:79], v[124:127], v[116:119], v[64:79]
    ds_read_b64_tr_b16 v[144:145], v210 offset:14336
    ds_read_b64_tr_b16 v[146:147], v210 offset:14848
    s_waitcnt lgkmcnt(6)
    s_nop 0
    v_mfma_f32_32x32x16_bf16 v[16:31], v[120:123], v[112:115], v[16:31]
    ds_read_b64_tr_b16 v[140:141], v210 offset:2048
    ds_read_b64_tr_b16 v[142:143], v210 offset:2560
    v_mfma_f32_32x32x16_bf16 v[32:47], v[120:123], v[116:119], v[32:47]
    ds_read_b64_tr_b16 v[148:149], v210 offset:26624
    ds_read_b64_tr_b16 v[150:151], v210 offset:27136
    s_waitcnt lgkmcnt(8)
    v_mfma_f32_32x32x16_bf16 v[80:95], v[112:115], v[128:131], v[80:95]
    v_mfma_f32_32x32x16_bf16 v[96:111], v[116:119], v[128:131], v[96:111]
    s_waitcnt lgkmcnt(4)
    v_mfma_f32_32x32x16_bf16 v[48:63], v[144:147], v[132:135], v[48:63]
    ds_read_b128 v[112:115], v6 offset:53248
    ds_read_b128 v[116:119], v6 offset:57344
    v_mfma_f32_32x32x16_bf16 v[64:79], v[144:147], v[136:139], v[64:79]
    ds_read_b64_tr_b16 v[124:125], v211 offset:12288
    ds_read_b64_tr_b16 v[126:127], v211 offset:12800
    s_waitcnt lgkmcnt(6)
    s_nop 0
    v_mfma_f32_32x32x16_bf16 v[16:31], v[140:143], v[132:135], v[16:31]
    ds_read_b64_tr_b16 v[120:121], v211 offset:0
    ds_read_b64_tr_b16 v[122:123], v211 offset:512
    v_mfma_f32_32x32x16_bf16 v[32:47], v[140:143], v[136:139], v[32:47]
    ds_read_b64_tr_b16 v[128:129], v211 offset:24576
    ds_read_b64_tr_b16 v[130:131], v211 offset:25088
    s_waitcnt lgkmcnt(8)
    v_mfma_f32_32x32x16_bf16 v[80:95], v[132:135], v[148:151], v[80:95]
    v_mfma_f32_32x32x16_bf16 v[96:111], v[136:139], v[148:151], v[96:111]
    s_waitcnt lgkmcnt(4)
    v_mfma_f32_32x32x16_bf16 v[48:63], v[124:127], v[112:115], v[48:63]
    ds_read_b128 v[132:135], v7 offset:53248
    ds_read_b128 v[136:139], v7 offset:57344
    v_mfma_f32_32x32x16_bf16 v[64:79], v[124:127], v[116:119], v[64:79]
    ds_read_b64_tr_b16 v[144:145], v211 offset:14336
    ds_read_b64_tr_b16 v[146:147], v211 offset:14848
    s_waitcnt lgkmcnt(6)
    s_nop 0
    v_mfma_f32_32x32x16_bf16 v[16:31], v[120:123], v[112:115], v[16:31]
    ds_read_b64_tr_b16 v[140:141], v211 offset:2048
    ds_read_b64_tr_b16 v[142:143], v211 offset:2560
    v_mfma_f32_32x32x16_bf16 v[32:47], v[120:123], v[116:119], v[32:47]
    ds_read_b64_tr_b16 v[148:149], v211 offset:26624
    ds_read_b64_tr_b16 v[150:151], v211 offset:27136
    s_waitcnt lgkmcnt(8)
    v_mfma_f32_32x32x16_bf16 v[80:95], v[112:115], v[128:131], v[80:95]
    v_mfma_f32_32x32x16_bf16 v[96:111], v[116:119], v[128:131], v[96:111]
    s_waitcnt lgkmcnt(4)
    v_mfma_f32_32x32x16_bf16 v[48:63], v[144:147], v[132:135], v[48:63]
    v_mfma_f32_32x32x16_bf16 v[64:79], v[144:147], v[136:139], v[64:79]
    s_waitcnt lgkmcnt(2)
    v_mfma_f32_32x32x16_bf16 v[16:31], v[140:143], v[132:135], v[16:31]
    v_mfma_f32_32x32x16_bf16 v[32:47], v[140:143], v[136:139], v[32:47]
    s_waitcnt lgkmcnt(0)
    s_barrier
    s_nop 0
    ds_read_b128 v[112:115], v8 offset:0
    ds_read_b128 v[116:119], v8 offset:4096
    ds_read_b64_tr_b16 v[124:125], v212 offset:12288
    ds_read_b64_tr_b16 v[126:127], v212 offset:12800
    v_mfma_f32_32x32x16_bf16 v[80:95], v[132:135], v[148:151], v[80:95]
    ds_read_b64_tr_b16 v[120:121], v212 offset:0
    ds_read_b64_tr_b16 v[122:123], v212 offset:512
    v_mfma_f32_32x32x16_bf16 v[96:111], v[136:139], v[148:151], v[96:111]
    ds_read_b64_tr_b16 v[128:129], v212 offset:24576
    ds_read_b64_tr_b16 v[130:131], v212 offset:25088
    s_waitcnt lgkmcnt(4)
    s_nop 0
    v_mfma_f32_32x32x16_bf16 v[48:63], v[124:127], v[112:115], v[48:63]
    ds_read_b128 v[132:135], v9 offset:0
    ds_read_b128 v[136:139], v9 offset:4096
    v_mfma_f32_32x32x16_bf16 v[64:79], v[124:127], v[116:119], v[64:79]
    ds_read_b64_tr_b16 v[144:145], v212 offset:14336
    ds_read_b64_tr_b16 v[146:147], v212 offset:14848
    s_waitcnt lgkmcnt(6)
    s_nop 0
    v_mfma_f32_32x32x16_bf16 v[16:31], v[120:123], v[112:115], v[16:31]
    ds_read_b64_tr_b16 v[140:141], v212 offset:2048
    ds_read_b64_tr_b16 v[142:143], v212 offset:2560
    v_mfma_f32_32x32x16_bf16 v[32:47], v[120:123], v[116:119], v[32:47]
    ds_read_b64_tr_b16 v[148:149], v212 offset:26624
    ds_read_b64_tr_b16 v[150:151], v212 offset:27136
    s_waitcnt lgkmcnt(8)
    v_mfma_f32_32x32x16_bf16 v[80:95], v[112:115], v[128:131], v[80:95]
    v_mfma_f32_32x32x16_bf16 v[96:111], v[116:119], v[128:131], v[96:111]
    s_waitcnt lgkmcnt(4)
    v_mfma_f32_32x32x16_bf16 v[48:63], v[144:147], v[132:135], v[48:63]
    ds_read_b128 v[112:115], v10 offset:0
    ds_read_b128 v[116:119], v10 offset:4096
    v_mfma_f32_32x32x16_bf16 v[64:79], v[144:147], v[136:139], v[64:79]
    ds_read_b64_tr_b16 v[124:125], v213 offset:12288
    ds_read_b64_tr_b16 v[126:127], v213 offset:12800
    s_waitcnt lgkmcnt(6)
    s_nop 0
    v_mfma_f32_32x32x16_bf16 v[16:31], v[140:143], v[132:135], v[16:31]
    ds_read_b64_tr_b16 v[120:121], v213 offset:0
    ds_read_b64_tr_b16 v[122:123], v213 offset:512
    v_mfma_f32_32x32x16_bf16 v[32:47], v[140:143], v[136:139], v[32:47]
    ds_read_b64_tr_b16 v[128:129], v213 offset:24576
    ds_read_b64_tr_b16 v[130:131], v213 offset:25088
    s_waitcnt lgkmcnt(8)
    v_mfma_f32_32x32x16_bf16 v[80:95], v[132:135], v[148:151], v[80:95]
    v_mfma_f32_32x32x16_bf16 v[96:111], v[136:139], v[148:151], v[96:111]
    s_waitcnt lgkmcnt(4)
    v_mfma_f32_32x32x16_bf16 v[48:63], v[124:127], v[112:115], v[48:63]
    ds_read_b128 v[132:135], v11 offset:0
    ds_read_b128 v[136:139], v11 offset:4096
    v_mfma_f32_32x32x16_bf16 v[64:79], v[124:127], v[116:119], v[64:79]
    ds_read_b64_tr_b16 v[144:145], v213 offset:14336
    ds_read_b64_tr_b16 v[146:147], v213 offset:14848
    s_waitcnt lgkmcnt(6)
    s_nop 0
    v_mfma_f32_32x32x16_bf16 v[16:31], v[120:123], v[112:115], v[16:31]
    ds_read_b64_tr_b16 v[140:141], v213 offset:2048
    ds_read_b64_tr_b16 v[142:143], v213 offset:2560
    v_mfma_f32_32x32x16_bf16 v[32:47], v[120:123], v[116:119], v[32:47]
    ds_read_b64_tr_b16 v[148:149], v213 offset:26624
    ds_read_b64_tr_b16 v[150:151], v213 offset:27136
    s_waitcnt lgkmcnt(8)
    v_mfma_f32_32x32x16_bf16 v[80:95], v[112:115], v[128:131], v[80:95]
    v_mfma_f32_32x32x16_bf16 v[96:111], v[116:119], v[128:131], v[96:111]
    s_waitcnt lgkmcnt(4)
    v_mfma_f32_32x32x16_bf16 v[48:63], v[144:147], v[132:135], v[48:63]
    v_mfma_f32_32x32x16_bf16 v[64:79], v[144:147], v[136:139], v[64:79]
    s_waitcnt lgkmcnt(2)
    v_mfma_f32_32x32x16_bf16 v[16:31], v[140:143], v[132:135], v[16:31]
    v_mfma_f32_32x32x16_bf16 v[32:47], v[140:143], v[136:139], v[32:47]
    s_waitcnt lgkmcnt(0)
    s_barrier
    s_nop 0
    ds_read_b128 v[112:115], v4 offset:0
    ds_read_b128 v[116:119], v4 offset:4096
    ds_read_b64_tr_b16 v[124:125], v208 offset:12288
    ds_read_b64_tr_b16 v[126:127], v208 offset:12800
    v_mfma_f32_32x32x16_bf16 v[80:95], v[132:135], v[148:151], v[80:95]
    ds_read_b64_tr_b16 v[120:121], v208 offset:0
    ds_read_b64_tr_b16 v[122:123], v208 offset:512
    v_mfma_f32_32x32x16_bf16 v[96:111], v[136:139], v[148:151], v[96:111]
    ds_read_b64_tr_b16 v[128:129], v208 offset:24576
    ds_read_b64_tr_b16 v[130:131], v208 offset:25088
    s_waitcnt lgkmcnt(4)
    s_nop 0
    v_mfma_f32_32x32x16_bf16 v[48:63], v[124:127], v[112:115], v[48:63]
    ds_read_b128 v[132:135], v5 offset:0
    ds_read_b128 v[136:139], v5 offset:4096
    v_mfma_f32_32x32x16_bf16 v[64:79], v[124:127], v[116:119], v[64:79]
    ds_read_b64_tr_b16 v[144:145], v208 offset:14336
    ds_read_b64_tr_b16 v[146:147], v208 offset:14848
    s_waitcnt lgkmcnt(6)
    s_nop 0
    v_mfma_f32_32x32x16_bf16 v[16:31], v[120:123], v[112:115], v[16:31]
    ds_read_b64_tr_b16 v[140:141], v208 offset:2048
    ds_read_b64_tr_b16 v[142:143], v208 offset:2560
    v_mfma_f32_32x32x16_bf16 v[32:47], v[120:123], v[116:119], v[32:47]
    ds_read_b64_tr_b16 v[148:149], v208 offset:26624
    ds_read_b64_tr_b16 v[150:151], v208 offset:27136
    s_waitcnt lgkmcnt(8)
    v_mfma_f32_32x32x16_bf16 v[80:95], v[112:115], v[128:131], v[80:95]
    v_mfma_f32_32x32x16_bf16 v[96:111], v[116:119], v[128:131], v[96:111]
    s_waitcnt lgkmcnt(4)
    v_mfma_f32_32x32x16_bf16 v[48:63], v[144:147], v[132:135], v[48:63]
    ds_read_b128 v[112:115], v6 offset:0
    ds_read_b128 v[116:119], v6 offset:4096
    v_mfma_f32_32x32x16_bf16 v[64:79], v[144:147], v[136:139], v[64:79]
    ds_read_b64_tr_b16 v[124:125], v209 offset:12288
    ds_read_b64_tr_b16 v[126:127], v209 offset:12800
    s_waitcnt lgkmcnt(6)
    s_nop 0
    v_mfma_f32_32x32x16_bf16 v[16:31], v[140:143], v[132:135], v[16:31]
    ds_read_b64_tr_b16 v[120:121], v209 offset:0
    ds_read_b64_tr_b16 v[122:123], v209 offset:512
    v_mfma_f32_32x32x16_bf16 v[32:47], v[140:143], v[136:139], v[32:47]
    ds_read_b64_tr_b16 v[128:129], v209 offset:24576
    ds_read_b64_tr_b16 v[130:131], v209 offset:25088
    s_waitcnt lgkmcnt(8)
    v_mfma_f32_32x32x16_bf16 v[80:95], v[132:135], v[148:151], v[80:95]
    v_mfma_f32_32x32x16_bf16 v[96:111], v[136:139], v[148:151], v[96:111]
    s_waitcnt lgkmcnt(4)
    v_mfma_f32_32x32x16_bf16 v[48:63], v[124:127], v[112:115], v[48:63]
    ds_read_b128 v[132:135], v7 offset:0
    ds_read_b128 v[136:139], v7 offset:4096
    v_mfma_f32_32x32x16_bf16 v[64:79], v[124:127], v[116:119], v[64:79]
    ds_read_b64_tr_b16 v[144:145], v209 offset:14336
    ds_read_b64_tr_b16 v[146:147], v209 offset:14848
    s_waitcnt lgkmcnt(6)
    s_nop 0
    v_mfma_f32_32x32x16_bf16 v[16:31], v[120:123], v[112:115], v[16:31]
    ds_read_b64_tr_b16 v[140:141], v209 offset:2048
    ds_read_b64_tr_b16 v[142:143], v209 offset:2560
    v_mfma_f32_32x32x16_bf16 v[32:47], v[120:123], v[116:119], v[32:47]
    ds_read_b64_tr_b16 v[148:149], v209 offset:26624
    ds_read_b64_tr_b16 v[150:151], v209 offset:27136
    s_waitcnt lgkmcnt(8)
    v_mfma_f32_32x32x16_bf16 v[80:95], v[112:115], v[128:131], v[80:95]
    v_mfma_f32_32x32x16_bf16 v[96:111], v[116:119], v[128:131], v[96:111]
    s_waitcnt lgkmcnt(4)
    v_mfma_f32_32x32x16_bf16 v[48:63], v[144:147], v[132:135], v[48:63]
    v_mfma_f32_32x32x16_bf16 v[64:79], v[144:147], v[136:139], v[64:79]
    s_waitcnt lgkmcnt(2)
    v_mfma_f32_32x32x16_bf16 v[16:31], v[140:143], v[132:135], v[16:31]
    v_mfma_f32_32x32x16_bf16 v[32:47], v[140:143], v[136:139], v[32:47]
    s_waitcnt lgkmcnt(0)
    s_barrier
    s_nop 0
    ds_read_b128 v[112:115], v4 offset:53248
    ds_read_b128 v[116:119], v4 offset:57344
    ds_read_b64_tr_b16 v[124:125], v210 offset:12288
    ds_read_b64_tr_b16 v[126:127], v210 offset:12800
    v_mfma_f32_32x32x16_bf16 v[80:95], v[132:135], v[148:151], v[80:95]
    ds_read_b64_tr_b16 v[120:121], v210 offset:0
    ds_read_b64_tr_b16 v[122:123], v210 offset:512
    v_mfma_f32_32x32x16_bf16 v[96:111], v[136:139], v[148:151], v[96:111]
    ds_read_b64_tr_b16 v[128:129], v210 offset:24576
    ds_read_b64_tr_b16 v[130:131], v210 offset:25088
    s_waitcnt lgkmcnt(4)
    s_nop 0
    v_mfma_f32_32x32x16_bf16 v[48:63], v[124:127], v[112:115], v[48:63]
    ds_read_b128 v[132:135], v5 offset:53248
    ds_read_b128 v[136:139], v5 offset:57344
    v_mfma_f32_32x32x16_bf16 v[64:79], v[124:127], v[116:119], v[64:79]
    ds_read_b64_tr_b16 v[144:145], v210 offset:14336
    ds_read_b64_tr_b16 v[146:147], v210 offset:14848
    s_waitcnt lgkmcnt(6)
    s_nop 0
    v_mfma_f32_32x32x16_bf16 v[16:31], v[120:123], v[112:115], v[16:31]
    ds_read_b64_tr_b16 v[140:141], v210 offset:2048
    ds_read_b64_tr_b16 v[142:143], v210 offset:2560
    v_mfma_f32_32x32x16_bf16 v[32:47], v[120:123], v[116:119], v[32:47]
    ds_read_b64_tr_b16 v[148:149], v210 offset:26624
    ds_read_b64_tr_b16 v[150:151], v210 offset:27136
    s_waitcnt lgkmcnt(8)
    v_mfma_f32_32x32x16_bf16 v[80:95], v[112:115], v[128:131], v[80:95]
    v_mfma_f32_32x32x16_bf16 v[96:111], v[116:119], v[128:131], v[96:111]
    s_waitcnt lgkmcnt(4)
    v_mfma_f32_32x32x16_bf16 v[48:63], v[144:147], v[132:135], v[48:63]
    ds_read_b128 v[112:115], v6 offset:53248
    ds_read_b128 v[116:119], v6 offset:57344
    v_mfma_f32_32x32x16_bf16 v[64:79], v[144:147], v[136:139], v[64:79]
    ds_read_b64_tr_b16 v[124:125], v211 offset:12288
    ds_read_b64_tr_b16 v[126:127], v211 offset:12800
    s_waitcnt lgkmcnt(6)
    s_nop 0
    v_mfma_f32_32x32x16_bf16 v[16:31], v[140:143], v[132:135], v[16:31]
    ds_read_b64_tr_b16 v[120:121], v211 offset:0
    ds_read_b64_tr_b16 v[122:123], v211 offset:512
    v_mfma_f32_32x32x16_bf16 v[32:47], v[140:143], v[136:139], v[32:47]
    ds_read_b64_tr_b16 v[128:129], v211 offset:24576
    ds_read_b64_tr_b16 v[130:131], v211 offset:25088
    s_waitcnt lgkmcnt(8)
    v_mfma_f32_32x32x16_bf16 v[80:95], v[132:135], v[148:151], v[80:95]
    v_mfma_f32_32x32x16_bf16 v[96:111], v[136:139], v[148:151], v[96:111]
    s_waitcnt lgkmcnt(4)
    v_mfma_f32_32x32x16_bf16 v[48:63], v[124:127], v[112:115], v[48:63]
    ds_read_b128 v[132:135], v7 offset:53248
    ds_read_b128 v[136:139], v7 offset:57344
    v_mfma_f32_32x32x16_bf16 v[64:79], v[124:127], v[116:119], v[64:79]
    ds_read_b64_tr_b16 v[144:145], v211 offset:14336
    ds_read_b64_tr_b16 v[146:147], v211 offset:14848
    s_waitcnt lgkmcnt(6)
    s_nop 0
    v_mfma_f32_32x32x16_bf16 v[16:31], v[120:123], v[112:115], v[16:31]
    ds_read_b64_tr_b16 v[140:141], v211 offset:2048
    ds_read_b64_tr_b16 v[142:143], v211 offset:2560
    v_mfma_f32_32x32x16_bf16 v[32:47], v[120:123], v[116:119], v[32:47]
    ds_read_b64_tr_b16 v[148:149], v211 offset:26624
    ds_read_b64_tr_b16 v[150:151], v211 offset:27136
    s_waitcnt lgkmcnt(8)
    v_mfma_f32_32x32x16_bf16 v[80:95], v[112:115], v[128:131], v[80:95]
    v_mfma_f32_32x32x16_bf16 v[96:111], v[116:119], v[128:131], v[96:111]
    s_waitcnt lgkmcnt(4)
    v_mfma_f32_32x32x16_bf16 v[48:63], v[144:147], v[132:135], v[48:63]
    v_mfma_f32_32x32x16_bf16 v[64:79], v[144:147], v[136:139], v[64:79]
    s_waitcnt lgkmcnt(2)
    v_mfma_f32_32x32x16_bf16 v[16:31], v[140:143], v[132:135], v[16:31]
    v_mfma_f32_32x32x16_bf16 v[32:47], v[140:143], v[136:139], v[32:47]
    s_waitcnt lgkmcnt(0)
    s_barrier
    s_nop 0
    ds_read_b128 v[152:155], v8 offset:0
    ds_read_b128 v[156:159], v8 offset:4096
    ds_read_b64_tr_b16 v[184:185], v212 offset:12288
    ds_read_b64_tr_b16 v[186:187], v212 offset:12800
    v_mfma_f32_32x32x16_bf16 v[80:95], v[132:135], v[148:151], v[80:95]
    ds_read_b128 v[160:163], v9 offset:0
    ds_read_b128 v[164:167], v9 offset:4096
    ds_read_b64_tr_b16 v[188:189], v212 offset:14336
    ds_read_b64_tr_b16 v[190:191], v212 offset:14848
    v_mfma_f32_32x32x16_bf16 v[96:111], v[136:139], v[148:151], v[96:111]
    s_waitcnt lgkmcnt(4)
    s_nop 0
    v_mfma_f32_32x32x16_bf16 v[48:63], v[184:187], v[152:155], v[48:63]
    ds_read_b128 v[168:171], v10 offset:0
    ds_read_b128 v[172:175], v10 offset:4096
    ds_read_b64_tr_b16 v[192:193], v213 offset:12288
    ds_read_b64_tr_b16 v[194:195], v213 offset:12800
    v_mfma_f32_32x32x16_bf16 v[64:79], v[184:187], v[156:159], v[64:79]
    s_waitcnt lgkmcnt(4)
    s_nop 0
    v_mfma_f32_32x32x16_bf16 v[48:63], v[188:191], v[160:163], v[48:63]
    ds_read_b128 v[176:179], v11 offset:0
    ds_read_b128 v[180:183], v11 offset:4096
    ds_read_b64_tr_b16 v[196:197], v213 offset:14336
    ds_read_b64_tr_b16 v[198:199], v213 offset:14848
    v_mfma_f32_32x32x16_bf16 v[64:79], v[188:191], v[164:167], v[64:79]
    s_waitcnt lgkmcnt(4)
    v_mfma_f32_32x32x16_bf16 v[48:63], v[192:195], v[168:171], v[48:63]
    s_barrier
    ds_read_b128 v[152:155], v4 offset:0
    ds_read_b128 v[156:159], v4 offset:4096
    ds_read_b64_tr_b16 v[184:185], v208 offset:12288
    ds_read_b64_tr_b16 v[186:187], v208 offset:12800
    v_mfma_f32_32x32x16_bf16 v[64:79], v[192:195], v[172:175], v[64:79]
    s_waitcnt lgkmcnt(4)
    s_nop 0
    v_mfma_f32_32x32x16_bf16 v[48:63], v[196:199], v[176:179], v[48:63]
    ds_read_b128 v[160:163], v5 offset:0
    ds_read_b128 v[164:167], v5 offset:4096
    ds_read_b64_tr_b16 v[188:189], v208 offset:14336
    ds_read_b64_tr_b16 v[190:191], v208 offset:14848
    v_mfma_f32_32x32x16_bf16 v[64:79], v[196:199], v[180:183], v[64:79]
    s_waitcnt lgkmcnt(4)
    s_nop 0
    v_mfma_f32_32x32x16_bf16 v[48:63], v[184:187], v[152:155], v[48:63]
    ds_read_b128 v[168:171], v6 offset:0
    ds_read_b128 v[172:175], v6 offset:4096
    ds_read_b64_tr_b16 v[192:193], v209 offset:12288
    ds_read_b64_tr_b16 v[194:195], v209 offset:12800
    ds_read_b64_tr_b16 v[232:233], v14 offset:0
    ds_read_b64_tr_b16 v[234:235], v14 offset:448
    ds_read_b64_tr_b16 v[236:237], v14 offset:896
    ds_read_b64_tr_b16 v[238:239], v14 offset:1344
    v_mfma_f32_32x32x16_bf16 v[64:79], v[184:187], v[156:159], v[64:79]
    s_waitcnt lgkmcnt(8)
    s_nop 0
    v_mfma_f32_32x32x16_bf16 v[48:63], v[188:191], v[160:163], v[48:63]
    ds_read_b128 v[176:179], v7 offset:0
    ds_read_b128 v[180:183], v7 offset:4096
    ds_read_b64_tr_b16 v[196:197], v209 offset:14336
    ds_read_b64_tr_b16 v[198:199], v209 offset:14848
    v_mfma_f32_32x32x16_bf16 v[64:79], v[188:191], v[164:167], v[64:79]
    s_waitcnt lgkmcnt(8)
    v_mfma_f32_32x32x16_bf16 v[48:63], v[192:195], v[168:171], v[48:63]
    v_mfma_f32_32x32x16_bf16 v[64:79], v[192:195], v[172:175], v[64:79]
    s_waitcnt lgkmcnt(0)
    v_mfma_f32_32x32x16_bf16 v[48:63], v[196:199], v[176:179], v[48:63]
    v_mfma_f32_32x32x16_bf16 v[64:79], v[196:199], v[180:183], v[64:79]
    s_mov_b32 exec_lo, 0
    v_mov_b64 v[238:239], 0
    s_mov_b32 exec_lo, -1
    s_nop 7
    v_cvt_pk_bf16_f32 v112, v48, v49
    v_cvt_pk_bf16_f32 v113, v50, v51
    v_cvt_pk_bf16_f32 v114, v52, v53
    v_cvt_pk_bf16_f32 v115, v54, v55
    v_cvt_pk_bf16_f32 v116, v56, v57
    v_cvt_pk_bf16_f32 v117, v58, v59
    v_cvt_pk_bf16_f32 v118, v60, v61
    v_cvt_pk_bf16_f32 v119, v62, v63
    v_mfma_f32_32x32x16_bf16 v[48:63], v[232:235], v[112:115], 0
    s_nop 0
    s_nop 0
    v_mfma_f32_32x32x16_bf16 v[48:63], v[236:239], v[116:119], v[48:63]
    v_cvt_pk_bf16_f32 v120, v64, v65
    v_cvt_pk_bf16_f32 v121, v66, v67
    v_cvt_pk_bf16_f32 v122, v68, v69
    v_cvt_pk_bf16_f32 v123, v70, v71
    v_cvt_pk_bf16_f32 v124, v72, v73
    v_cvt_pk_bf16_f32 v125, v74, v75
    v_cvt_pk_bf16_f32 v126, v76, v77
    v_cvt_pk_bf16_f32 v127, v78, v79
    v_mfma_f32_32x32x16_bf16 v[64:79], v[232:235], v[120:123], 0
    s_nop 0
    v_mfma_f32_32x32x16_bf16 v[64:79], v[236:239], v[124:127], v[64:79]
    s_nop 0
    v_max3_f32 v216, v48, v49, v50
    v_min3_f32 v218, v48, v49, v50
    v_max3_f32 v216, v216, v51, v52
    v_min3_f32 v218, v218, v51, v52
    v_max3_f32 v216, v216, v53, v54
    v_min3_f32 v218, v218, v53, v54
    v_max3_f32 v216, v216, v55, v56
    v_min3_f32 v218, v218, v55, v56
    v_max3_f32 v216, v216, v57, v58
    v_min3_f32 v218, v218, v57, v58
    v_max3_f32 v216, v216, v59, v60
    v_min3_f32 v218, v218, v59, v60
    v_max3_f32 v216, v216, v61, v62
    v_min3_f32 v218, v218, v61, v62
    v_max_f32 v216, v216, v63
    v_min_f32 v218, v218, v63
    v_max3_f32 v220, v64, v65, v66
    v_min3_f32 v222, v64, v65, v66
    v_max3_f32 v220, v220, v67, v68
    v_min3_f32 v222, v222, v67, v68
    v_max3_f32 v220, v220, v69, v70
    v_min3_f32 v222, v222, v69, v70
    v_max3_f32 v220, v220, v71, v72
    v_min3_f32 v222, v222, v71, v72
    v_max3_f32 v220, v220, v73, v74
    v_min3_f32 v222, v222, v73, v74
    v_max3_f32 v220, v220, v75, v76
    v_min3_f32 v222, v222, v75, v76
    v_max3_f32 v220, v220, v77, v78
    v_min3_f32 v222, v222, v77, v78
    v_max_f32 v220, v220, v79
    v_min_f32 v222, v222, v79
    s_barrier
    ds_read_b64_tr_b16 v[184:185], v208 offset:0
    ds_read_b64_tr_b16 v[186:187], v208 offset:512
    ds_read_b64_tr_b16 v[188:189], v208 offset:2048
    ds_read_b64_tr_b16 v[190:191], v208 offset:2560
    s_nop 0
    v_permlane32_swap_b32 v216, v220
    v_permlane32_swap_b32 v218, v222
    v_max_f32 v216, v216, v220
    v_min_f32 v218, v218, v222
    v_mul_f32 v220, s76, v216
    v_mul_f32 v216, s76, v216
    v_mul_f32 v222, s76, v218
    v_mul_f32 v218, s76, v218
    v_permlane32_swap_b32 v216, v220
    v_add_f32 v217, v216, v15
    v_permlane32_swap_b32 v218, v222
    v_add_f32 v221, v220, v15
    v_sub_f32 v219, v218, v15
    v_sub_f32 v223, v222, v15
    v_pk_fma_f32 v[112:113], v[48:49], s[76:77], v[216:217] op_sel_hi:[1,1,0] neg_lo:[0,0,1] neg_hi:[0,0,1]
    v_pk_fma_f32 v[128:129], v[48:49], s[76:77], v[218:219] op_sel_hi:[1,1,0] neg_lo:[1,0,0] neg_hi:[1,0,0]
    v_pk_fma_f32 v[114:115], v[50:51], s[76:77], v[216:217] op_sel_hi:[1,1,0] neg_lo:[0,0,1] neg_hi:[0,0,1]
    v_pk_fma_f32 v[130:131], v[50:51], s[76:77], v[218:219] op_sel_hi:[1,1,0] neg_lo:[1,0,0] neg_hi:[1,0,0]
    v_pk_fma_f32 v[116:117], v[52:53], s[76:77], v[216:217] op_sel_hi:[1,1,0] neg_lo:[0,0,1] neg_hi:[0,0,1]
    v_pk_fma_f32 v[132:133], v[52:53], s[76:77], v[218:219] op_sel_hi:[1,1,0] neg_lo:[1,0,0] neg_hi:[1,0,0]
    v_pk_fma_f32 v[118:119], v[54:55], s[76:77], v[216:217] op_sel_hi:[1,1,0] neg_lo:[0,0,1] neg_hi:[0,0,1]
    v_pk_fma_f32 v[134:135], v[54:55], s[76:77], v[218:219] op_sel_hi:[1,1,0] neg_lo:[1,0,0] neg_hi:[1,0,0]
    v_pk_fma_f32 v[120:121], v[56:57], s[76:77], v[216:217] op_sel_hi:[1,1,0] neg_lo:[0,0,1] neg_hi:[0,0,1]
    v_pk_fma_f32 v[136:137], v[56:57], s[76:77], v[218:219] op_sel_hi:[1,1,0] neg_lo:[1,0,0] neg_hi:[1,0,0]
    v_pk_fma_f32 v[122:123], v[58:59], s[76:77], v[216:217] op_sel_hi:[1,1,0] neg_lo:[0,0,1] neg_hi:[0,0,1]
    v_pk_fma_f32 v[138:139], v[58:59], s[76:77], v[218:219] op_sel_hi:[1,1,0] neg_lo:[1,0,0] neg_hi:[1,0,0]
    v_pk_fma_f32 v[124:125], v[60:61], s[76:77], v[216:217] op_sel:[0,0,1] op_sel_hi:[1,1,1] neg_lo:[0,0,1] neg_hi:[0,0,1]
    v_pk_fma_f32 v[140:141], v[60:61], s[76:77], v[218:219] op_sel:[0,0,1] op_sel_hi:[1,1,1] neg_lo:[1,0,0] neg_hi:[1,0,0]
    v_pk_fma_f32 v[126:127], v[62:63], s[76:77], v[216:217] op_sel:[0,0,1] op_sel_hi:[1,1,1] neg_lo:[0,0,1] neg_hi:[0,0,1]
    v_pk_fma_f32 v[142:143], v[62:63], s[76:77], v[218:219] op_sel:[0,0,1] op_sel_hi:[1,1,1] neg_lo:[1,0,0] neg_hi:[1,0,0]
    s_waitcnt lgkmcnt(2)
    v_mfma_f32_32x32x16_bf16 v[16:31], v[184:187], v[152:155], v[16:31]
    ds_read_b64_tr_b16 v[192:193], v209 offset:0
    ds_read_b64_tr_b16 v[194:195], v209 offset:512
    v_exp_f32 v112, v112
    v_exp_f32 v113, v113
    v_exp_f32 v114, v114
    v_mfma_f32_32x32x16_bf16 v[32:47], v[184:187], v[156:159], v[32:47]
    v_exp_f32 v115, v115
    v_exp_f32 v116, v116
    v_exp_f32 v117, v117
    s_waitcnt lgkmcnt(2)
    v_mfma_f32_32x32x16_bf16 v[16:31], v[188:191], v[160:163], v[16:31]
    ds_read_b64_tr_b16 v[196:197], v209 offset:2048
    ds_read_b64_tr_b16 v[198:199], v209 offset:2560
    v_exp_f32 v118, v118
    v_exp_f32 v119, v119
    v_exp_f32 v120, v120
    v_mfma_f32_32x32x16_bf16 v[32:47], v[188:191], v[164:167], v[32:47]
    v_exp_f32 v121, v121
    v_exp_f32 v122, v122
    v_exp_f32_e64 v123, v123
    s_waitcnt lgkmcnt(2)
    v_mfma_f32_32x32x16_bf16 v[16:31], v[192:195], v[168:171], v[16:31]
    ds_read_b128 v[152:155], v8 offset:0
    ds_read_b128 v[156:159], v8 offset:4096
    ds_read_b64_tr_b16 v[184:185], v212 offset:0
    ds_read_b64_tr_b16 v[186:187], v212 offset:512
    v_exp_f32 v124, v124
    v_exp_f32 v125, v125
    v_exp_f32 v126, v126
    v_mfma_f32_32x32x16_bf16 v[32:47], v[192:195], v[172:175], v[32:47]
    v_exp_f32 v127, v127
    v_exp_f32 v128, v128
    v_exp_f32_e64 v129, v129
    s_waitcnt lgkmcnt(4)
    v_mfma_f32_32x32x16_bf16 v[16:31], v[196:199], v[176:179], v[16:31]
    ds_read_b128 v[160:163], v9 offset:0
    ds_read_b128 v[164:167], v9 offset:4096
    ds_read_b64_tr_b16 v[188:189], v212 offset:2048
    ds_read_b64_tr_b16 v[190:191], v212 offset:2560
    v_exp_f32 v130, v130
    v_exp_f32 v131, v131
    v_exp_f32 v132, v132
    v_mfma_f32_32x32x16_bf16 v[32:47], v[196:199], v[180:183], v[32:47]
    v_exp_f32 v133, v133
    v_exp_f32 v134, v134
    v_exp_f32 v135, v135
    v_exp_f32 v136, v136
    v_exp_f32 v137, v137
    v_exp_f32 v138, v138
    v_exp_f32 v139, v139
    v_exp_f32 v140, v140
    v_exp_f32 v141, v141
    v_exp_f32 v142, v142
    v_exp_f32 v143, v143
    v_pk_add_f32 v[216:217], v[112:113], v[114:115]
    v_pk_add_f32 v[218:219], v[128:129], v[130:131]
    v_pk_add_f32 v[216:217], v[216:217], v[116:117]
    v_pk_add_f32 v[218:219], v[218:219], v[132:133]
    v_pk_add_f32 v[216:217], v[216:217], v[118:119]
    v_pk_add_f32 v[218:219], v[218:219], v[134:135]
    v_pk_add_f32 v[216:217], v[216:217], v[120:121]
    v_pk_add_f32 v[218:219], v[218:219], v[136:137]
    v_pk_add_f32 v[216:217], v[216:217], v[122:123]
    v_pk_add_f32 v[218:219], v[218:219], v[138:139]
    v_pk_add_f32 v[216:217], v[216:217], v[124:125]
    v_pk_add_f32 v[218:219], v[218:219], v[140:141]
    v_pk_add_f32 v[216:217], v[216:217], v[126:127]
    v_pk_add_f32 v[218:219], v[218:219], v[142:143]
    v_add_f32 v216, v216, v217
    v_add_f32 v218, v218, v219
    s_nop 1
    v_permlane32_swap_b32 v216, v218
    v_add_f32 v216, v216, v218
    v_rcp_f32 v216, v216
    s_nop 0
    v_mov_b32 v218, v216
    s_nop 1
    v_permlane32_swap_b32 v216, v218
    v_pk_mul_f32 v[112:113], v[112:113], v[216:217] op_sel_hi:[1,0]
    v_pk_mul_f32 v[114:115], v[114:115], v[216:217] op_sel_hi:[1,0]
    v_pk_mul_f32 v[116:117], v[116:117], v[216:217] op_sel_hi:[1,0]
    v_pk_mul_f32 v[118:119], v[118:119], v[216:217] op_sel_hi:[1,0]
    v_pk_mul_f32 v[120:121], v[120:121], v[216:217] op_sel_hi:[1,0]
    v_pk_mul_f32 v[122:123], v[122:123], v[216:217] op_sel_hi:[1,0]
    v_pk_mul_f32 v[124:125], v[124:125], v[216:217] op_sel_hi:[1,0]
    v_pk_mul_f32 v[126:127], v[126:127], v[216:217] op_sel_hi:[1,0]
    v_pk_mul_f32 v[128:129], v[128:129], v[218:219] op_sel_hi:[1,0]
    v_pk_mul_f32 v[130:131], v[130:131], v[218:219] op_sel_hi:[1,0]
    v_pk_mul_f32 v[132:133], v[132:133], v[218:219] op_sel_hi:[1,0]
    v_pk_mul_f32 v[134:135], v[134:135], v[218:219] op_sel_hi:[1,0]
    v_pk_mul_f32 v[136:137], v[136:137], v[218:219] op_sel_hi:[1,0]
    v_pk_mul_f32 v[138:139], v[138:139], v[218:219] op_sel_hi:[1,0]
    v_pk_mul_f32 v[140:141], v[140:141], v[218:219] op_sel_hi:[1,0]
    v_pk_mul_f32 v[142:143], v[142:143], v[218:219] op_sel_hi:[1,0]
    v_cvt_pk_bf16_f32 v48, v112, v113
    v_cvt_pk_bf16_f32 v49, v114, v115
    v_cvt_pk_bf16_f32 v50, v116, v117
    v_cvt_pk_bf16_f32 v51, v118, v119
    v_cvt_pk_bf16_f32 v52, v120, v121
    v_cvt_pk_bf16_f32 v53, v122, v123
    v_cvt_pk_bf16_f32 v54, v124, v125
    v_cvt_pk_bf16_f32 v55, v126, v127
    v_cvt_pk_bf16_f32 v56, v128, v129
    v_cvt_pk_bf16_f32 v57, v130, v131
    v_cvt_pk_bf16_f32 v58, v132, v133
    v_cvt_pk_bf16_f32 v59, v134, v135
    v_cvt_pk_bf16_f32 v60, v136, v137
    v_cvt_pk_bf16_f32 v61, v138, v139
    v_cvt_pk_bf16_f32 v62, v140, v141
    v_cvt_pk_bf16_f32 v63, v142, v143
    ds_write_b64 v200, v[48:49] offset:0
    ds_write_b64 v201, v[50:51] offset:0
    ds_write_b64 v202, v[52:53] offset:0
    ds_write_b64 v203, v[54:55] offset:0
    ds_write_b64 v200, v[56:57] offset:8192
    ds_write_b64 v201, v[58:59] offset:8192
    ds_write_b64 v202, v[60:61] offset:8192
    ds_write_b64 v203, v[62:63] offset:8192
    v_pk_fma_f32 v[112:113], v[64:65], s[76:77], v[220:221] op_sel_hi:[1,1,0] neg_lo:[0,0,1] neg_hi:[0,0,1]
    v_pk_fma_f32 v[128:129], v[64:65], s[76:77], v[222:223] op_sel_hi:[1,1,0] neg_lo:[1,0,0] neg_hi:[1,0,0]
    v_pk_fma_f32 v[114:115], v[66:67], s[76:77], v[220:221] op_sel_hi:[1,1,0] neg_lo:[0,0,1] neg_hi:[0,0,1]
    v_pk_fma_f32 v[130:131], v[66:67], s[76:77], v[222:223] op_sel_hi:[1,1,0] neg_lo:[1,0,0] neg_hi:[1,0,0]
    v_pk_fma_f32 v[116:117], v[68:69], s[76:77], v[220:221] op_sel_hi:[1,1,0] neg_lo:[0,0,1] neg_hi:[0,0,1]
    v_pk_fma_f32 v[132:133], v[68:69], s[76:77], v[222:223] op_sel_hi:[1,1,0] neg_lo:[1,0,0] neg_hi:[1,0,0]
    v_pk_fma_f32 v[118:119], v[70:71], s[76:77], v[220:221] op_sel_hi:[1,1,0] neg_lo:[0,0,1] neg_hi:[0,0,1]
    v_pk_fma_f32 v[134:135], v[70:71], s[76:77], v[222:223] op_sel_hi:[1,1,0] neg_lo:[1,0,0] neg_hi:[1,0,0]
    v_pk_fma_f32 v[120:121], v[72:73], s[76:77], v[220:221] op_sel_hi:[1,1,0] neg_lo:[0,0,1] neg_hi:[0,0,1]
    v_pk_fma_f32 v[136:137], v[72:73], s[76:77], v[222:223] op_sel_hi:[1,1,0] neg_lo:[1,0,0] neg_hi:[1,0,0]
    v_pk_fma_f32 v[122:123], v[74:75], s[76:77], v[220:221] op_sel_hi:[1,1,0] neg_lo:[0,0,1] neg_hi:[0,0,1]
    v_pk_fma_f32 v[138:139], v[74:75], s[76:77], v[222:223] op_sel_hi:[1,1,0] neg_lo:[1,0,0] neg_hi:[1,0,0]
    v_pk_fma_f32 v[124:125], v[76:77], s[76:77], v[220:221] op_sel:[0,0,1] op_sel_hi:[1,1,1] neg_lo:[0,0,1] neg_hi:[0,0,1]
    v_pk_fma_f32 v[140:141], v[76:77], s[76:77], v[222:223] op_sel:[0,0,1] op_sel_hi:[1,1,1] neg_lo:[1,0,0] neg_hi:[1,0,0]
    v_pk_fma_f32 v[126:127], v[78:79], s[76:77], v[220:221] op_sel:[0,0,1] op_sel_hi:[1,1,1] neg_lo:[0,0,1] neg_hi:[0,0,1]
    v_pk_fma_f32 v[142:143], v[78:79], s[76:77], v[222:223] op_sel:[0,0,1] op_sel_hi:[1,1,1] neg_lo:[1,0,0] neg_hi:[1,0,0]
    s_waitcnt lgkmcnt(12)
    s_nop 0
    v_mfma_f32_32x32x16_bf16 v[16:31], v[184:187], v[152:155], v[16:31]
    ds_read_b128 v[168:171], v10 offset:0
    ds_read_b128 v[172:175], v10 offset:4096
    ds_read_b64_tr_b16 v[192:193], v213 offset:0
    ds_read_b64_tr_b16 v[194:195], v213 offset:512
    v_exp_f32 v112, v112
    v_exp_f32 v113, v113
    v_exp_f32 v114, v114
    v_mfma_f32_32x32x16_bf16 v[32:47], v[184:187], v[156:159], v[32:47]
    v_exp_f32 v115, v115
    v_exp_f32 v116, v116
    v_exp_f32_e64 v117, v117
    s_waitcnt lgkmcnt(12)
    v_mfma_f32_32x32x16_bf16 v[16:31], v[188:191], v[160:163], v[16:31]
    ds_read_b128 v[176:179], v11 offset:0
    ds_read_b128 v[180:183], v11 offset:4096
    ds_read_b64_tr_b16 v[196:197], v213 offset:2048
    ds_read_b64_tr_b16 v[198:199], v213 offset:2560
    v_exp_f32 v118, v118
    v_exp_f32 v119, v119
    v_exp_f32 v120, v120
    v_mfma_f32_32x32x16_bf16 v[32:47], v[188:191], v[164:167], v[32:47]
    v_exp_f32 v121, v121
    v_exp_f32 v122, v122
    v_exp_f32 v123, v123
    s_waitcnt lgkmcnt(4)
    v_mfma_f32_32x32x16_bf16 v[16:31], v[192:195], v[168:171], v[16:31]
    v_exp_f32 v124, v124
    v_exp_f32 v125, v125
    v_exp_f32 v126, v126
    v_mfma_f32_32x32x16_bf16 v[32:47], v[192:195], v[172:175], v[32:47]
    v_exp_f32 v127, v127
    v_exp_f32 v128, v128
    v_exp_f32 v129, v129
    s_waitcnt lgkmcnt(0)
    v_mfma_f32_32x32x16_bf16 v[16:31], v[196:199], v[176:179], v[16:31]
    v_exp_f32 v130, v130
    v_exp_f32 v131, v131
    v_exp_f32 v132, v132
    v_mfma_f32_32x32x16_bf16 v[32:47], v[196:199], v[180:183], v[32:47]
    v_exp_f32 v133, v133
    v_exp_f32 v134, v134
    v_exp_f32 v135, v135
    v_exp_f32 v136, v136
    v_exp_f32 v137, v137
    v_exp_f32 v138, v138
    v_exp_f32 v139, v139
    v_exp_f32 v140, v140
    v_exp_f32 v141, v141
    v_exp_f32 v142, v142
    v_exp_f32 v143, v143
    v_pk_add_f32 v[220:221], v[112:113], v[114:115]
    v_pk_add_f32 v[222:223], v[128:129], v[130:131]
    v_pk_add_f32 v[220:221], v[220:221], v[116:117]
    v_pk_add_f32 v[222:223], v[222:223], v[132:133]
    v_pk_add_f32 v[220:221], v[220:221], v[118:119]
    v_pk_add_f32 v[222:223], v[222:223], v[134:135]
    v_pk_add_f32 v[220:221], v[220:221], v[120:121]
    v_pk_add_f32 v[222:223], v[222:223], v[136:137]
    v_pk_add_f32 v[220:221], v[220:221], v[122:123]
    v_pk_add_f32 v[222:223], v[222:223], v[138:139]
    v_pk_add_f32 v[220:221], v[220:221], v[124:125]
    v_pk_add_f32 v[222:223], v[222:223], v[140:141]
    v_pk_add_f32 v[220:221], v[220:221], v[126:127]
    v_pk_add_f32 v[222:223], v[222:223], v[142:143]
    v_add_f32 v220, v220, v221
    v_add_f32 v222, v222, v223
    s_nop 1
    v_permlane32_swap_b32 v220, v222
    v_add_f32 v220, v220, v222
    v_rcp_f32 v220, v220
    s_nop 0
    v_mov_b32 v222, v220
    s_nop 1
    v_permlane32_swap_b32 v220, v222
    v_pk_mul_f32 v[112:113], v[112:113], v[220:221] op_sel_hi:[1,0]
    v_pk_mul_f32 v[114:115], v[114:115], v[220:221] op_sel_hi:[1,0]
    v_pk_mul_f32 v[116:117], v[116:117], v[220:221] op_sel_hi:[1,0]
    v_pk_mul_f32 v[118:119], v[118:119], v[220:221] op_sel_hi:[1,0]
    v_pk_mul_f32 v[120:121], v[120:121], v[220:221] op_sel_hi:[1,0]
    v_pk_mul_f32 v[122:123], v[122:123], v[220:221] op_sel_hi:[1,0]
    v_pk_mul_f32 v[124:125], v[124:125], v[220:221] op_sel_hi:[1,0]
    v_pk_mul_f32 v[126:127], v[126:127], v[220:221] op_sel_hi:[1,0]
    v_pk_mul_f32 v[128:129], v[128:129], v[222:223] op_sel_hi:[1,0]
    v_pk_mul_f32 v[130:131], v[130:131], v[222:223] op_sel_hi:[1,0]
    v_pk_mul_f32 v[132:133], v[132:133], v[222:223] op_sel_hi:[1,0]
    v_pk_mul_f32 v[134:135], v[134:135], v[222:223] op_sel_hi:[1,0]
    v_pk_mul_f32 v[136:137], v[136:137], v[222:223] op_sel_hi:[1,0]
    v_pk_mul_f32 v[138:139], v[138:139], v[222:223] op_sel_hi:[1,0]
    v_pk_mul_f32 v[140:141], v[140:141], v[222:223] op_sel_hi:[1,0]
    v_pk_mul_f32 v[142:143], v[142:143], v[222:223] op_sel_hi:[1,0]
    v_cvt_pk_bf16_f32 v64, v112, v113
    v_cvt_pk_bf16_f32 v65, v114, v115
    v_cvt_pk_bf16_f32 v66, v116, v117
    v_cvt_pk_bf16_f32 v67, v118, v119
    v_cvt_pk_bf16_f32 v68, v120, v121
    v_cvt_pk_bf16_f32 v69, v122, v123
    v_cvt_pk_bf16_f32 v70, v124, v125
    v_cvt_pk_bf16_f32 v71, v126, v127
    v_cvt_pk_bf16_f32 v72, v128, v129
    v_cvt_pk_bf16_f32 v73, v130, v131
    v_cvt_pk_bf16_f32 v74, v132, v133
    v_cvt_pk_bf16_f32 v75, v134, v135
    v_cvt_pk_bf16_f32 v76, v136, v137
    v_cvt_pk_bf16_f32 v77, v138, v139
    v_cvt_pk_bf16_f32 v78, v140, v141
    v_cvt_pk_bf16_f32 v79, v142, v143
    s_barrier
    s_nop 0
    buffer_load_dwordx4 v[248:251], off, s[36:39], 0 sc1
    ds_read_b64_tr_b16 v[184:185], v212 offset:24576
    ds_read_b64_tr_b16 v[186:187], v212 offset:25088
    ds_read_b64_tr_b16 v[188:189], v212 offset:26624
    ds_read_b64_tr_b16 v[190:191], v212 offset:27136
    ds_write_b64 v200, v[64:65] offset:2048
    ds_write_b64 v201, v[66:67] offset:2048
    ds_write_b64 v202, v[68:69] offset:2048
    ds_write_b64 v203, v[70:71] offset:2048
    ds_write_b64 v200, v[72:73] offset:10240
    ds_write_b64 v201, v[74:75] offset:10240
    ds_write_b64 v202, v[76:77] offset:10240
    ds_write_b64 v203, v[78:79] offset:10240
    v_cvt_pk_bf16_f32 v112, v16, v17
    v_cvt_pk_bf16_f32 v113, v18, v19
    v_cvt_pk_bf16_f32 v114, v20, v21
    v_cvt_pk_bf16_f32 v115, v22, v23
    v_cvt_pk_bf16_f32 v116, v24, v25
    v_cvt_pk_bf16_f32 v117, v26, v27
    v_cvt_pk_bf16_f32 v118, v28, v29
    v_cvt_pk_bf16_f32 v119, v30, v31
    v_mfma_f32_32x32x16_bf16 v[16:31], v[232:235], v[112:115], 0
    s_nop 0
    s_nop 0
    v_mfma_f32_32x32x16_bf16 v[16:31], v[236:239], v[116:119], v[16:31]
    v_cvt_pk_bf16_f32 v120, v32, v33
    v_cvt_pk_bf16_f32 v121, v34, v35
    v_cvt_pk_bf16_f32 v122, v36, v37
    v_cvt_pk_bf16_f32 v123, v38, v39
    v_cvt_pk_bf16_f32 v124, v40, v41
    v_cvt_pk_bf16_f32 v125, v42, v43
    v_cvt_pk_bf16_f32 v126, v44, v45
    v_cvt_pk_bf16_f32 v127, v46, v47
    v_mfma_f32_32x32x16_bf16 v[32:47], v[232:235], v[120:123], 0
    s_nop 0
    v_mfma_f32_32x32x16_bf16 v[32:47], v[236:239], v[124:127], v[32:47]
    s_waitcnt lgkmcnt(10)
    v_mfma_f32_32x32x16_bf16 v[80:95], v[152:155], v[184:187], v[80:95]
    ds_read_b64_tr_b16 v[192:193], v213 offset:24576
    ds_read_b64_tr_b16 v[194:195], v213 offset:25088
    v_max3_f32 v216, v16, v17, v18
    v_mfma_f32_32x32x16_bf16 v[96:111], v[156:159], v[184:187], v[96:111]
    v_min3_f32 v218, v16, v17, v18
    v_max3_f32 v216, v216, v19, v20
    v_min3_f32 v218, v218, v19, v20
    v_max3_f32 v216, v216, v21, v22
    v_min3_f32 v218, v218, v21, v22
    s_waitcnt lgkmcnt(10)
    s_nop 0
    v_mfma_f32_32x32x16_bf16 v[80:95], v[160:163], v[188:191], v[80:95]
    ds_read_b64_tr_b16 v[196:197], v213 offset:26624
    ds_read_b64_tr_b16 v[198:199], v213 offset:27136
    v_max3_f32 v216, v216, v23, v24
    v_min3_f32 v218, v218, v23, v24
    v_max3_f32 v216, v216, v25, v26
    v_min3_f32 v218, v218, v25, v26
    v_max3_f32 v216, v216, v27, v28
    v_mfma_f32_32x32x16_bf16 v[96:111], v[164:167], v[188:191], v[96:111]
    v_min3_f32 v218, v218, v27, v28
    v_max3_f32 v216, v216, v29, v30
    v_min3_f32 v218, v218, v29, v30
    v_max_f32 v216, v216, v31
    v_min_f32_e64 v218, v218, v31
    s_waitcnt lgkmcnt(2)
    v_mfma_f32_32x32x16_bf16 v[80:95], v[168:171], v[192:195], v[80:95]
    ds_read_b128 v[152:155], v4 offset:0
    ds_read_b128 v[156:159], v4 offset:4096
    ds_read_b64_tr_b16 v[184:185], v208 offset:24576
    ds_read_b64_tr_b16 v[186:187], v208 offset:25088
    v_max3_f32 v220, v32, v33, v34
    v_min3_f32 v222, v32, v33, v34
    v_max3_f32 v220, v220, v35, v36
    v_min3_f32 v222, v222, v35, v36
    v_max3_f32 v220, v220, v37, v38
    v_mfma_f32_32x32x16_bf16 v[96:111], v[172:175], v[192:195], v[96:111]
    v_min3_f32 v222, v222, v37, v38
    v_max3_f32 v220, v220, v39, v40
    v_min3_f32 v222, v222, v39, v40
    v_max3_f32 v220, v220, v41, v42
    v_min3_f32 v222, v222, v41, v42
    s_waitcnt lgkmcnt(4)
    s_nop 0
    v_mfma_f32_32x32x16_bf16 v[80:95], v[176:179], v[196:199], v[80:95]
    ds_read_b128 v[160:163], v5 offset:0
    ds_read_b128 v[164:167], v5 offset:4096
    ds_read_b64_tr_b16 v[188:189], v208 offset:26624
    ds_read_b64_tr_b16 v[190:191], v208 offset:27136
    v_max3_f32 v220, v220, v43, v44
    v_min3_f32 v222, v222, v43, v44
    v_max3_f32 v220, v220, v45, v46
    v_min3_f32 v222, v222, v45, v46
    v_max_f32 v220, v220, v47
    v_mfma_f32_32x32x16_bf16 v[96:111], v[180:183], v[196:199], v[96:111]
    v_min_f32 v222, v222, v47
    s_nop 0
    v_permlane32_swap_b32 v216, v220
    v_permlane32_swap_b32 v218, v222
    v_max_f32 v216, v216, v220
    v_min_f32 v218, v218, v222
    v_mul_f32 v220, s76, v216
    v_mul_f32 v216, s76, v216
    v_mul_f32 v222, s76, v218
    v_mul_f32 v218, s76, v218
    v_permlane32_swap_b32 v216, v220
    v_add_f32 v217, v216, v15
    v_permlane32_swap_b32 v218, v222
    v_add_f32 v221, v220, v15
    v_sub_f32 v219, v218, v15
    v_sub_f32_e64 v223, v222, v15
    v_pk_fma_f32 v[112:113], v[16:17], s[76:77], v[216:217] op_sel_hi:[1,1,0] neg_lo:[0,0,1] neg_hi:[0,0,1]
    v_pk_fma_f32 v[128:129], v[16:17], s[76:77], v[218:219] op_sel_hi:[1,1,0] neg_lo:[1,0,0] neg_hi:[1,0,0]
    v_pk_fma_f32 v[114:115], v[18:19], s[76:77], v[216:217] op_sel_hi:[1,1,0] neg_lo:[0,0,1] neg_hi:[0,0,1]
    v_pk_fma_f32 v[130:131], v[18:19], s[76:77], v[218:219] op_sel_hi:[1,1,0] neg_lo:[1,0,0] neg_hi:[1,0,0]
    v_pk_fma_f32 v[116:117], v[20:21], s[76:77], v[216:217] op_sel_hi:[1,1,0] neg_lo:[0,0,1] neg_hi:[0,0,1]
    v_pk_fma_f32 v[132:133], v[20:21], s[76:77], v[218:219] op_sel_hi:[1,1,0] neg_lo:[1,0,0] neg_hi:[1,0,0]
    v_pk_fma_f32 v[118:119], v[22:23], s[76:77], v[216:217] op_sel_hi:[1,1,0] neg_lo:[0,0,1] neg_hi:[0,0,1]
    v_pk_fma_f32 v[134:135], v[22:23], s[76:77], v[218:219] op_sel_hi:[1,1,0] neg_lo:[1,0,0] neg_hi:[1,0,0]
    v_pk_fma_f32 v[120:121], v[24:25], s[76:77], v[216:217] op_sel_hi:[1,1,0] neg_lo:[0,0,1] neg_hi:[0,0,1]
    v_pk_fma_f32 v[136:137], v[24:25], s[76:77], v[218:219] op_sel_hi:[1,1,0] neg_lo:[1,0,0] neg_hi:[1,0,0]
    v_pk_fma_f32 v[122:123], v[26:27], s[76:77], v[216:217] op_sel_hi:[1,1,0] neg_lo:[0,0,1] neg_hi:[0,0,1]
    v_pk_fma_f32 v[138:139], v[26:27], s[76:77], v[218:219] op_sel_hi:[1,1,0] neg_lo:[1,0,0] neg_hi:[1,0,0]
    v_pk_fma_f32 v[124:125], v[28:29], s[76:77], v[216:217] op_sel:[0,0,1] op_sel_hi:[1,1,1] neg_lo:[0,0,1] neg_hi:[0,0,1]
    v_pk_fma_f32 v[140:141], v[28:29], s[76:77], v[218:219] op_sel:[0,0,1] op_sel_hi:[1,1,1] neg_lo:[1,0,0] neg_hi:[1,0,0]
    v_pk_fma_f32 v[126:127], v[30:31], s[76:77], v[216:217] op_sel:[0,0,1] op_sel_hi:[1,1,1] neg_lo:[0,0,1] neg_hi:[0,0,1]
    v_pk_fma_f32 v[142:143], v[30:31], s[76:77], v[218:219] op_sel:[0,0,1] op_sel_hi:[1,1,1] neg_lo:[1,0,0] neg_hi:[1,0,0]
    s_waitcnt lgkmcnt(4)
    s_nop 0
    v_mfma_f32_32x32x16_bf16 v[80:95], v[152:155], v[184:187], v[80:95]
    ds_read_b128 v[168:171], v6 offset:0
    ds_read_b128 v[172:175], v6 offset:4096
    ds_read_b64_tr_b16 v[192:193], v209 offset:24576
    ds_read_b64_tr_b16 v[194:195], v209 offset:25088
    v_exp_f32 v112, v112
    v_exp_f32 v113, v113
    v_exp_f32 v114, v114
    v_mfma_f32_32x32x16_bf16 v[96:111], v[156:159], v[184:187], v[96:111]
    v_exp_f32 v115, v115
    v_exp_f32 v116, v116
    v_exp_f32_e64 v117, v117
    s_waitcnt lgkmcnt(4)
    v_mfma_f32_32x32x16_bf16 v[80:95], v[160:163], v[188:191], v[80:95]
    ds_read_b128 v[176:179], v7 offset:0
    ds_read_b128 v[180:183], v7 offset:4096
    ds_read_b64_tr_b16 v[196:197], v209 offset:26624
    ds_read_b64_tr_b16 v[198:199], v209 offset:27136
    v_exp_f32 v118, v118
    v_exp_f32 v119, v119
    v_exp_f32 v120, v120
    v_mfma_f32_32x32x16_bf16 v[96:111], v[164:167], v[188:191], v[96:111]
    v_exp_f32 v121, v121
    v_exp_f32 v122, v122
    v_exp_f32 v123, v123
    s_waitcnt lgkmcnt(4)
    v_mfma_f32_32x32x16_bf16 v[80:95], v[168:171], v[192:195], v[80:95]
    v_exp_f32 v124, v124
    v_exp_f32 v125, v125
    v_exp_f32 v126, v126
    v_mfma_f32_32x32x16_bf16 v[96:111], v[172:175], v[192:195], v[96:111]
    v_exp_f32 v127, v127
    v_exp_f32 v128, v128
    v_exp_f32 v129, v129
    s_waitcnt lgkmcnt(0)
    v_mfma_f32_32x32x16_bf16 v[80:95], v[176:179], v[196:199], v[80:95]
    v_exp_f32 v130, v130
    v_exp_f32 v131, v131
    v_exp_f32 v132, v132
    v_mfma_f32_32x32x16_bf16 v[96:111], v[180:183], v[196:199], v[96:111]
    v_exp_f32 v133, v133
    v_exp_f32 v134, v134
    v_exp_f32 v135, v135
    v_exp_f32 v136, v136
    v_exp_f32 v137, v137
    v_exp_f32 v138, v138
    v_exp_f32 v139, v139
    v_exp_f32 v140, v140
    v_exp_f32 v141, v141
    v_exp_f32 v142, v142
    v_exp_f32 v143, v143
    v_cvt_pk_bf16_f32 v16, v112, v113
    v_cvt_pk_bf16_f32 v17, v114, v115
    v_cvt_pk_bf16_f32 v18, v116, v117
    v_cvt_pk_bf16_f32 v19, v118, v119
    v_cvt_pk_bf16_f32 v20, v120, v121
    v_cvt_pk_bf16_f32 v21, v122, v123
    v_cvt_pk_bf16_f32 v22, v124, v125
    v_cvt_pk_bf16_f32 v23, v126, v127
    v_cvt_pk_bf16_f32 v80, v80, v81
    v_cvt_pk_bf16_f32 v81, v82, v83
    v_cvt_pk_bf16_f32 v82, v84, v85
    v_cvt_pk_bf16_f32 v83, v86, v87
    v_cvt_pk_bf16_f32 v84, v88, v89
    v_cvt_pk_bf16_f32 v85, v90, v91
    v_cvt_pk_bf16_f32 v86, v92, v93
    v_cvt_pk_bf16_f32 v87, v94, v95
    s_mov_b64 exec, s[100:101]
    v_mov_b64 v[80:81], v[228:229]
    v_mov_b64 v[82:83], v[228:229]
    v_mov_b64 v[84:85], v[228:229]
    v_mov_b64 v[86:87], v[228:229]
    s_mov_b64 exec, -1
    ds_write_b128 v214, v[80:83] offset:0
    ds_write_b128 v214, v[84:87] offset:1024
    v_cvt_pk_bf16_f32 v96, v96, v97
    v_cvt_pk_bf16_f32 v97, v98, v99
    v_cvt_pk_bf16_f32 v98, v100, v101
    v_cvt_pk_bf16_f32 v99, v102, v103
    v_cvt_pk_bf16_f32 v100, v104, v105
    v_cvt_pk_bf16_f32 v101, v106, v107
    v_cvt_pk_bf16_f32 v102, v108, v109
    v_cvt_pk_bf16_f32 v103, v110, v111
    s_mov_b64 exec, s[100:101]
    v_mov_b64 v[96:97], v[228:229]
    v_mov_b64 v[98:99], v[228:229]
    v_mov_b64 v[100:101], v[228:229]
    v_mov_b64 v[102:103], v[228:229]
    s_mov_b64 exec, -1
    ds_write_b128 v214, v[96:99] offset:2048
    ds_write_b128 v214, v[100:103] offset:3072
    ds_write_b32 v12, v12
    v_pk_add_f32 v[216:217], v[112:113], v[114:115]
    v_pk_add_f32 v[218:219], v[128:129], v[130:131]
    v_pk_add_f32 v[216:217], v[216:217], v[116:117]
    v_pk_add_f32 v[218:219], v[218:219], v[132:133]
    v_pk_add_f32 v[216:217], v[216:217], v[118:119]
    v_pk_add_f32 v[218:219], v[218:219], v[134:135]
    v_pk_add_f32 v[216:217], v[216:217], v[120:121]
    v_pk_add_f32 v[218:219], v[218:219], v[136:137]
    v_pk_add_f32 v[216:217], v[216:217], v[122:123]
    v_pk_add_f32 v[218:219], v[218:219], v[138:139]
    v_pk_add_f32 v[216:217], v[216:217], v[124:125]
    v_pk_add_f32 v[218:219], v[218:219], v[140:141]
    v_pk_add_f32 v[216:217], v[216:217], v[126:127]
    v_pk_add_f32 v[218:219], v[218:219], v[142:143]
    v_add_f32 v216, v216, v217
    v_add_f32 v218, v218, v219
    s_nop 1
    v_permlane32_swap_b32 v216, v218
    v_add_f32 v230, v216, v218
    v_add_f32 v218, v216, v218
    s_nop 1
    v_permlane32_swap_b32 v230, v218
    v_rcp_f32 v218, v218
    s_nop 0
    v_mul_f32_e64 v218, v218, v230
    v_pk_mul_f32 v[128:129], v[128:129], v[218:219] op_sel_hi:[1,0]
    v_pk_mul_f32 v[130:131], v[130:131], v[218:219] op_sel_hi:[1,0]
    v_pk_mul_f32 v[132:133], v[132:133], v[218:219] op_sel_hi:[1,0]
    v_pk_mul_f32 v[134:135], v[134:135], v[218:219] op_sel_hi:[1,0]
    v_pk_mul_f32 v[136:137], v[136:137], v[218:219] op_sel_hi:[1,0]
    v_pk_mul_f32 v[138:139], v[138:139], v[218:219] op_sel_hi:[1,0]
    v_pk_mul_f32 v[140:141], v[140:141], v[218:219] op_sel_hi:[1,0]
    v_pk_mul_f32 v[142:143], v[142:143], v[218:219] op_sel_hi:[1,0]
    v_cvt_pk_bf16_f32 v24, v128, v129
    v_cvt_pk_bf16_f32 v25, v130, v131
    v_cvt_pk_bf16_f32 v26, v132, v133
    v_cvt_pk_bf16_f32 v27, v134, v135
    v_cvt_pk_bf16_f32 v28, v136, v137
    v_cvt_pk_bf16_f32 v29, v138, v139
    v_cvt_pk_bf16_f32 v30, v140, v141
    v_cvt_pk_bf16_f32 v31, v142, v143
    s_mov_b32 s90, 0x400000
    ds_read_b32 v2, v13
    ds_read_b64_tr_b16 v[48:49], v204 offset:0
    ds_read_b64_tr_b16 v[50:51], v205 offset:512
    ds_read_b64_tr_b16 v[52:53], v204 offset:1024
    ds_read_b64_tr_b16 v[54:55], v205 offset:1536
    ds_read_b64_tr_b16 v[56:57], v204 offset:2048
    ds_read_b64_tr_b16 v[58:59], v205 offset:2560
    ds_read_b64_tr_b16 v[60:61], v204 offset:3072
    ds_read_b64_tr_b16 v[62:63], v205 offset:3584
    v_pk_fma_f32 v[112:113], v[32:33], s[76:77], v[220:221] op_sel_hi:[1,1,0] neg_lo:[0,0,1] neg_hi:[0,0,1]
    v_pk_fma_f32 v[128:129], v[32:33], s[76:77], v[222:223] op_sel_hi:[1,1,0] neg_lo:[1,0,0] neg_hi:[1,0,0]
    v_pk_fma_f32 v[114:115], v[34:35], s[76:77], v[220:221] op_sel_hi:[1,1,0] neg_lo:[0,0,1] neg_hi:[0,0,1]
    v_pk_fma_f32 v[130:131], v[34:35], s[76:77], v[222:223] op_sel_hi:[1,1,0] neg_lo:[1,0,0] neg_hi:[1,0,0]
    v_pk_fma_f32 v[116:117], v[36:37], s[76:77], v[220:221] op_sel_hi:[1,1,0] neg_lo:[0,0,1] neg_hi:[0,0,1]
    v_pk_fma_f32 v[132:133], v[36:37], s[76:77], v[222:223] op_sel_hi:[1,1,0] neg_lo:[1,0,0] neg_hi:[1,0,0]
    v_pk_fma_f32 v[118:119], v[38:39], s[76:77], v[220:221] op_sel_hi:[1,1,0] neg_lo:[0,0,1] neg_hi:[0,0,1]
    v_pk_fma_f32 v[134:135], v[38:39], s[76:77], v[222:223] op_sel_hi:[1,1,0] neg_lo:[1,0,0] neg_hi:[1,0,0]
    v_pk_fma_f32 v[120:121], v[40:41], s[76:77], v[220:221] op_sel_hi:[1,1,0] neg_lo:[0,0,1] neg_hi:[0,0,1]
    v_pk_fma_f32 v[136:137], v[40:41], s[76:77], v[222:223] op_sel_hi:[1,1,0] neg_lo:[1,0,0] neg_hi:[1,0,0]
    v_pk_fma_f32 v[122:123], v[42:43], s[76:77], v[220:221] op_sel_hi:[1,1,0] neg_lo:[0,0,1] neg_hi:[0,0,1]
    v_pk_fma_f32 v[138:139], v[42:43], s[76:77], v[222:223] op_sel_hi:[1,1,0] neg_lo:[1,0,0] neg_hi:[1,0,0]
    v_pk_fma_f32 v[124:125], v[44:45], s[76:77], v[220:221] op_sel:[0,0,1] op_sel_hi:[1,1,1] neg_lo:[0,0,1] neg_hi:[0,0,1]
    v_pk_fma_f32 v[140:141], v[44:45], s[76:77], v[222:223] op_sel:[0,0,1] op_sel_hi:[1,1,1] neg_lo:[1,0,0] neg_hi:[1,0,0]
    v_pk_fma_f32 v[126:127], v[46:47], s[76:77], v[220:221] op_sel:[0,0,1] op_sel_hi:[1,1,1] neg_lo:[0,0,1] neg_hi:[0,0,1]
    v_pk_fma_f32 v[142:143], v[46:47], s[76:77], v[222:223] op_sel:[0,0,1] op_sel_hi:[1,1,1] neg_lo:[1,0,0] neg_hi:[1,0,0]
L_pair:
    s_waitcnt lgkmcnt(0)
    v_cmp_ne_u32 vcc, 0, v2
    s_cbranch_vccnz L_paird
    ds_read_b32 v2, v13
    s_sub_u32 s90, s90, 1
    s_cbranch_scc0 L_pair
    s_waitcnt lgkmcnt(0)
L_paird:
    ds_read_b64_tr_b16 v[64:65], v206 offset:0
    ds_read_b64_tr_b16 v[66:67], v207 offset:512
    ds_read_b128 v[160:163], v215 offset:0
    ds_read_b64_tr_b16 v[68:69], v206 offset:1024
    ds_read_b64_tr_b16 v[70:71], v207 offset:1536
    ds_read_b128 v[164:167], v215 offset:1024
    ds_read_b64_tr_b16 v[72:73], v206 offset:2048
    ds_read_b64_tr_b16 v[74:75], v207 offset:2560
    ds_read_b128 v[168:171], v215 offset:2048
    ds_read_b64_tr_b16 v[76:77], v206 offset:3072
    ds_read_b64_tr_b16 v[78:79], v207 offset:3584
    ds_read_b128 v[172:175], v215 offset:3072
    v_mfma_f32_32x32x16_bf16 v[144:159], v[48:51], v[80:83], 0
    v_exp_f32 v112, v112
    v_exp_f32 v113, v113
    v_exp_f32 v114, v114
    v_mfma_f32_32x32x16_bf16 v[144:159], v[52:55], v[84:87], v[144:159]
    v_exp_f32 v115, v115
    v_exp_f32 v116, v116
    v_exp_f32 v117, v117
    v_mfma_f32_32x32x16_bf16 v[144:159], v[56:59], v[96:99], v[144:159]
    v_exp_f32 v118, v118
    v_exp_f32 v119, v119
    v_exp_f32 v120, v120
    v_mfma_f32_32x32x16_bf16 v[144:159], v[60:63], v[100:103], v[144:159]
    v_exp_f32 v121, v121
    v_exp_f32 v122, v122
    v_exp_f32 v123, v123
    s_waitcnt lgkmcnt(9)
    v_mfma_f32_32x32x16_bf16 v[144:159], v[64:67], v[160:163], v[144:159]
    v_exp_f32 v124, v124
    v_exp_f32 v125, v125
    v_exp_f32 v126, v126
    s_waitcnt lgkmcnt(6)
    v_mfma_f32_32x32x16_bf16 v[144:159], v[68:71], v[164:167], v[144:159]
    v_exp_f32 v127, v127
    v_exp_f32 v128, v128
    v_exp_f32 v129, v129
    s_waitcnt lgkmcnt(3)
    v_mfma_f32_32x32x16_bf16 v[144:159], v[72:75], v[168:171], v[144:159]
    v_exp_f32 v130, v130
    v_exp_f32 v131, v131
    v_exp_f32 v132, v132
    s_waitcnt lgkmcnt(0)
    v_mfma_f32_32x32x16_bf16 v[144:159], v[76:79], v[172:175], v[144:159]
    v_exp_f32 v133, v133
    v_exp_f32 v134, v134
    v_exp_f32 v135, v135
    v_exp_f32 v136, v136
    v_exp_f32 v137, v137
    v_exp_f32 v138, v138
    v_exp_f32 v139, v139
    v_exp_f32 v140, v140
    v_exp_f32 v141, v141
    v_exp_f32 v142, v142
    v_exp_f32 v143, v143
    v_cvt_pk_bf16_f32 v32, v112, v113
    v_cvt_pk_bf16_f32 v33, v114, v115
    v_cvt_pk_bf16_f32 v34, v116, v117
    v_cvt_pk_bf16_f32 v35, v118, v119
    v_cvt_pk_bf16_f32 v36, v120, v121
    v_cvt_pk_bf16_f32 v37, v122, v123
    v_cvt_pk_bf16_f32 v38, v124, v125
    v_cvt_pk_bf16_f32 v39, v126, v127
    v_pk_add_f32 v[220:221], v[112:113], v[114:115]
    v_pk_add_f32 v[222:223], v[128:129], v[130:131]
    v_pk_add_f32 v[220:221], v[220:221], v[116:117]
    v_pk_add_f32 v[222:223], v[222:223], v[132:133]
    v_pk_add_f32 v[220:221], v[220:221], v[118:119]
    v_pk_add_f32 v[222:223], v[222:223], v[134:135]
    v_pk_add_f32 v[220:221], v[220:221], v[120:121]
    v_pk_add_f32 v[222:223], v[222:223], v[136:137]
    v_pk_add_f32 v[220:221], v[220:221], v[122:123]
    v_pk_add_f32 v[222:223], v[222:223], v[138:139]
    v_pk_add_f32 v[220:221], v[220:221], v[124:125]
    v_pk_add_f32 v[222:223], v[222:223], v[140:141]
    v_pk_add_f32 v[220:221], v[220:221], v[126:127]
    v_pk_add_f32 v[222:223], v[222:223], v[142:143]
    v_add_f32 v220, v220, v221
    v_add_f32 v222, v222, v223
    s_nop 1
    v_permlane32_swap_b32 v220, v222
    v_add_f32 v231, v220, v222
    v_add_f32 v222, v220, v222
    s_nop 1
    v_permlane32_swap_b32 v231, v222
    v_rcp_f32 v222, v222
    s_nop 0
    v_mul_f32_e64 v222, v222, v231
    v_pk_mul_f32 v[128:129], v[128:129], v[222:223] op_sel_hi:[1,0]
    v_pk_mul_f32 v[130:131], v[130:131], v[222:223] op_sel_hi:[1,0]
    v_pk_mul_f32 v[132:133], v[132:133], v[222:223] op_sel_hi:[1,0]
    v_pk_mul_f32 v[134:135], v[134:135], v[222:223] op_sel_hi:[1,0]
    v_pk_mul_f32 v[136:137], v[136:137], v[222:223] op_sel_hi:[1,0]
    v_pk_mul_f32 v[138:139], v[138:139], v[222:223] op_sel_hi:[1,0]
    v_pk_mul_f32 v[140:141], v[140:141], v[222:223] op_sel_hi:[1,0]
    v_pk_mul_f32 v[142:143], v[142:143], v[222:223] op_sel_hi:[1,0]
    v_cvt_pk_bf16_f32 v40, v128, v129
    v_cvt_pk_bf16_f32 v41, v130, v131
    v_cvt_pk_bf16_f32 v42, v132, v133
    v_cvt_pk_bf16_f32 v43, v134, v135
    v_cvt_pk_bf16_f32 v44, v136, v137
    v_cvt_pk_bf16_f32 v45, v138, v139
    v_cvt_pk_bf16_f32 v46, v140, v141
    v_cvt_pk_bf16_f32 v47, v142, v143
    s_barrier
    buffer_store_dwordx4 v[144:147], v1, s[32:35], s78 offen offset:0 sc1
    buffer_store_dwordx4 v[148:151], v1, s[32:35], s78 offen offset:1024 sc1
    buffer_store_dwordx4 v[152:155], v1, s[32:35], s78 offen offset:2048 sc1
    buffer_store_dwordx4 v[156:159], v1, s[32:35], s78 offen offset:3072 sc1
    s_barrier
    s_waitcnt vmcnt(0)
    s_mov_b64 exec, 255
    buffer_store_dwordx4 v[248:251], v1, s[32:35], s82 offen sc1
    s_mov_b64 exec, -1
    v_and_b32 v2, 3, v0
    v_lshlrev_b32 v2, 4, v2
    v_lshrrev_b64 v[2:3], v2, v[248:249]
    v_lshlrev_b32 v253, 16, v2
    s_mov_b32 s86, 0x07060302
    s_mov_b32 s87, 0x07060100
    s_cmp_ge_u32 s59, 28
    s_cbranch_scc1 L_nowo_12
    s_lshl_b32 s96, s65, 7
    s_mul_i32 s94, s57, 100352
    s_add_u32 s96, s96, s94
    s_mul_i32 s95, s57, 14336
    s_add_u32 m0, s95, 0
    s_add_u32 s94, s96, 0
    buffer_load_dwordx4 v224, s[48:51], s94 offen offset:0 lds
    s_waitcnt vmcnt(1)
    buffer_load_dwordx4 v225, s[48:51], s94 offen offset:1024 lds
    s_waitcnt vmcnt(1)
    buffer_load_dwordx4 v226, s[48:51], s94 offen offset:2048 lds
    s_waitcnt vmcnt(1)
    buffer_load_dwordx4 v227, s[48:51], s94 offen offset:3072 lds
    s_waitcnt vmcnt(1)
    s_add_u32 m0, s95, 4096
    s_add_u32 s94, s96, 28672
    buffer_load_dwordx4 v224, s[48:51], s94 offen offset:0 lds
    s_waitcnt vmcnt(1)
    buffer_load_dwordx4 v225, s[48:51], s94 offen offset:1024 lds
    s_waitcnt vmcnt(1)
    buffer_load_dwordx4 v226, s[48:51], s94 offen offset:2048 lds
    s_waitcnt vmcnt(1)
    buffer_load_dwordx4 v227, s[48:51], s94 offen offset:3072 lds
    s_waitcnt vmcnt(1)
    s_add_u32 m0, s95, 8192
    s_add_u32 s94, s96, 57344
    buffer_load_dwordx4 v224, s[48:51], s94 offen offset:0 lds
    s_waitcnt vmcnt(1)
    buffer_load_dwordx4 v225, s[48:51], s94 offen offset:1024 lds
    s_waitcnt vmcnt(1)
    buffer_load_dwordx4 v226, s[48:51], s94 offen offset:2048 lds
    s_waitcnt vmcnt(1)
    buffer_load_dwordx4 v227, s[48:51], s94 offen offset:3072 lds
    s_waitcnt vmcnt(1)
    s_add_u32 m0, s95, 12288
    s_add_u32 s94, s96, 86016
    buffer_load_dwordx4 v224, s[48:51], s94 offen offset:0 lds
    s_waitcnt vmcnt(1)
    buffer_load_dwordx4 v225, s[48:51], s94 offen offset:1024 lds
    s_waitcnt vmcnt(1)
    s_add_u32 m0, s95, 57344
    s_add_u32 s94, s96, 0
    buffer_load_dwordx4 v224, s[44:47], s94 offen offset:0 lds
    s_waitcnt vmcnt(1)
    buffer_load_dwordx4 v225, s[44:47], s94 offen offset:1024 lds
    s_waitcnt vmcnt(1)
    buffer_load_dwordx4 v226, s[44:47], s94 offen offset:2048 lds
    s_waitcnt vmcnt(1)
    buffer_load_dwordx4 v227, s[44:47], s94 offen offset:3072 lds
    s_waitcnt vmcnt(1)
L_nowo_12:
    s_lshl_b32 s79, s72, 10
    s_add_u32 s79, s79, 327680
    s_lshr_b32 s80, s61, 2
    s_lshl_b32 s80, s80, 14
    s_add_u32 s79, s79, s80
    s_lshl_b32 s78, s72, 12
    s_add_u32 s78, s78, 589824
    v_lshlrev_b32 v15, 7, v0
    v_add_u32 v15, s79, v15
    s_mov_b64 exec, 255
    s_mov_b32 s90, 0x40000
L_poll_13:
    buffer_load_dwordx2 v[2:3], v15, s[32:35], 0 offen sc1
    s_waitcnt vmcnt(0)
    v_cmp_ne_u64 vcc, v[248:249], v[2:3]
    s_cbranch_vccz L_polld_14
    s_mov_b64 exec, vcc
    s_sleep 8
    s_sub_u32 s90, s90, 1
    s_cbranch_scc0 L_poll_13
L_polld_14:
    s_mov_b64 exec, -1
    buffer_load_dwordx4 v[48:51], v1, s[32:35], s78 offen offset:0 sc1
    buffer_load_dwordx4 v[52:55], v1, s[32:35], s78 offen offset:1024 sc1
    buffer_load_dwordx4 v[56:59], v1, s[32:35], s78 offen offset:2048 sc1
    buffer_load_dwordx4 v[60:63], v1, s[32:35], s78 offen offset:3072 sc1
    s_lshl1_add_u32 s83, s61, s70
    s_lshl_b32 s78, s83, 5
    s_add_u32 s78, s78, s72
    s_lshl_b32 s78, s78, 11
    s_add_u32 s78, s78, 10485760
    s_add_u32 s79, s78, 32768
    s_lshl4_add_u32 s82, s83, s72
    s_lshl_b32 s82, s82, 7
    s_add_u32 s82, s82, 65536
    s_waitcnt vmcnt(0)
    v_mfma_f32_32x32x16_bf16 v[112:127], v[48:51], v[16:19], 0
    v_mfma_f32_32x32x16_bf16 v[112:127], v[52:55], v[20:23], v[112:127]
    v_mfma_f32_32x32x16_bf16 v[112:127], v[56:59], v[24:27], v[112:127]
    v_mfma_f32_32x32x16_bf16 v[112:127], v[60:63], v[28:31], v[112:127]
    v_mfma_f32_32x32x16_bf16 v[128:143], v[48:51], v[32:35], 0
    v_mfma_f32_32x32x16_bf16 v[128:143], v[52:55], v[36:39], v[128:143]
    v_mfma_f32_32x32x16_bf16 v[128:143], v[56:59], v[40:43], v[128:143]
    v_mfma_f32_32x32x16_bf16 v[128:143], v[60:63], v[44:47], v[128:143]
    s_nop 7
    v_mov_b32 v4, v124
    v_mov_b32 v5, v124
    s_nop 1
    v_permlane32_swap_b32 v4, v5
    v_fmac_f32 v5, 0x358637bd, v230
    v_rcp_f32 v4, v5
    s_nop 0
    v_mul_f32 v112, v112, v4
    v_mul_f32 v113, v113, v4
    v_mul_f32 v114, v114, v4
    v_mul_f32 v115, v115, v4
    v_mul_f32 v116, v116, v4
    v_mul_f32 v117, v117, v4
    v_mul_f32 v118, v118, v4
    v_mul_f32 v119, v119, v4
    v_mul_f32 v120, v120, v4
    v_mul_f32 v121, v121, v4
    v_mul_f32 v122, v122, v4
    v_mul_f32 v123, v123, v4
    v_mul_f32 v124, v124, v4
    v_mul_f32 v125, v125, v4
    v_mul_f32 v126, v126, v4
    v_mul_f32_e64 v127, v127, v4
    v_cvt_pk_bf16_f32 v70, v124, v125
    v_cvt_pk_bf16_f32 v71, v126, v127
    v_cvt_pk_bf16_f32 v64, v112, v113
    v_cvt_pk_bf16_f32 v65, v114, v115
    v_cvt_pk_bf16_f32 v66, v116, v117
    v_cvt_pk_bf16_f32 v67, v118, v119
    v_cvt_pk_bf16_f32 v68, v120, v121
    v_cvt_pk_bf16_f32 v69, v122, v123
    v_permlane32_swap_b32 v70, v71
    v_perm_b32 v71, v253, v67, s86
    v_perm_b32 v67, v253, v67, s87
    buffer_store_dwordx4 v[64:67], v1, s[32:35], s78 offen offset:0 sc1
    buffer_store_dwordx4 v[68:71], v1, s[32:35], s78 offen offset:1024 sc1
    v_mov_b32 v4, v140
    v_mov_b32 v5, v140
    s_nop 1
    v_permlane32_swap_b32 v4, v5
    v_fmac_f32 v5, 0x358637bd, v231
    v_rcp_f32 v4, v5
    s_nop 0
    v_mul_f32 v128, v128, v4
    v_mul_f32 v129, v129, v4
    v_mul_f32 v130, v130, v4
    v_mul_f32 v131, v131, v4
    v_mul_f32 v132, v132, v4
    v_mul_f32 v133, v133, v4
    v_mul_f32 v134, v134, v4
    v_mul_f32 v135, v135, v4
    v_mul_f32 v136, v136, v4
    v_mul_f32 v137, v137, v4
    v_mul_f32 v138, v138, v4
    v_mul_f32 v139, v139, v4
    v_mul_f32 v140, v140, v4
    v_mul_f32 v141, v141, v4
    v_mul_f32 v142, v142, v4
    v_mul_f32_e64 v143, v143, v4
    v_cvt_pk_bf16_f32 v78, v140, v141
    v_cvt_pk_bf16_f32 v79, v142, v143
    v_cvt_pk_bf16_f32 v72, v128, v129
    v_cvt_pk_bf16_f32 v73, v130, v131
    v_cvt_pk_bf16_f32 v74, v132, v133
    v_cvt_pk_bf16_f32 v75, v134, v135
    v_cvt_pk_bf16_f32 v76, v136, v137
    v_cvt_pk_bf16_f32 v77, v138, v139
    v_permlane32_swap_b32 v78, v79
    s_nop 0
    v_perm_b32 v79, v253, v75, s86
    v_perm_b32 v75, v253, v75, s87
    buffer_store_dwordx4 v[72:75], v1, s[32:35], s79 offen offset:0 sc1
    buffer_store_dwordx4 v[76:79], v1, s[32:35], s79 offen offset:1024 sc1
    s_mov_b64 exec, 255
    buffer_store_dwordx4 v[248:251], v1, s[32:35], s82 offen sc1
    s_mov_b64 exec, -1
    s_add_u32 s82, s57, 3
    s_and_b32 s82, s82, 3
    s_lshl_b32 s82, s82, 12
    s_add_u32 s82, s82, 151040
    v_mov_b32 v9, s82
    s_movk_i32 s90, 64
L_go_15:
    ds_read_b32 v13, v9
    s_waitcnt lgkmcnt(0)
    v_cmp_ne_u32 vcc, 0, v13
    s_cbranch_vccnz L_god_16
    s_sleep 3
    s_sub_u32 s90, s90, 1
    s_cbranch_scc0 L_go_15
L_god_16:
    s_cmp_ge_u32 s59, 28
    s_cbranch_scc1 L_nowo_17
    s_lshl_b32 s96, s65, 7
    s_mul_i32 s94, s57, 100352
    s_add_u32 s96, s96, s94
    s_mul_i32 s95, s57, 14336
    s_add_u32 m0, s95, 61440
    s_add_u32 s94, s96, 28672
    buffer_load_dwordx4 v224, s[44:47], s94 offen offset:0 lds
    s_waitcnt vmcnt(8)
    buffer_load_dwordx4 v225, s[44:47], s94 offen offset:1024 lds
    s_waitcnt vmcnt(8)
    buffer_load_dwordx4 v226, s[44:47], s94 offen offset:2048 lds
    s_waitcnt vmcnt(8)
    buffer_load_dwordx4 v227, s[44:47], s94 offen offset:3072 lds
    s_waitcnt vmcnt(8)
    s_add_u32 m0, s95, 65536
    s_add_u32 s94, s96, 57344
    buffer_load_dwordx4 v224, s[44:47], s94 offen offset:0 lds
    s_waitcnt vmcnt(8)
    buffer_load_dwordx4 v225, s[44:47], s94 offen offset:1024 lds
    s_waitcnt vmcnt(8)
    buffer_load_dwordx4 v226, s[44:47], s94 offen offset:2048 lds
    s_waitcnt vmcnt(8)
    buffer_load_dwordx4 v227, s[44:47], s94 offen offset:3072 lds
    s_waitcnt vmcnt(8)
    s_add_u32 m0, s95, 69632
    s_add_u32 s94, s96, 86016
    buffer_load_dwordx4 v224, s[44:47], s94 offen offset:0 lds
    s_waitcnt vmcnt(8)
    buffer_load_dwordx4 v225, s[44:47], s94 offen offset:1024 lds
    s_waitcnt vmcnt(8)
L_nowo_17:
L_G_p3:
    s_cmp_ge_u32 s59, 28
    s_cbranch_scc1 L_fin
    s_mov_b32 s76, s85
    s_add_u32 s77, s85, 4096
    s_add_u32 s78, s85, 8192
    s_add_u32 s79, s85, 12288
    s_lshl_b32 s82, s57, 12
    s_add_u32 s82, s82, 147460
    v_mov_b32_e64 v10, s82
    v_xor_b32 v11, 8192, v10
    s_mov_b32 s90, 0x40000
L_ob_try:
    s_mov_b64 exec, 0xff
    buffer_load_dwordx2 v[14:15], v247, s[32:35], 0 offen sc1
    ds_read_b32 v13, v9
    s_waitcnt vmcnt(0) lgkmcnt(0)
    v_cmp_ne_u64 vcc, v[248:249], v[14:15]
    v_cmp_lt_u32 s[82:83], 1, v13
    s_mov_b64 exec, -1
    s_cbranch_vccz L_ob_early
    s_cmp_lg_u32 s82, 0
    s_cbranch_scc1 L_ob_late
    s_sleep 4
    s_sub_u32 s90, s90, 1
    s_cbranch_scc0 L_ob_try
L_ob_late:
    s_barrier
    s_barrier
    s_branch L_p3_wait
L_ob_early:
    buffer_load_dwordx4 v[112:115], v1, s[32:35], s76 offen offset:0 sc1
    buffer_load_dwordx4 v[116:119], v1, s[32:35], s76 offen offset:1024 sc1
    buffer_load_dwordx4 v[120:123], v1, s[32:35], s76 offen offset:2048 sc1
    buffer_load_dwordx4 v[124:127], v1, s[32:35], s76 offen offset:3072 sc1
    buffer_load_dwordx4 v[128:131], v1, s[32:35], s77 offen offset:0 sc1
    buffer_load_dwordx4 v[132:135], v1, s[32:35], s77 offen offset:1024 sc1
    buffer_load_dwordx4 v[136:139], v1, s[32:35], s77 offen offset:2048 sc1
    buffer_load_dwordx4 v[140:143], v1, s[32:35], s77 offen offset:3072 sc1
    buffer_load_dwordx4 v[144:147], v1, s[32:35], s78 offen offset:0 sc1
    buffer_load_dwordx4 v[148:151], v1, s[32:35], s78 offen offset:1024 sc1
    buffer_load_dwordx4 v[152:155], v1, s[32:35], s78 offen offset:2048 sc1
    buffer_load_dwordx4 v[156:159], v1, s[32:35], s78 offen offset:3072 sc1
    buffer_load_dwordx4 v[160:163], v1, s[32:35], s79 offen offset:0 sc1
    buffer_load_dwordx4 v[164:167], v1, s[32:35], s79 offen offset:1024 sc1
    buffer_load_dwordx4 v[168:171], v1, s[32:35], s79 offen offset:2048 sc1
    buffer_load_dwordx4 v[172:175], v1, s[32:35], s79 offen offset:3072 sc1
    s_barrier
    s_barrier
    s_branch L_p3
L_code_end:
L_fallback:
    s_mov_b32 exec_lo, 0
    v_mov_b32 v110, 0
    s_mov_b32 exec_lo, -1
    s_lshl_b32 s76, s63, 18
    s_add_u32 s76, s76, 4194304
    s_mov_b32 s77, s76
    s_add_u32 s78, s76, 262144
    v_mov_b32 v12, 0xff800000
L_fb1:
    buffer_load_dwordx4 v[112:115], v1, s[32:35], s77 offen sc1
    buffer_load_dwordx4 v[116:119], v1, s[32:35], s77 offen offset:1024 sc1
    s_waitcnt vmcnt(0)
    v_mfma_f32_32x32x16_bf16 v[192:207], v[112:115], v[104:107], 0
    v_mfma_f32_32x32x16_bf16 v[192:207], v[116:119], v[108:111], v[192:207]
    s_nop 11
    v_max3_f32 v12, v12, v192, v193
    v_max3_f32 v12, v12, v194, v195
    v_max3_f32 v12, v12, v196, v197
    v_max3_f32 v12, v12, v198, v199
    v_max3_f32 v12, v12, v200, v201
    v_max3_f32 v12, v12, v202, v203
    v_max3_f32 v12, v12, v204, v205
    v_max3_f32 v12, v12, v206, v207
    s_add_u32 s77, s77, 4096
    s_cmp_lt_u32 s77, s78
    s_cbranch_scc1 L_fb1
    v_mov_b32 v13, v12
    s_nop 1
    v_permlane32_swap_b32 v12, v13
    v_max_f32 v12, v12, v13
    v_mov_b64 v[64:65], 0
    v_mov_b64 v[66:67], 0
    v_mov_b64 v[68:69], 0
    v_mov_b64 v[70:71], 0
    v_mov_b64 v[72:73], 0
    v_mov_b64 v[74:75], 0
    v_mov_b64 v[76:77], 0
    v_mov_b64 v[78:79], 0
L_fb2:
    buffer_load_dwordx4 v[112:115], v1, s[32:35], s76 offen offset:0 sc1
    buffer_load_dwordx4 v[116:119], v1, s[32:35], s76 offen offset:1024 sc1
    buffer_load_dwordx4 v[120:123], v1, s[32:35], s76 offen offset:2048 sc1
    buffer_load_dwordx4 v[124:127], v1, s[32:35], s76 offen offset:3072 sc1
    s_waitcnt vmcnt(0)
    v_mfma_f32_32x32x16_bf16 v[192:207], v[112:115], v[104:107], 0
    v_mfma_f32_32x32x16_bf16 v[192:207], v[116:119], v[108:111], v[192:207]
    s_nop 11
    v_sub_f32 v192, v192, v12
    v_sub_f32 v193, v193, v12
    v_sub_f32 v194, v194, v12
    v_sub_f32 v195, v195, v12
    v_sub_f32 v196, v196, v12
    v_sub_f32 v197, v197, v12
    v_sub_f32 v198, v198, v12
    v_sub_f32 v199, v199, v12
    v_sub_f32 v200, v200, v12
    v_sub_f32 v201, v201, v12
    v_sub_f32 v202, v202, v12
    v_sub_f32 v203, v203, v12
    v_sub_f32 v204, v204, v12
    v_sub_f32 v205, v205, v12
    v_sub_f32 v206, v206, v12
    v_sub_f32 v207, v207, v12
    v_exp_f32 v192, v192
    v_exp_f32 v193, v193
    v_exp_f32 v194, v194
    v_exp_f32 v195, v195
    v_exp_f32 v196, v196
    v_exp_f32 v197, v197
    v_exp_f32 v198, v198
    v_exp_f32 v199, v199
    v_exp_f32 v200, v200
    v_exp_f32 v201, v201
    v_exp_f32 v202, v202
    v_exp_f32 v203, v203
    v_exp_f32 v204, v204
    v_exp_f32 v205, v205
    v_exp_f32 v206, v206
    v_exp_f32 v207, v207
    s_nop 1
    v_smfmac_f32_32x32x32_bf16 v[64:79], v[120:123], v[192:199], v2
    v_smfmac_f32_32x32x32_bf16 v[64:79], v[124:127], v[200:207], v2
    s_add_u32 s76, s76, 4096
    s_cmp_lt_u32 s76, s78
    s_cbranch_scc1 L_fb2
    s_nop 11
    v_mov_b32 v8, v76
    v_mov_b32 v9, v76
    s_nop 1
    v_permlane32_swap_b32 v8, v9
    v_rcp_f32 v10, v9
    s_nop 0
    v_pk_mul_f32 v[64:65], v[64:65], v[10:11] op_sel_hi:[1,0]
    v_pk_mul_f32 v[66:67], v[66:67], v[10:11] op_sel_hi:[1,0]
    v_pk_mul_f32 v[68:69], v[68:69], v[10:11] op_sel_hi:[1,0]
    v_pk_mul_f32 v[70:71], v[70:71], v[10:11] op_sel_hi:[1,0]
    v_pk_mul_f32 v[72:73], v[72:73], v[10:11] op_sel_hi:[1,0]
    v_pk_mul_f32 v[74:75], v[74:75], v[10:11] op_sel_hi:[1,0]
    v_pk_mul_f32 v[76:77], v[76:77], v[10:11] op_sel_hi:[1,0]
    v_pk_mul_f32 v[78:79], v[78:79], v[10:11] op_sel_hi:[1,0]
    v_cvt_pk_bf16_f32 v214, v76, v77
    v_cvt_pk_bf16_f32 v215, v78, v79
    v_cvt_pk_bf16_f32 v208, v64, v65
    v_cvt_pk_bf16_f32 v209, v66, v67
    v_cvt_pk_bf16_f32 v210, v68, v69
    v_cvt_pk_bf16_f32 v211, v70, v71
    v_cvt_pk_bf16_f32 v212, v72, v73
    v_cvt_pk_bf16_f32 v213, v74, v75
    v_permlane32_swap_b32 v214, v215
    v_perm_b32 v215, v253, v211, s86
    v_perm_b32 v211, v253, v211, s87
    s_branch L_ostore
.section .rodata,"a"
.p2align 6
.amdhsa_kernel concat_heads__softmax_full_mha__linear_kernel_hedgehog__prompt_kernel
  .amdhsa_next_free_vgpr 256
  .amdhsa_next_free_sgpr 102
  .amdhsa_accum_offset 256
  .amdhsa_group_segment_fixed_size 0
  .amdhsa_kernarg_size 80
  .amdhsa_user_sgpr_count 2
  .amdhsa_user_sgpr_kernarg_segment_ptr 1
  .amdhsa_system_sgpr_workgroup_id_x 1
.end_amdhsa_kernel
```
